```python
import torch

def _softmax(x, axis=-1):
    return torch.softmax(x, dim=axis)

def _gelu(x):
    return torch.nn.functional.gelu(x, approximate='tanh')

def _silu(x):
    return torch.nn.functional.silu(x)

def _sigmoid(x):
    return torch.sigmoid(x)

def _layernorm(x, axis=-1, eps=1e-05):
    m = x.mean(dim=axis, keepdim=True)
    v = x.var(dim=axis, keepdim=True, unbiased=False)
    return (x - m) / torch.sqrt(v + eps)

def _scatter_add(tgt, idx, src, axis=0):
    return tgt.clone().index_add_(axis, idx, src)

def _segment_sum(src, seg, n):
    out = torch.zeros((n,) + src.shape[1:], dtype=src.dtype)
    return out.index_add_(0, seg, src)

def _pad(x, pw):
    flat = tuple((v for pair in reversed(pw) for v in pair))
    return torch.nn.functional.pad(x, flat)
kernel_name = 'adaLN_cond__memory_aug_recurrent_mem_tr__swiglu_ffn__prompt'

def setup_inputs():

    _w = lambda a: (lambda t: t.to(torch.bfloat16) if t.is_floating_point() else t)(torch.as_tensor(a))

    def _A_setup():
        B, S, Dm = (1, 2048, 576)
        H, Dh = (32, 128)
        M, seg = (8, 32)
        seg = min(seg, S)
        S = S // seg * seg
        return {'x': _w((lambda *s: torch.randn(*s, dtype=torch.bfloat16) * 0.05)(B, S, Dm)), 'mem0': _w((lambda *s: torch.randn(*s, dtype=torch.bfloat16) * 0.4)(B, M, Dm)), 'Wq': _w((lambda *s: torch.randn(*s, dtype=torch.bfloat16) * 3.2)(Dm, H, Dh) * Dm ** (-0.5)), 'Wk': _w((lambda *s: torch.randn(*s, dtype=torch.bfloat16) * 3.2)(Dm, H, Dh) * Dm ** (-0.5)), 'Wv': _w((lambda *s: torch.randn(*s, dtype=torch.bfloat16) * 0.4)(Dm, H, Dh) * Dm ** (-0.5)), 'Wo': _w((lambda *s: torch.randn(*s, dtype=torch.bfloat16) * 0.4)(H, Dh, Dm) * (H * Dh) ** (-0.5)), 'seg_len': seg}
    _A_in = _A_setup()

    def _B_setup():
        B, S, D, F = (1, 2048, 576, 4608)
        return {'x': _w((lambda *s: torch.randn(*s, dtype=torch.bfloat16) * 0.05)(B, S, D)), 'w_gate': _w((lambda *s: torch.randn(*s, dtype=torch.bfloat16) * 0.05)(D, F)), 'w_up': _w((lambda *s: torch.randn(*s, dtype=torch.bfloat16) * 0.05)(D, F)), 'w_down': _w((lambda *s: torch.randn(*s, dtype=torch.bfloat16) * 0.05)(F, D))}
    _B_in = _B_setup()
    return {'A_x': _A_in['x'], 'A_mem0': _A_in['mem0'], 'A_Wq': _A_in['Wq'], 'A_Wk': _A_in['Wk'], 'A_Wv': _A_in['Wv'], 'A_Wo': _A_in['Wo'], 'A_seg_len': _A_in['seg_len'], 'B_x': _B_in['x'], 'B_w_gate': _B_in['w_gate'], 'B_w_up': _B_in['w_up'], 'B_w_down': _B_in['w_down'], 'c': _w((lambda *s: torch.randn(*s, dtype=torch.bfloat16) * 0.1)(1, 576) * 8.0), 'w_mod': _w((lambda *s: torch.randn(*s, dtype=torch.bfloat16) * 0.1)(576, 6 * 576) * 576 ** (-0.5) * 8.0)}

def reference(A_x, A_mem0, A_Wq, A_Wk, A_Wv, A_Wo, A_seg_len, B_x, B_w_gate, B_w_up, B_w_down, c, w_mod):

    def _A_ref(x, mem0, Wq, Wk, Wv, Wo, seg_len):
        B, S, Dm = x.shape
        H, Dh = (Wq.shape[1], Wq.shape[2])
        M = mem0.shape[1]
        scale = Dh ** (-0.5)
        n_seg = S // seg_len
        L = M + seg_len
        idx = torch.arange(L)
        mask = (idx[:, None] < M) | (idx[:, None] >= idx[None, :])
        mem = mem0
        outs = []
        for s in range(n_seg):
            xs = x[:, s * seg_len:(s + 1) * seg_len, :].clone()
            h = torch.concatenate([mem, xs], axis=1)
            q = torch.einsum('btd,dhe->bhte', h, Wq)
            k = torch.einsum('btd,dhe->bhte', h, Wk)
            v = torch.einsum('btd,dhe->bhte', h, Wv)
            scores = torch.einsum('bhqe,bhke->bhqk', q, k) * scale
            scores = torch.where(mask[None, None], scores, -1000000000.0)
            p = _softmax(scores, axis=-1)
            o = torch.einsum('bhqk,bhke->bhqe', p, v)
            o = torch.einsum('bhte,hed->btd', o, Wo)
            mem = o[:, :M, :].clone()
            outs.append(o[:, M:, :])
        return torch.concatenate(outs, axis=1)

    def _B_ref(x, w_gate, w_up, w_down):
        g = _silu(x @ w_gate)
        u = x @ w_up
        return g * u @ w_down
    x = A_x
    mod = (_silu(c) @ w_mod).reshape(c.shape[0], 6, 1, -1)
    sa, ca, ga, sb, cb, gb = (mod[:, 0].clone(), mod[:, 1].clone(), mod[:, 2].clone(), mod[:, 3].clone(), mod[:, 4].clone(), mod[:, 5].clone())
    h = _layernorm(x, axis=-1) * (1 + ca) + sa
    x = x + ga * _A_ref(h, A_mem0, A_Wq, A_Wk, A_Wv, A_Wo, A_seg_len)
    h = _layernorm(x, axis=-1) * (1 + cb) + sb
    x = x + gb * _B_ref(h, B_w_gate, B_w_up, B_w_down)
    return x
```

```asm
; @launch grid=(256,1,1) block=(256,1,1) lds=163840
.amdgcn_target "amdgcn-amd-amdhsa--gfx950"
.text
.globl adaLN_cond__memory_aug_recurrent_mem_tr__swiglu_ffn__prompt_kernel
.p2align 8
.type adaLN_cond__memory_aug_recurrent_mem_tr__swiglu_ffn__prompt_kernel,@function
adaLN_cond__memory_aug_recurrent_mem_tr__swiglu_ffn__prompt_kernel:
  s_cmp_ge_u32 s2, 256
  s_cbranch_scc1 L_END
  s_load_dwordx16 s[4:19], s[0:1], 0
  s_load_dwordx16 s[20:35], s[0:1], 64
  s_getreg_b32 s66, hwreg(HW_REG_XCC_ID)
  v_lshrrev_b32 v1, 6, v0
  s_and_b32 s66, s66, 7
  s_lshl_b32 s66, s66, 2
  s_lshr_b32 s66, 1952600368, s66
  s_and_b32 s66, s66, 7
  v_readfirstlane_b32 s64, v1
  v_and_b32 v0, 63, v0
  s_mov_b32 s68, 0
  s_mov_b32 s65, 0
  s_waitcnt lgkmcnt(0)
  s_mov_b32 s36, s34
  s_and_b32 s37, s35, 0xffff
  s_mov_b32 s38, 268435456
  s_mov_b32 s39, 0x20000
  s_mov_b32 s40, s32
  s_and_b32 s41, s33, 0xffff
  s_mov_b32 s42, 256
  s_mov_b32 s43, 0x20000
  v_mov_b32 v3, 0
  s_cmp_lg_u32 s64, 0
  s_cbranch_scc1 L_TK
  s_mov_b32 s72, 0x40848000
  s_mov_b32 s73, 0xc8c4c044
  s_lshl_b32 s70, s66, 3
  s_lshr_b64 s[72:73], s[72:73], s70
  s_and_b32 s70, s72, 0xff
  v_mov_b32 v1, 1
  v_mov_b32 v2, s70
  s_mov_b64 exec, 1
  buffer_atomic_add v1, v2, s[40:43], 0 offen sc0
  s_waitcnt vmcnt(0)
  ds_write_b32 v3, v1
  s_mov_b64 exec, -1
  s_waitcnt lgkmcnt(0)
L_TK:
  s_getpc_b64 s[60:61]
PC_1:
  s_add_u32 s60, s60, L_ABORT-PC_1
  s_addc_u32 s61, s61, 0
  s_and_b32 s61, s61, 0xffff
  s_mov_b32 s62, L_CODE_END-L_ABORT
  s_mov_b32 s63, 0x20000
  v_lshlrev_b32_e64 v4, 7, v0
  s_mul_i32 s97, s64, 32768
  buffer_load_dword v5, v4, s[60:63], s97 offen
  s_add_u32 s97, s97, 8192
  buffer_load_dword v5, v4, s[60:63], s97 offen
  s_add_u32 s97, s97, 8192
  buffer_load_dword v5, v4, s[60:63], s97 offen
  s_add_u32 s97, s97, 8192
  buffer_load_dword v5, v4, s[60:63], s97 offen
  s_barrier
  ds_read_b32 v1, v3
  s_waitcnt lgkmcnt(0)
  v_readfirstlane_b32 s65, v1
  s_barrier
  s_cmp_ge_u32 s65, 32
  s_cbranch_scc1 L_END
  s_cmp_eq_u32 s66, 0
  s_cbranch_scc1 L_J_T
  s_sub_u32 s67, s66, 1
  s_cmp_lt_u32 s66, 3
  s_cbranch_scc1 L_J_P
  s_sub_u32 s67, s66, 3
  s_cmp_lt_u32 s66, 5
  s_cbranch_scc1 L_J_A
  s_sub_u32 s67, s66, 5
  s_branch L_ROLE_F
L_J_T:
  s_branch L_ROLE_T
L_J_P:
  s_branch L_ROLE_P
L_J_A:
  s_branch L_ROLE_A
L_ABORT:
  s_mov_b64 exec, 1
  v_mov_b32 v1, s68
  s_lshl_b32 s70, s66, 2
  v_mov_b32 v2, s70
  buffer_store_dword v1, v2, s[40:43], 0 offen offset:224
  s_waitcnt vmcnt(0)
L_END:
  s_endpgm
L_ROLE_T:
  s_mov_b32 s44, s8
  s_and_b32 s45, s9, 0xffff
  s_mov_b32 s46, 4718592
  s_mov_b32 s47, 0x20000
  s_mov_b32 s48, s10
  s_and_b32 s49, s11, 0xffff
  s_mov_b32 s50, 4718592
  s_mov_b32 s51, 0x20000
  s_mov_b32 s52, s12
  s_and_b32 s53, s13, 0xffff
  s_mov_b32 s54, 4718592
  s_mov_b32 s55, 0x20000
  s_mov_b32 s56, s14
  s_and_b32 s57, s15, 0xffff
  s_mov_b32 s58, 4718592
  s_mov_b32 s59, 0x20000
  s_mov_b32 s60, s6
  s_and_b32 s61, s7, 0xffff
  s_mov_b32 s62, 9216
  s_mov_b32 s63, 0x20000
  v_mov_b32_e64 v60, v0
  s_mov_b32 s16, 0x00ff00ff
  s_mov_b32 s17, 0x00ff00ff
  v_bfe_u32 v61, v60, 4, 1
  v_lshlrev_b32_e64 v65, 17, v61
  v_bfe_u32 v61, v60, 5, 1
  v_lshl_add_u32 v65, v61, 13, v65
  v_bfe_u32 v61, v60, 0, 4
  v_lshl_add_u32 v65, v61, 4, v65
  v_bfe_u32 v61, v60, 5, 1
  v_lshlrev_b32_e64 v69, 15, v61
  v_bfe_u32 v61, v60, 4, 1
  v_lshl_add_u32 v69, v61, 13, v69
  v_bfe_u32 v61, v60, 0, 4
  v_lshl_add_u32 v69, v61, 4, v69
  v_bfe_u32 v61, v60, 4, 2
  v_lshlrev_b32_e64 v62, 0, v61
  v_mul_u32_u24 v66, 1152, v62
  v_bfe_u32 v61, v60, 0, 4
  v_lshl_add_u32 v66, v61, 4, v66
  v_bfe_u32 v61, v60, 4, 2
  v_lshlrev_b32_e64 v62, 0, v61
  v_bfe_u32 v61, v60, 3, 1
  v_lshl_add_u32 v62, v61, 6, v62
  v_mul_u32_u24 v67, 1152, v62
  v_bfe_u32 v61, v60, 0, 3
  v_lshl_add_u32 v67, v61, 4, v67
  s_mul_i32 s70, s64, 36864
  s_add_u32 s70, s70, 16384
  s_lshl_b32 s79, s65, 8
  s_and_b32 s71, s64, 1
  s_lshl_b32 s71, s71, 20
  s_add_u32 s75, s79, s71
  s_lshr_b32 s71, s64, 1
  s_lshl_b32 s71, s71, 16
  s_add_u32 s75, s75, s71
  s_lshl_b32 s71, s64, 17
  s_add_u32 s79, s79, s71
  s_mul_i32 s80, s65, 147456
  s_mul_i32 s71, s64, 4608
  s_add_u32 s80, s80, s71
  v_lshlrev_b32 v2, 4, v60
  v_add_u32 v4, s70, v2
  v_bfe_u32 v61, v60, 5, 1
  v_lshlrev_b32_e64 v62, 0, v61
  v_mul_u32_u24 v68, 36864, v62
  v_bfe_u32 v61, v60, 3, 1
  v_lshl_add_u32 v68, v61, 11, v68
  v_bfe_u32 v61, v60, 4, 1
  v_lshl_add_u32 v68, v61, 10, v68
  v_bfe_u32 v61, v60, 2, 1
  v_lshl_add_u32 v68, v61, 8, v68
  v_bfe_u32 v61, v60, 0, 2
  v_lshl_add_u32 v68, v61, 3, v68
  s_lshl_b32 s71, s64, 5
  s_add_u32 s71, s71, 16384
  v_add_u32 v71, s71, v68
  v_add_u32 v72, 73728, v71
  s_lshl_b32 s71, s64, 5
  v_add_u32 v68, s71, v71
  v_add_u32 v70, 73728, v68
  v_lshrrev_b32 v74, 1, v60
  v_lshlrev_b32 v74, 13, v74
  v_and_b32 v75, 1, v60
  v_lshl_add_u32 v74, v75, 7, v74
  s_and_b32 s71, s65, 3
  s_lshl_b32 s71, s71, 2
  s_lshr_b32 s77, 0x21f0, s71
  s_and_b32 s77, s77, 15
  s_mul_i32 s71, s64, 3
  s_add_u32 s77, s77, s71
  s_and_b32 s78, s65, 28
  s_add_u32 s78, s78, 1
  s_lshl_b32 s78, s78, 8
  v_bfe_u32 v61, v60, 4, 2
  v_lshlrev_b32 v1, 8, v61
  v_bfe_u32 v61, v60, 1, 1
  v_lshl_add_u32 v1, v61, 7, v1
  v_bfe_u32 v61, v60, 2, 2
  v_lshl_add_u32 v1, v61, 5, v1
  v_bfe_u32 v61, v60, 0, 1
  v_lshl_add_u32 v1, v61, 4, v1
  v_bfe_u32 v61, v60, 4, 2
  v_lshlrev_b32 v73, 5, v61
  v_bfe_u32 v61, v60, 0, 3
  v_lshl_add_u32 v73, v61, 2, v73
  v_mov_b32 v64, 0
  s_lshl_b32 s74, s64, 5
  s_xor_b32 s71, s65, -1
  s_and_b32 s89, s71, 3
  s_lshl_b32 s89, s89, 3
  s_lshr_b32 s71, s71, 2
  s_add_u32 s71, s71, s89
  s_cmp_eq_u32 s64, 99
  s_cselect_b32 s71, s71, s65
  s_add_u32 s74, s74, s71
  s_cmp_lt_u32 s74, 72
  s_cselect_b32 s90, 1, 0
  s_lshl_b32 s94, s65, 7
  s_lshl_b32 s93, s74, 7
  s_add_u32 s88, s94, 8192
  s_lshl_b32 s82, s74, 12
  s_add_u32 s82, s82, 31457280
  buffer_store_dword v64, v64, s[36:39], s88 offen sc1
  buffer_store_dword v64, v64, s[36:39], s88 offen offset:4 sc1
  s_cmp_eq_u32 s90, 0
  s_cbranch_scc1 L_T_NOINIT
  v_mov_b32 v16, -1
  v_mov_b32 v17, -1
  v_mov_b32 v18, -1
  v_mov_b32 v19, -1
  buffer_store_dwordx4 v[16:19], v2, s[36:39], s82 offen offset:0
  buffer_store_dwordx4 v[16:19], v2, s[36:39], s82 offen offset:1024
  buffer_store_dwordx4 v[16:19], v2, s[36:39], s82 offen offset:2048
  buffer_store_dwordx4 v[16:19], v2, s[36:39], s82 offen offset:3072
  s_cmp_ge_u32 s74, 64
  s_cbranch_scc1 L_T_M0B
  v_bfe_u32 v61, v60, 4, 1
  v_lshlrev_b32_e64 v62, 0, v61
  v_mul_u32_u24 v62, 1152, v62
  v_bfe_u32 v61, v60, 5, 1
  v_lshl_add_u32 v62, v61, 8, v62
  v_bfe_u32 v61, v60, 0, 3
  v_lshl_add_u32 v62, v61, 1, v62
  s_bfe_u32 s71, s74, 0x20001
  s_mul_i32 s71, s71, 2304
  s_bfe_u32 s89, s74, 0x20003
  s_lshl_b32 s89, s89, 6
  s_add_u32 s71, s71, s89
  s_bfe_u32 s89, s74, 0x10005
  s_lshl_b32 s89, s89, 9
  s_add_u32 s71, s71, s89
  s_and_b32 s89, s74, 1
  s_lshl_b32 s89, s89, 4
  s_add_u32 s71, s71, s89
  buffer_load_ushort v63, v62, s[60:63], s71 offen
  buffer_load_ushort v61, v62, s[60:63], s71 offen offset:32
  s_branch L_T_M0C
L_T_M0B:
  v_bfe_u32 v61, v60, 2, 1
  v_lshlrev_b32_e64 v62, 1, v61
  v_bfe_u32 v61, v60, 4, 1
  v_lshl_add_u32 v62, v61, 0, v62
  v_mul_u32_u24 v62, 1152, v62
  v_bfe_u32 v61, v60, 0, 2
  v_lshl_add_u32 v62, v61, 3, v62
  v_bfe_u32 v61, v60, 5, 1
  v_lshl_add_u32 v62, v61, 2, v62
  s_bfe_u32 s71, s74, 0x20001
  s_lshl_b32 s71, s71, 5
  s_and_b32 s89, s74, 1
  s_mul_i32 s89, s89, 4608
  s_add_u32 s71, s71, s89
  buffer_load_dword v63, v62, s[60:63], s71 offen offset:1024
  v_mov_b32_e64 v61, 0
L_T_M0C:
  s_mov_b64 exec, s[16:17]
  s_add_u32 s71, s93, 140288
  buffer_store_dword v16, v73, s[36:39], s71 offen
  s_add_u32 s71, s93, 149504
  buffer_store_dword v16, v73, s[36:39], s71 offen
  s_mov_b64 exec, -1
L_T_NOINIT:
  s_add_u32 m0, s70, 0
  s_add_u32 s71, s75, 0
  buffer_load_dwordx4 v65, s[48:51], s71 offen lds
  s_add_u32 m0, s70, 1024
  s_add_u32 s71, s75, 16384
  buffer_load_dwordx4 v65, s[48:51], s71 offen lds
  s_add_u32 m0, s70, 2048
  s_add_u32 s71, s75, 32768
  buffer_load_dwordx4 v65, s[48:51], s71 offen lds
  s_add_u32 m0, s70, 3072
  s_add_u32 s71, s75, 49152
  buffer_load_dwordx4 v65, s[48:51], s71 offen lds
  s_add_u32 m0, s70, 4096
  s_add_u32 s71, s75, 262144
  buffer_load_dwordx4 v65, s[48:51], s71 offen lds
  s_add_u32 m0, s70, 5120
  s_add_u32 s71, s75, 278528
  buffer_load_dwordx4 v65, s[48:51], s71 offen lds
  s_add_u32 m0, s70, 6144
  s_add_u32 s71, s75, 294912
  buffer_load_dwordx4 v65, s[48:51], s71 offen lds
  s_add_u32 m0, s70, 7168
  s_add_u32 s71, s75, 311296
  buffer_load_dwordx4 v65, s[48:51], s71 offen lds
  s_add_u32 m0, s70, 8192
  s_add_u32 s71, s75, 524288
  buffer_load_dwordx4 v65, s[48:51], s71 offen lds
  s_add_u32 m0, s70, 9216
  s_add_u32 s71, s75, 540672
  buffer_load_dwordx4 v65, s[48:51], s71 offen lds
  s_add_u32 m0, s70, 10240
  s_add_u32 s71, s75, 557056
  buffer_load_dwordx4 v65, s[48:51], s71 offen lds
  s_add_u32 m0, s70, 11264
  s_add_u32 s71, s75, 573440
  buffer_load_dwordx4 v65, s[48:51], s71 offen lds
  s_add_u32 m0, s70, 12288
  s_add_u32 s71, s75, 786432
  buffer_load_dwordx4 v65, s[48:51], s71 offen lds
  s_add_u32 m0, s70, 13312
  s_add_u32 s71, s75, 802816
  buffer_load_dwordx4 v65, s[48:51], s71 offen lds
  s_add_u32 m0, s70, 14336
  s_add_u32 s71, s75, 819200
  buffer_load_dwordx4 v65, s[48:51], s71 offen lds
  s_add_u32 m0, s70, 15360
  s_add_u32 s71, s75, 835584
  buffer_load_dwordx4 v65, s[48:51], s71 offen lds
  s_add_u32 m0, s70, 16384
  s_add_u32 s71, s75, 2097152
  buffer_load_dwordx4 v65, s[48:51], s71 offen lds
  s_add_u32 m0, s70, 17408
  s_add_u32 s71, s75, 2113536
  buffer_load_dwordx4 v65, s[48:51], s71 offen lds
  s_add_u32 m0, s70, 18432
  s_add_u32 s71, s75, 2129920
  buffer_load_dwordx4 v65, s[48:51], s71 offen lds
  s_add_u32 m0, s70, 19456
  s_add_u32 s71, s75, 2146304
  buffer_load_dwordx4 v65, s[48:51], s71 offen lds
  s_add_u32 m0, s70, 20480
  s_add_u32 s71, s75, 2359296
  buffer_load_dwordx4 v65, s[48:51], s71 offen lds
  s_add_u32 m0, s70, 21504
  s_add_u32 s71, s75, 2375680
  buffer_load_dwordx4 v65, s[48:51], s71 offen lds
  s_add_u32 m0, s70, 22528
  s_add_u32 s71, s75, 2392064
  buffer_load_dwordx4 v65, s[48:51], s71 offen lds
  s_add_u32 m0, s70, 23552
  s_add_u32 s71, s75, 2408448
  buffer_load_dwordx4 v65, s[48:51], s71 offen lds
  s_add_u32 m0, s70, 24576
  s_add_u32 s71, s75, 2621440
  buffer_load_dwordx4 v65, s[48:51], s71 offen lds
  s_add_u32 m0, s70, 25600
  s_add_u32 s71, s75, 2637824
  buffer_load_dwordx4 v65, s[48:51], s71 offen lds
  s_add_u32 m0, s70, 26624
  s_add_u32 s71, s75, 2654208
  buffer_load_dwordx4 v65, s[48:51], s71 offen lds
  s_add_u32 m0, s70, 27648
  s_add_u32 s71, s75, 2670592
  buffer_load_dwordx4 v65, s[48:51], s71 offen lds
  s_add_u32 m0, s70, 28672
  s_add_u32 s71, s75, 2883584
  buffer_load_dwordx4 v65, s[48:51], s71 offen lds
  s_add_u32 m0, s70, 29696
  s_add_u32 s71, s75, 2899968
  buffer_load_dwordx4 v65, s[48:51], s71 offen lds
  s_add_u32 m0, s70, 30720
  s_add_u32 s71, s75, 2916352
  buffer_load_dwordx4 v65, s[48:51], s71 offen lds
  s_add_u32 m0, s70, 31744
  s_add_u32 s71, s75, 2932736
  buffer_load_dwordx4 v65, s[48:51], s71 offen lds
  s_add_u32 m0, s70, 32768
  s_add_u32 s71, s79, 4194304
  buffer_load_dwordx4 v69, s[48:51], s71 offen lds
  s_add_u32 m0, s70, 33792
  s_add_u32 s71, s79, 4259840
  buffer_load_dwordx4 v69, s[48:51], s71 offen lds
  s_add_u32 m0, s70, 34816
  s_add_u32 s71, s79, 4210688
  buffer_load_dwordx4 v69, s[48:51], s71 offen lds
  s_add_u32 m0, s70, 35840
  s_add_u32 s71, s79, 4276224
  buffer_load_dwordx4 v69, s[48:51], s71 offen lds
  s_waitcnt vmcnt(32) lgkmcnt(0)
  s_barrier
  s_cmp_eq_u32 s90, 0
  s_cbranch_scc1 L_T_HK0
  v_lshl_add_u32 v63, v61, 16, v63
  v_min_u32 v63, -2, v63
  s_mov_b64 exec, s[16:17]
  s_add_u32 s71, s93, 131072
  buffer_store_dword v63, v73, s[36:39], s71 offen
  s_mov_b64 exec, -1
L_T_HK0:
  ds_read_b64_tr_b16 a[0:1], v68 offset:0
  ds_read_b64_tr_b16 a[2:3], v68 offset:512
  ds_read_b64_tr_b16 a[4:5], v70 offset:0
  ds_read_b64_tr_b16 a[6:7], v70 offset:512
  ds_read_b64_tr_b16 a[8:9], v68 offset:32
  ds_read_b64_tr_b16 a[10:11], v68 offset:544
  ds_read_b64_tr_b16 a[12:13], v70 offset:32
  ds_read_b64_tr_b16 a[14:15], v70 offset:544
  s_waitcnt vmcnt(28) lgkmcnt(0)
  s_barrier
  s_add_u32 m0, s70, 0
  s_add_u32 s71, s75, 2097152
  buffer_load_dwordx4 v65, s[44:47], s71 offen lds
  s_add_u32 m0, s70, 1024
  s_add_u32 s71, s75, 2113536
  buffer_load_dwordx4 v65, s[44:47], s71 offen lds
  s_add_u32 m0, s70, 2048
  s_add_u32 s71, s75, 2129920
  buffer_load_dwordx4 v65, s[44:47], s71 offen lds
  s_add_u32 m0, s70, 3072
  s_add_u32 s71, s75, 2146304
  buffer_load_dwordx4 v65, s[44:47], s71 offen lds
  ds_read_b64_tr_b16 a[16:17], v68 offset:4096
  ds_read_b64_tr_b16 a[18:19], v68 offset:4608
  ds_read_b64_tr_b16 a[20:21], v70 offset:4096
  ds_read_b64_tr_b16 a[22:23], v70 offset:4608
  ds_read_b64_tr_b16 a[24:25], v68 offset:4128
  ds_read_b64_tr_b16 a[26:27], v68 offset:4640
  ds_read_b64_tr_b16 a[28:29], v70 offset:4128
  ds_read_b64_tr_b16 a[30:31], v70 offset:4640
  s_waitcnt vmcnt(28) lgkmcnt(0)
  s_barrier
  s_add_u32 m0, s70, 4096
  s_add_u32 s71, s75, 2359296
  buffer_load_dwordx4 v65, s[44:47], s71 offen lds
  s_add_u32 m0, s70, 5120
  s_add_u32 s71, s75, 2375680
  buffer_load_dwordx4 v65, s[44:47], s71 offen lds
  s_add_u32 m0, s70, 6144
  s_add_u32 s71, s75, 2392064
  buffer_load_dwordx4 v65, s[44:47], s71 offen lds
  s_add_u32 m0, s70, 7168
  s_add_u32 s71, s75, 2408448
  buffer_load_dwordx4 v65, s[44:47], s71 offen lds
  ds_read_b64_tr_b16 a[32:33], v68 offset:8192
  ds_read_b64_tr_b16 a[34:35], v68 offset:8704
  ds_read_b64_tr_b16 a[36:37], v70 offset:8192
  ds_read_b64_tr_b16 a[38:39], v70 offset:8704
  ds_read_b64_tr_b16 a[40:41], v68 offset:8224
  ds_read_b64_tr_b16 a[42:43], v68 offset:8736
  ds_read_b64_tr_b16 a[44:45], v70 offset:8224
  ds_read_b64_tr_b16 a[46:47], v70 offset:8736
  s_waitcnt vmcnt(28) lgkmcnt(0)
  s_barrier
  s_add_u32 m0, s70, 8192
  s_add_u32 s71, s75, 2621440
  buffer_load_dwordx4 v65, s[44:47], s71 offen lds
  s_add_u32 m0, s70, 9216
  s_add_u32 s71, s75, 2637824
  buffer_load_dwordx4 v65, s[44:47], s71 offen lds
  s_add_u32 m0, s70, 10240
  s_add_u32 s71, s75, 2654208
  buffer_load_dwordx4 v65, s[44:47], s71 offen lds
  s_add_u32 m0, s70, 11264
  s_add_u32 s71, s75, 2670592
  buffer_load_dwordx4 v65, s[44:47], s71 offen lds
  ds_read_b64_tr_b16 a[48:49], v68 offset:12288
  ds_read_b64_tr_b16 a[50:51], v68 offset:12800
  ds_read_b64_tr_b16 a[52:53], v70 offset:12288
  ds_read_b64_tr_b16 a[54:55], v70 offset:12800
  ds_read_b64_tr_b16 a[56:57], v68 offset:12320
  ds_read_b64_tr_b16 a[58:59], v68 offset:12832
  ds_read_b64_tr_b16 a[60:61], v70 offset:12320
  ds_read_b64_tr_b16 a[62:63], v70 offset:12832
  s_waitcnt vmcnt(28) lgkmcnt(0)
  s_barrier
  s_add_u32 m0, s70, 12288
  s_add_u32 s71, s75, 2883584
  buffer_load_dwordx4 v65, s[44:47], s71 offen lds
  s_add_u32 m0, s70, 13312
  s_add_u32 s71, s75, 2899968
  buffer_load_dwordx4 v65, s[44:47], s71 offen lds
  s_add_u32 m0, s70, 14336
  s_add_u32 s71, s75, 2916352
  buffer_load_dwordx4 v65, s[44:47], s71 offen lds
  s_add_u32 m0, s70, 15360
  s_add_u32 s71, s75, 2932736
  buffer_load_dwordx4 v65, s[44:47], s71 offen lds
  ds_read_b64_tr_b16 a[64:65], v68 offset:16384
  ds_read_b64_tr_b16 a[66:67], v68 offset:16896
  ds_read_b64_tr_b16 a[68:69], v70 offset:16384
  ds_read_b64_tr_b16 a[70:71], v70 offset:16896
  ds_read_b64_tr_b16 a[72:73], v68 offset:16416
  ds_read_b64_tr_b16 a[74:75], v68 offset:16928
  ds_read_b64_tr_b16 a[76:77], v70 offset:16416
  ds_read_b64_tr_b16 a[78:79], v70 offset:16928
  s_waitcnt vmcnt(28) lgkmcnt(0)
  s_barrier
  s_add_u32 m0, s70, 16384
  s_add_u32 s71, s75, 0
  buffer_load_dwordx4 v65, s[52:55], s71 offen lds
  s_add_u32 m0, s70, 17408
  s_add_u32 s71, s75, 16384
  buffer_load_dwordx4 v65, s[52:55], s71 offen lds
  s_add_u32 m0, s70, 18432
  s_add_u32 s71, s75, 32768
  buffer_load_dwordx4 v65, s[52:55], s71 offen lds
  s_add_u32 m0, s70, 19456
  s_add_u32 s71, s75, 49152
  buffer_load_dwordx4 v65, s[52:55], s71 offen lds
  ds_read_b64_tr_b16 a[80:81], v68 offset:20480
  ds_read_b64_tr_b16 a[82:83], v68 offset:20992
  ds_read_b64_tr_b16 a[84:85], v70 offset:20480
  ds_read_b64_tr_b16 a[86:87], v70 offset:20992
  ds_read_b64_tr_b16 a[88:89], v68 offset:20512
  ds_read_b64_tr_b16 a[90:91], v68 offset:21024
  ds_read_b64_tr_b16 a[92:93], v70 offset:20512
  ds_read_b64_tr_b16 a[94:95], v70 offset:21024
  s_waitcnt vmcnt(28) lgkmcnt(0)
  s_barrier
  s_add_u32 m0, s70, 20480
  s_add_u32 s71, s75, 262144
  buffer_load_dwordx4 v65, s[52:55], s71 offen lds
  s_add_u32 m0, s70, 21504
  s_add_u32 s71, s75, 278528
  buffer_load_dwordx4 v65, s[52:55], s71 offen lds
  s_add_u32 m0, s70, 22528
  s_add_u32 s71, s75, 294912
  buffer_load_dwordx4 v65, s[52:55], s71 offen lds
  s_add_u32 m0, s70, 23552
  s_add_u32 s71, s75, 311296
  buffer_load_dwordx4 v65, s[52:55], s71 offen lds
  ds_read_b64_tr_b16 a[96:97], v68 offset:24576
  ds_read_b64_tr_b16 a[98:99], v68 offset:25088
  ds_read_b64_tr_b16 a[100:101], v70 offset:24576
  ds_read_b64_tr_b16 a[102:103], v70 offset:25088
  ds_read_b64_tr_b16 a[104:105], v68 offset:24608
  ds_read_b64_tr_b16 a[106:107], v68 offset:25120
  ds_read_b64_tr_b16 a[108:109], v70 offset:24608
  ds_read_b64_tr_b16 a[110:111], v70 offset:25120
  s_waitcnt vmcnt(28) lgkmcnt(0)
  s_barrier
  s_add_u32 m0, s70, 24576
  s_add_u32 s71, s75, 524288
  buffer_load_dwordx4 v65, s[52:55], s71 offen lds
  s_add_u32 m0, s70, 25600
  s_add_u32 s71, s75, 540672
  buffer_load_dwordx4 v65, s[52:55], s71 offen lds
  s_add_u32 m0, s70, 26624
  s_add_u32 s71, s75, 557056
  buffer_load_dwordx4 v65, s[52:55], s71 offen lds
  s_add_u32 m0, s70, 27648
  s_add_u32 s71, s75, 573440
  buffer_load_dwordx4 v65, s[52:55], s71 offen lds
  ds_read_b64_tr_b16 a[112:113], v68 offset:28672
  ds_read_b64_tr_b16 a[114:115], v68 offset:29184
  ds_read_b64_tr_b16 a[116:117], v70 offset:28672
  ds_read_b64_tr_b16 a[118:119], v70 offset:29184
  ds_read_b64_tr_b16 a[120:121], v68 offset:28704
  ds_read_b64_tr_b16 a[122:123], v68 offset:29216
  ds_read_b64_tr_b16 a[124:125], v70 offset:28704
  ds_read_b64_tr_b16 a[126:127], v70 offset:29216
  s_waitcnt vmcnt(28) lgkmcnt(0)
  s_barrier
  s_add_u32 m0, s70, 28672
  s_add_u32 s71, s75, 786432
  buffer_load_dwordx4 v65, s[52:55], s71 offen lds
  s_add_u32 m0, s70, 29696
  s_add_u32 s71, s75, 802816
  buffer_load_dwordx4 v65, s[52:55], s71 offen lds
  s_add_u32 m0, s70, 30720
  s_add_u32 s71, s75, 819200
  buffer_load_dwordx4 v65, s[52:55], s71 offen lds
  s_add_u32 m0, s70, 31744
  s_add_u32 s71, s75, 835584
  buffer_load_dwordx4 v65, s[52:55], s71 offen lds
  ds_read_b64_tr_b16 a[128:129], v68 offset:32768
  ds_read_b64_tr_b16 a[130:131], v68 offset:33280
  ds_read_b64_tr_b16 a[132:133], v70 offset:32768
  ds_read_b64_tr_b16 a[134:135], v70 offset:33280
  ds_read_b64_tr_b16 a[136:137], v68 offset:32800
  ds_read_b64_tr_b16 a[138:139], v68 offset:33312
  ds_read_b64_tr_b16 a[140:141], v70 offset:32800
  ds_read_b64_tr_b16 a[142:143], v70 offset:33312
  s_waitcnt vmcnt(28) lgkmcnt(0)
  s_barrier
  s_add_u32 m0, s70, 32768
  s_add_u32 s71, s75, 2097152
  buffer_load_dwordx4 v65, s[52:55], s71 offen lds
  s_add_u32 m0, s70, 33792
  s_add_u32 s71, s75, 2113536
  buffer_load_dwordx4 v65, s[52:55], s71 offen lds
  s_add_u32 m0, s70, 34816
  s_add_u32 s71, s75, 2129920
  buffer_load_dwordx4 v65, s[52:55], s71 offen lds
  s_add_u32 m0, s70, 35840
  s_add_u32 s71, s75, 2146304
  buffer_load_dwordx4 v65, s[52:55], s71 offen lds
  ds_read_b64_tr_b16 a[144:145], v68 offset:0
  ds_read_b64_tr_b16 a[146:147], v68 offset:512
  ds_read_b64_tr_b16 a[148:149], v70 offset:0
  ds_read_b64_tr_b16 a[150:151], v70 offset:512
  ds_read_b64_tr_b16 a[152:153], v68 offset:32
  ds_read_b64_tr_b16 a[154:155], v68 offset:544
  ds_read_b64_tr_b16 a[156:157], v70 offset:32
  ds_read_b64_tr_b16 a[158:159], v70 offset:544
  s_waitcnt vmcnt(28) lgkmcnt(0)
  s_barrier
  s_add_u32 m0, s70, 0
  s_add_u32 s71, s75, 2359296
  buffer_load_dwordx4 v65, s[52:55], s71 offen lds
  s_add_u32 m0, s70, 1024
  s_add_u32 s71, s75, 2375680
  buffer_load_dwordx4 v65, s[52:55], s71 offen lds
  s_add_u32 m0, s70, 2048
  s_add_u32 s71, s75, 2392064
  buffer_load_dwordx4 v65, s[52:55], s71 offen lds
  s_add_u32 m0, s70, 3072
  s_add_u32 s71, s75, 2408448
  buffer_load_dwordx4 v65, s[52:55], s71 offen lds
  ds_read_b64_tr_b16 a[160:161], v68 offset:4096
  ds_read_b64_tr_b16 a[162:163], v68 offset:4608
  ds_read_b64_tr_b16 a[164:165], v70 offset:4096
  ds_read_b64_tr_b16 a[166:167], v70 offset:4608
  ds_read_b64_tr_b16 a[168:169], v68 offset:4128
  ds_read_b64_tr_b16 a[170:171], v68 offset:4640
  ds_read_b64_tr_b16 a[172:173], v70 offset:4128
  ds_read_b64_tr_b16 a[174:175], v70 offset:4640
  s_waitcnt vmcnt(28) lgkmcnt(0)
  s_barrier
  s_cmp_eq_u32 s90, 0
  s_cbranch_scc1 AI_2
  v_mov_b32 v61, 1
  s_mov_b64 exec, 1
  buffer_atomic_add v61, v64, s[40:43], 0 offen offset:12
  s_mov_b64 exec, -1
AI_2:
  s_add_u32 m0, s70, 4096
  s_add_u32 s71, s75, 2621440
  buffer_load_dwordx4 v65, s[52:55], s71 offen lds
  s_add_u32 m0, s70, 5120
  s_add_u32 s71, s75, 2637824
  buffer_load_dwordx4 v65, s[52:55], s71 offen lds
  s_add_u32 m0, s70, 6144
  s_add_u32 s71, s75, 2654208
  buffer_load_dwordx4 v65, s[52:55], s71 offen lds
  s_add_u32 m0, s70, 7168
  s_add_u32 s71, s75, 2670592
  buffer_load_dwordx4 v65, s[52:55], s71 offen lds
  ds_read_b64_tr_b16 a[176:177], v68 offset:8192
  ds_read_b64_tr_b16 a[178:179], v68 offset:8704
  ds_read_b64_tr_b16 a[180:181], v70 offset:8192
  ds_read_b64_tr_b16 a[182:183], v70 offset:8704
  ds_read_b64_tr_b16 a[184:185], v68 offset:8224
  ds_read_b64_tr_b16 a[186:187], v68 offset:8736
  ds_read_b64_tr_b16 a[188:189], v70 offset:8224
  ds_read_b64_tr_b16 a[190:191], v70 offset:8736
  s_waitcnt vmcnt(28) lgkmcnt(0)
  s_barrier
  s_add_u32 m0, s70, 8192
  s_add_u32 s71, s75, 2883584
  buffer_load_dwordx4 v65, s[52:55], s71 offen lds
  s_add_u32 m0, s70, 9216
  s_add_u32 s71, s75, 2899968
  buffer_load_dwordx4 v65, s[52:55], s71 offen lds
  s_add_u32 m0, s70, 10240
  s_add_u32 s71, s75, 2916352
  buffer_load_dwordx4 v65, s[52:55], s71 offen lds
  s_add_u32 m0, s70, 11264
  s_add_u32 s71, s75, 2932736
  buffer_load_dwordx4 v65, s[52:55], s71 offen lds
  ds_read_b64_tr_b16 a[192:193], v68 offset:12288
  ds_read_b64_tr_b16 a[194:195], v68 offset:12800
  ds_read_b64_tr_b16 a[196:197], v70 offset:12288
  ds_read_b64_tr_b16 a[198:199], v70 offset:12800
  ds_read_b64_tr_b16 a[200:201], v68 offset:12320
  ds_read_b64_tr_b16 a[202:203], v68 offset:12832
  ds_read_b64_tr_b16 a[204:205], v70 offset:12320
  ds_read_b64_tr_b16 a[206:207], v70 offset:12832
  s_waitcnt vmcnt(28) lgkmcnt(0)
  s_barrier
  s_add_u32 m0, s70, 12288
  s_add_u32 s71, s79, 4194304
  buffer_load_dwordx4 v69, s[52:55], s71 offen lds
  s_add_u32 m0, s70, 13312
  s_add_u32 s71, s79, 4259840
  buffer_load_dwordx4 v69, s[52:55], s71 offen lds
  s_add_u32 m0, s70, 14336
  s_add_u32 s71, s79, 4210688
  buffer_load_dwordx4 v69, s[52:55], s71 offen lds
  s_add_u32 m0, s70, 15360
  s_add_u32 s71, s79, 4276224
  buffer_load_dwordx4 v69, s[52:55], s71 offen lds
  ds_read_b64_tr_b16 a[208:209], v68 offset:16384
  ds_read_b64_tr_b16 a[210:211], v68 offset:16896
  ds_read_b64_tr_b16 a[212:213], v70 offset:16384
  ds_read_b64_tr_b16 a[214:215], v70 offset:16896
  ds_read_b64_tr_b16 a[216:217], v68 offset:16416
  ds_read_b64_tr_b16 a[218:219], v68 offset:16928
  ds_read_b64_tr_b16 a[220:221], v70 offset:16416
  ds_read_b64_tr_b16 a[222:223], v70 offset:16928
  s_waitcnt vmcnt(28) lgkmcnt(0)
  s_barrier
  s_add_u32 m0, s70, 16384
  s_add_u32 s71, s80, 73728
  buffer_load_dwordx4 v66, s[56:59], s71 offen lds
  s_add_u32 m0, s70, 17408
  s_add_u32 s71, s80, 110592
  buffer_load_dwordx4 v66, s[56:59], s71 offen lds
  s_add_u32 m0, s70, 18432
  s_add_u32 s71, s80, 92160
  buffer_load_dwordx4 v66, s[56:59], s71 offen lds
  s_add_u32 m0, s70, 19456
  s_add_u32 s71, s80, 129024
  buffer_load_dwordx4 v66, s[56:59], s71 offen lds
  ds_read_b64_tr_b16 a[224:225], v68 offset:20480
  ds_read_b64_tr_b16 a[226:227], v68 offset:20992
  ds_read_b64_tr_b16 a[228:229], v70 offset:20480
  ds_read_b64_tr_b16 a[230:231], v70 offset:20992
  ds_read_b64_tr_b16 a[232:233], v68 offset:20512
  ds_read_b64_tr_b16 a[234:235], v68 offset:21024
  ds_read_b64_tr_b16 a[236:237], v70 offset:20512
  ds_read_b64_tr_b16 a[238:239], v70 offset:21024
  s_waitcnt vmcnt(28) lgkmcnt(0)
  s_barrier
  s_add_u32 m0, s70, 20480
  s_add_u32 s71, s80, 73984
  buffer_load_dwordx4 v66, s[56:59], s71 offen lds
  s_add_u32 m0, s70, 21504
  s_add_u32 s71, s80, 110848
  buffer_load_dwordx4 v66, s[56:59], s71 offen lds
  s_add_u32 m0, s70, 22528
  s_add_u32 s71, s80, 92416
  buffer_load_dwordx4 v66, s[56:59], s71 offen lds
  s_add_u32 m0, s70, 23552
  s_add_u32 s71, s80, 129280
  buffer_load_dwordx4 v66, s[56:59], s71 offen lds
  ds_read_b64_tr_b16 a[240:241], v68 offset:24576
  ds_read_b64_tr_b16 a[242:243], v68 offset:25088
  ds_read_b64_tr_b16 a[244:245], v70 offset:24576
  ds_read_b64_tr_b16 a[246:247], v70 offset:25088
  ds_read_b64_tr_b16 a[248:249], v68 offset:24608
  ds_read_b64_tr_b16 a[250:251], v68 offset:25120
  ds_read_b64_tr_b16 a[252:253], v70 offset:24608
  ds_read_b64_tr_b16 a[254:255], v70 offset:25120
  s_waitcnt vmcnt(28) lgkmcnt(0)
  s_barrier
  s_add_u32 m0, s70, 24576
  s_add_u32 s71, s80, 74240
  buffer_load_dwordx4 v66, s[56:59], s71 offen lds
  s_add_u32 m0, s70, 25600
  s_add_u32 s71, s80, 111104
  buffer_load_dwordx4 v66, s[56:59], s71 offen lds
  s_add_u32 m0, s70, 26624
  s_add_u32 s71, s80, 92672
  buffer_load_dwordx4 v66, s[56:59], s71 offen lds
  s_add_u32 m0, s70, 27648
  s_add_u32 s71, s80, 129536
  buffer_load_dwordx4 v66, s[56:59], s71 offen lds
  ds_read_b64_tr_b16 v[80:81], v68 offset:28672
  ds_read_b64_tr_b16 v[82:83], v68 offset:29184
  ds_read_b64_tr_b16 v[84:85], v70 offset:28672
  ds_read_b64_tr_b16 v[86:87], v70 offset:29184
  ds_read_b64_tr_b16 v[88:89], v68 offset:28704
  ds_read_b64_tr_b16 v[90:91], v68 offset:29216
  ds_read_b64_tr_b16 v[92:93], v70 offset:28704
  ds_read_b64_tr_b16 v[94:95], v70 offset:29216
  s_waitcnt vmcnt(28) lgkmcnt(0)
  s_barrier
  s_add_u32 m0, s70, 28672
  s_add_u32 s71, s80, 74496
  buffer_load_dwordx4 v66, s[56:59], s71 offen lds
  s_add_u32 m0, s70, 29696
  s_add_u32 s71, s80, 111360
  buffer_load_dwordx4 v66, s[56:59], s71 offen lds
  s_add_u32 m0, s70, 30720
  s_add_u32 s71, s80, 92928
  buffer_load_dwordx4 v66, s[56:59], s71 offen lds
  s_add_u32 m0, s70, 31744
  s_add_u32 s71, s80, 129792
  buffer_load_dwordx4 v66, s[56:59], s71 offen lds
  ds_read_b64_tr_b16 v[96:97], v68 offset:32768
  ds_read_b64_tr_b16 v[98:99], v68 offset:33280
  ds_read_b64_tr_b16 v[100:101], v70 offset:32768
  ds_read_b64_tr_b16 v[102:103], v70 offset:33280
  ds_read_b64_tr_b16 v[104:105], v68 offset:32800
  ds_read_b64_tr_b16 v[106:107], v68 offset:33312
  ds_read_b64_tr_b16 v[108:109], v70 offset:32800
  ds_read_b64_tr_b16 v[110:111], v70 offset:33312
  s_waitcnt vmcnt(28) lgkmcnt(0)
  s_barrier
  s_add_u32 m0, s70, 32768
  s_add_u32 s71, s80, 1024
  buffer_load_dwordx4 v67, s[56:59], s71 offen lds
  s_add_u32 m0, s70, 33792
  s_add_u32 s71, s80, 37888
  buffer_load_dwordx4 v67, s[56:59], s71 offen lds
  s_add_u32 m0, s70, 34816
  s_add_u32 s71, s80, 19456
  buffer_load_dwordx4 v67, s[56:59], s71 offen lds
  s_add_u32 m0, s70, 35840
  s_add_u32 s71, s80, 56320
  buffer_load_dwordx4 v67, s[56:59], s71 offen lds
  ds_read_b64_tr_b16 v[112:113], v68 offset:0
  ds_read_b64_tr_b16 v[114:115], v68 offset:512
  ds_read_b64_tr_b16 v[116:117], v70 offset:0
  ds_read_b64_tr_b16 v[118:119], v70 offset:512
  ds_read_b64_tr_b16 v[120:121], v68 offset:32
  ds_read_b64_tr_b16 v[122:123], v68 offset:544
  ds_read_b64_tr_b16 v[124:125], v70 offset:32
  ds_read_b64_tr_b16 v[126:127], v70 offset:544
  s_waitcnt vmcnt(28) lgkmcnt(0)
  s_barrier
  s_add_u32 m0, s70, 0
  s_add_u32 s71, s75, 0
  buffer_load_dwordx4 v65, s[44:47], s71 offen lds
  s_add_u32 m0, s70, 1024
  s_add_u32 s71, s75, 16384
  buffer_load_dwordx4 v65, s[44:47], s71 offen lds
  s_add_u32 m0, s70, 2048
  s_add_u32 s71, s75, 32768
  buffer_load_dwordx4 v65, s[44:47], s71 offen lds
  s_add_u32 m0, s70, 3072
  s_add_u32 s71, s75, 49152
  buffer_load_dwordx4 v65, s[44:47], s71 offen lds
  ds_read_b64_tr_b16 v[128:129], v68 offset:4096
  ds_read_b64_tr_b16 v[130:131], v68 offset:4608
  ds_read_b64_tr_b16 v[132:133], v70 offset:4096
  ds_read_b64_tr_b16 v[134:135], v70 offset:4608
  ds_read_b64_tr_b16 v[136:137], v68 offset:4128
  ds_read_b64_tr_b16 v[138:139], v68 offset:4640
  ds_read_b64_tr_b16 v[140:141], v70 offset:4128
  ds_read_b64_tr_b16 v[142:143], v70 offset:4640
  s_waitcnt vmcnt(28) lgkmcnt(0)
  s_barrier
  s_add_u32 m0, s70, 4096
  s_add_u32 s71, s75, 262144
  buffer_load_dwordx4 v65, s[44:47], s71 offen lds
  s_add_u32 m0, s70, 5120
  s_add_u32 s71, s75, 278528
  buffer_load_dwordx4 v65, s[44:47], s71 offen lds
  s_add_u32 m0, s70, 6144
  s_add_u32 s71, s75, 294912
  buffer_load_dwordx4 v65, s[44:47], s71 offen lds
  s_add_u32 m0, s70, 7168
  s_add_u32 s71, s75, 311296
  buffer_load_dwordx4 v65, s[44:47], s71 offen lds
  ds_read_b64_tr_b16 v[144:145], v68 offset:8192
  ds_read_b64_tr_b16 v[146:147], v68 offset:8704
  ds_read_b64_tr_b16 v[148:149], v70 offset:8192
  ds_read_b64_tr_b16 v[150:151], v70 offset:8704
  ds_read_b64_tr_b16 v[152:153], v68 offset:8224
  ds_read_b64_tr_b16 v[154:155], v68 offset:8736
  ds_read_b64_tr_b16 v[156:157], v70 offset:8224
  ds_read_b64_tr_b16 v[158:159], v70 offset:8736
  s_waitcnt vmcnt(28) lgkmcnt(0)
  s_barrier
  s_add_u32 m0, s70, 8192
  s_add_u32 s71, s75, 524288
  buffer_load_dwordx4 v65, s[44:47], s71 offen lds
  s_add_u32 m0, s70, 9216
  s_add_u32 s71, s75, 540672
  buffer_load_dwordx4 v65, s[44:47], s71 offen lds
  s_add_u32 m0, s70, 10240
  s_add_u32 s71, s75, 557056
  buffer_load_dwordx4 v65, s[44:47], s71 offen lds
  s_add_u32 m0, s70, 11264
  s_add_u32 s71, s75, 573440
  buffer_load_dwordx4 v65, s[44:47], s71 offen lds
  ds_read_b64_tr_b16 v[160:161], v68 offset:12288
  ds_read_b64_tr_b16 v[162:163], v68 offset:12800
  ds_read_b64_tr_b16 v[164:165], v70 offset:12288
  ds_read_b64_tr_b16 v[166:167], v70 offset:12800
  ds_read_b64_tr_b16 v[168:169], v68 offset:12320
  ds_read_b64_tr_b16 v[170:171], v68 offset:12832
  ds_read_b64_tr_b16 v[172:173], v70 offset:12320
  ds_read_b64_tr_b16 v[174:175], v70 offset:12832
  s_waitcnt vmcnt(28) lgkmcnt(0)
  s_barrier
  s_add_u32 m0, s70, 12288
  s_add_u32 s71, s75, 786432
  buffer_load_dwordx4 v65, s[44:47], s71 offen lds
  s_add_u32 m0, s70, 13312
  s_add_u32 s71, s75, 802816
  buffer_load_dwordx4 v65, s[44:47], s71 offen lds
  s_add_u32 m0, s70, 14336
  s_add_u32 s71, s75, 819200
  buffer_load_dwordx4 v65, s[44:47], s71 offen lds
  s_add_u32 m0, s70, 15360
  s_add_u32 s71, s75, 835584
  buffer_load_dwordx4 v65, s[44:47], s71 offen lds
  ds_read_b64_tr_b16 v[176:177], v68 offset:16384
  ds_read_b64_tr_b16 v[178:179], v68 offset:16896
  ds_read_b64_tr_b16 v[180:181], v70 offset:16384
  ds_read_b64_tr_b16 v[182:183], v70 offset:16896
  ds_read_b64_tr_b16 v[184:185], v68 offset:16416
  ds_read_b64_tr_b16 v[186:187], v68 offset:16928
  ds_read_b64_tr_b16 v[188:189], v70 offset:16416
  ds_read_b64_tr_b16 v[190:191], v70 offset:16928
  s_waitcnt vmcnt(28) lgkmcnt(0)
  s_barrier
  s_add_u32 m0, s70, 16384
  s_add_u32 s71, s79, 4194304
  buffer_load_dwordx4 v69, s[44:47], s71 offen lds
  s_add_u32 m0, s70, 17408
  s_add_u32 s71, s79, 4259840
  buffer_load_dwordx4 v69, s[44:47], s71 offen lds
  s_add_u32 m0, s70, 18432
  s_add_u32 s71, s79, 4210688
  buffer_load_dwordx4 v69, s[44:47], s71 offen lds
  s_add_u32 m0, s70, 19456
  s_add_u32 s71, s79, 4276224
  buffer_load_dwordx4 v69, s[44:47], s71 offen lds
  ds_read_b64_tr_b16 v[192:193], v68 offset:20480
  ds_read_b64_tr_b16 v[194:195], v68 offset:20992
  ds_read_b64_tr_b16 v[196:197], v70 offset:20480
  ds_read_b64_tr_b16 v[198:199], v70 offset:20992
  ds_read_b64_tr_b16 v[200:201], v68 offset:20512
  ds_read_b64_tr_b16 v[202:203], v68 offset:21024
  ds_read_b64_tr_b16 v[204:205], v70 offset:20512
  ds_read_b64_tr_b16 v[206:207], v70 offset:21024
  s_waitcnt vmcnt(28) lgkmcnt(0)
  s_barrier
  s_add_u32 m0, s70, 20480
  s_add_u32 s71, s80, 0
  buffer_load_dwordx4 v66, s[56:59], s71 offen lds
  s_add_u32 m0, s70, 21504
  s_add_u32 s71, s80, 36864
  buffer_load_dwordx4 v66, s[56:59], s71 offen lds
  s_add_u32 m0, s70, 22528
  s_add_u32 s71, s80, 18432
  buffer_load_dwordx4 v66, s[56:59], s71 offen lds
  s_add_u32 m0, s70, 23552
  s_add_u32 s71, s80, 55296
  buffer_load_dwordx4 v66, s[56:59], s71 offen lds
  ds_read_b64_tr_b16 v[208:209], v68 offset:24576
  ds_read_b64_tr_b16 v[210:211], v68 offset:25088
  ds_read_b64_tr_b16 v[212:213], v70 offset:24576
  ds_read_b64_tr_b16 v[214:215], v70 offset:25088
  ds_read_b64_tr_b16 v[216:217], v68 offset:24608
  ds_read_b64_tr_b16 v[218:219], v68 offset:25120
  ds_read_b64_tr_b16 v[220:221], v70 offset:24608
  ds_read_b64_tr_b16 v[222:223], v70 offset:25120
  s_waitcnt vmcnt(28) lgkmcnt(0)
  s_barrier
  s_add_u32 m0, s70, 24576
  s_add_u32 s71, s80, 256
  buffer_load_dwordx4 v66, s[56:59], s71 offen lds
  s_add_u32 m0, s70, 25600
  s_add_u32 s71, s80, 37120
  buffer_load_dwordx4 v66, s[56:59], s71 offen lds
  s_add_u32 m0, s70, 26624
  s_add_u32 s71, s80, 18688
  buffer_load_dwordx4 v66, s[56:59], s71 offen lds
  s_add_u32 m0, s70, 27648
  s_add_u32 s71, s80, 55552
  buffer_load_dwordx4 v66, s[56:59], s71 offen lds
  ds_read_b64_tr_b16 v[224:225], v68 offset:28672
  ds_read_b64_tr_b16 v[226:227], v68 offset:29184
  ds_read_b64_tr_b16 v[228:229], v70 offset:28672
  ds_read_b64_tr_b16 v[230:231], v70 offset:29184
  ds_read_b64_tr_b16 v[232:233], v68 offset:28704
  ds_read_b64_tr_b16 v[234:235], v68 offset:29216
  ds_read_b64_tr_b16 v[236:237], v70 offset:28704
  ds_read_b64_tr_b16 v[238:239], v70 offset:29216
  s_waitcnt vmcnt(28) lgkmcnt(0)
  s_barrier
  s_add_u32 m0, s70, 28672
  s_add_u32 s71, s80, 512
  buffer_load_dwordx4 v66, s[56:59], s71 offen lds
  s_add_u32 m0, s70, 29696
  s_add_u32 s71, s80, 37376
  buffer_load_dwordx4 v66, s[56:59], s71 offen lds
  s_add_u32 m0, s70, 30720
  s_add_u32 s71, s80, 18944
  buffer_load_dwordx4 v66, s[56:59], s71 offen lds
  s_add_u32 m0, s70, 31744
  s_add_u32 s71, s80, 55808
  buffer_load_dwordx4 v66, s[56:59], s71 offen lds
  ds_read_b64_tr_b16 v[240:241], v71 offset:32768
  ds_read_b64_tr_b16 v[242:243], v71 offset:33280
  ds_read_b64_tr_b16 v[244:245], v72 offset:32768
  ds_read_b64_tr_b16 v[246:247], v72 offset:33280
  ds_read_b64_tr_b16 v[248:249], v71 offset:32896
  ds_read_b64_tr_b16 v[250:251], v71 offset:33408
  ds_read_b64_tr_b16 v[252:253], v72 offset:32896
  ds_read_b64_tr_b16 v[254:255], v72 offset:33408
  s_waitcnt vmcnt(28) lgkmcnt(0)
  s_barrier
  s_add_u32 m0, s70, 32768
  s_add_u32 s71, s80, 768
  buffer_load_dwordx4 v66, s[56:59], s71 offen lds
  s_add_u32 m0, s70, 33792
  s_add_u32 s71, s80, 37632
  buffer_load_dwordx4 v66, s[56:59], s71 offen lds
  s_add_u32 m0, s70, 34816
  s_add_u32 s71, s80, 19200
  buffer_load_dwordx4 v66, s[56:59], s71 offen lds
  s_add_u32 m0, s70, 35840
  s_add_u32 s71, s80, 56064
  buffer_load_dwordx4 v66, s[56:59], s71 offen lds
  ds_read_b64_tr_b16 v[16:17], v68 offset:0
  ds_read_b64_tr_b16 v[18:19], v68 offset:512
  ds_read_b64_tr_b16 v[20:21], v70 offset:0
  ds_read_b64_tr_b16 v[22:23], v70 offset:512
  ds_read_b64_tr_b16 v[24:25], v68 offset:32
  ds_read_b64_tr_b16 v[26:27], v68 offset:544
  ds_read_b64_tr_b16 v[28:29], v70 offset:32
  ds_read_b64_tr_b16 v[30:31], v70 offset:544
  s_waitcnt vmcnt(28) lgkmcnt(0)
  s_barrier
  ds_write_b128 v4, v[16:19] offset:0
  ds_write_b128 v4, v[20:23] offset:1024
  ds_write_b128 v4, v[24:27] offset:2048
  ds_write_b128 v4, v[28:31] offset:3072
  ds_read_b64_tr_b16 v[32:33], v68 offset:4096
  ds_read_b64_tr_b16 v[34:35], v68 offset:4608
  ds_read_b64_tr_b16 v[36:37], v70 offset:4096
  ds_read_b64_tr_b16 v[38:39], v70 offset:4608
  ds_read_b64_tr_b16 v[40:41], v68 offset:4128
  ds_read_b64_tr_b16 v[42:43], v68 offset:4640
  ds_read_b64_tr_b16 v[44:45], v70 offset:4128
  ds_read_b64_tr_b16 v[46:47], v70 offset:4640
  s_waitcnt vmcnt(24) lgkmcnt(0)
  s_barrier
  ds_write_b128 v4, v[32:35] offset:4096
  ds_write_b128 v4, v[36:39] offset:5120
  ds_write_b128 v4, v[40:43] offset:6144
  ds_write_b128 v4, v[44:47] offset:7168
  ds_read_b64_tr_b16 v[16:17], v68 offset:8192
  ds_read_b64_tr_b16 v[18:19], v68 offset:8704
  ds_read_b64_tr_b16 v[20:21], v70 offset:8192
  ds_read_b64_tr_b16 v[22:23], v70 offset:8704
  ds_read_b64_tr_b16 v[24:25], v68 offset:8224
  ds_read_b64_tr_b16 v[26:27], v68 offset:8736
  ds_read_b64_tr_b16 v[28:29], v70 offset:8224
  ds_read_b64_tr_b16 v[30:31], v70 offset:8736
  s_waitcnt vmcnt(20) lgkmcnt(0)
  s_barrier
  s_cmp_lg_u32 s64, 0
  s_cbranch_scc1 AI_3
  v_mov_b32 v61, 1
  s_mov_b64 exec, 1
  buffer_atomic_add v61, v64, s[40:43], 0 offen offset:208
  s_mov_b64 exec, -1
AI_3:
  ds_write_b128 v4, v[16:19] offset:8192
  ds_write_b128 v4, v[20:23] offset:9216
  ds_write_b128 v4, v[24:27] offset:10240
  ds_write_b128 v4, v[28:31] offset:11264
  ds_read_b64_tr_b16 v[32:33], v68 offset:12288
  ds_read_b64_tr_b16 v[34:35], v68 offset:12800
  ds_read_b64_tr_b16 v[36:37], v70 offset:12288
  ds_read_b64_tr_b16 v[38:39], v70 offset:12800
  ds_read_b64_tr_b16 v[40:41], v68 offset:12320
  ds_read_b64_tr_b16 v[42:43], v68 offset:12832
  ds_read_b64_tr_b16 v[44:45], v70 offset:12320
  ds_read_b64_tr_b16 v[46:47], v70 offset:12832
  s_waitcnt vmcnt(16) lgkmcnt(0)
  s_barrier
  s_getpc_b64 s[60:61]
PC_4:
  s_add_u32 s60, s60, L_T_LOADED-PC_4
  s_addc_u32 s61, s61, 0
  s_and_b32 s61, s61, 0xffff
  s_mov_b32 s62, L_T_TO1-L_T_LOADED
  s_mov_b32 s63, 0x20000
  v_lshlrev_b32_e64 v62, 7, v60
  s_mul_i32 s97, s64, 8192
  buffer_load_dword v63, v62, s[60:63], s97 offen
  ds_write_b128 v4, v[32:35] offset:12288
  ds_write_b128 v4, v[36:39] offset:13312
  ds_write_b128 v4, v[40:43] offset:14336
  ds_write_b128 v4, v[44:47] offset:15360
  ds_read_b64_tr_b16 v[16:17], v68 offset:16384
  ds_read_b64_tr_b16 v[18:19], v68 offset:16896
  ds_read_b64_tr_b16 v[20:21], v70 offset:16384
  ds_read_b64_tr_b16 v[22:23], v70 offset:16896
  ds_read_b64_tr_b16 v[24:25], v68 offset:16416
  ds_read_b64_tr_b16 v[26:27], v68 offset:16928
  ds_read_b64_tr_b16 v[28:29], v70 offset:16416
  ds_read_b64_tr_b16 v[30:31], v70 offset:16928
  s_waitcnt vmcnt(12) lgkmcnt(0)
  s_barrier
  ds_write_b128 v4, v[16:19] offset:16384
  ds_write_b128 v4, v[20:23] offset:17408
  ds_write_b128 v4, v[24:27] offset:18432
  ds_write_b128 v4, v[28:31] offset:19456
  ds_read_b64_tr_b16 v[32:33], v68 offset:20480
  ds_read_b64_tr_b16 v[34:35], v68 offset:20992
  ds_read_b64_tr_b16 v[36:37], v70 offset:20480
  ds_read_b64_tr_b16 v[38:39], v70 offset:20992
  ds_read_b64_tr_b16 v[40:41], v68 offset:20512
  ds_read_b64_tr_b16 v[42:43], v68 offset:21024
  ds_read_b64_tr_b16 v[44:45], v70 offset:20512
  ds_read_b64_tr_b16 v[46:47], v70 offset:21024
  s_waitcnt vmcnt(8) lgkmcnt(0)
  s_barrier
  ds_write_b128 v4, v[32:35] offset:20480
  ds_write_b128 v4, v[36:39] offset:21504
  ds_write_b128 v4, v[40:43] offset:22528
  ds_write_b128 v4, v[44:47] offset:23552
  ds_read_b64_tr_b16 v[16:17], v68 offset:24576
  ds_read_b64_tr_b16 v[18:19], v68 offset:25088
  ds_read_b64_tr_b16 v[20:21], v70 offset:24576
  ds_read_b64_tr_b16 v[22:23], v70 offset:25088
  ds_read_b64_tr_b16 v[24:25], v68 offset:24608
  ds_read_b64_tr_b16 v[26:27], v68 offset:25120
  ds_read_b64_tr_b16 v[28:29], v70 offset:24608
  ds_read_b64_tr_b16 v[30:31], v70 offset:25120
  s_waitcnt vmcnt(4) lgkmcnt(0)
  s_barrier
  ds_write_b128 v4, v[16:19] offset:24576
  ds_write_b128 v4, v[20:23] offset:25600
  ds_write_b128 v4, v[24:27] offset:26624
  ds_write_b128 v4, v[28:31] offset:27648
  ds_read_b64_tr_b16 v[32:33], v68 offset:28672
  ds_read_b64_tr_b16 v[34:35], v68 offset:29184
  ds_read_b64_tr_b16 v[36:37], v70 offset:28672
  ds_read_b64_tr_b16 v[38:39], v70 offset:29184
  ds_read_b64_tr_b16 v[40:41], v68 offset:28704
  ds_read_b64_tr_b16 v[42:43], v68 offset:29216
  ds_read_b64_tr_b16 v[44:45], v70 offset:28704
  ds_read_b64_tr_b16 v[46:47], v70 offset:29216
  s_waitcnt vmcnt(0) lgkmcnt(0)
  s_barrier
  ds_write_b128 v4, v[32:35] offset:28672
  ds_write_b128 v4, v[36:39] offset:29696
  ds_write_b128 v4, v[40:43] offset:30720
  ds_write_b128 v4, v[44:47] offset:31744
  ds_read_b64_tr_b16 v[16:17], v68 offset:32768
  ds_read_b64_tr_b16 v[18:19], v68 offset:33280
  ds_read_b64_tr_b16 v[20:21], v70 offset:32768
  ds_read_b64_tr_b16 v[22:23], v70 offset:33280
  ds_read_b64_tr_b16 v[24:25], v68 offset:32800
  ds_read_b64_tr_b16 v[26:27], v68 offset:33312
  ds_read_b64_tr_b16 v[28:29], v70 offset:32800
  ds_read_b64_tr_b16 v[30:31], v70 offset:33312
  s_waitcnt lgkmcnt(0)
  s_barrier
  ds_write_b128 v4, v[16:19] offset:32768
  ds_write_b128 v4, v[20:23] offset:33792
  ds_write_b128 v4, v[24:27] offset:34816
  ds_write_b128 v4, v[28:31] offset:35840
L_T_LOADED:
  v_bfe_u32 v61, v60, 1, 1
  v_mul_u32_u24 v61, 0xAAAA, v61
  v_add_u32 v0, 0x4444, v61
  s_lshl_b32 s71, s64, 9
  v_bfe_u32 v61, v60, 4, 2
  v_lshlrev_b32 v3, 7, v61
  v_bfe_u32 v61, v60, 0, 3
  v_lshl_add_u32 v3, v61, 4, v3
  v_bfe_u32 v61, v60, 2, 2
  v_lshlrev_b32_e64 v7, 7, v61
  v_bfe_u32 v61, v60, 4, 2
  v_lshl_add_u32 v7, v61, 5, v7
  v_bfe_u32 v61, v60, 0, 2
  v_lshl_add_u32 v7, v61, 2, v7
  v_add_u32 v7, s71, v7
  v_add_u32 v7, 9216, v7
  v_bfe_u32 v61, v60, 3, 1
  v_lshlrev_b32 v8, 8, v61
  v_bfe_u32 v61, v60, 0, 1
  v_lshl_add_u32 v8, v61, 7, v8
  v_bfe_u32 v61, v60, 4, 2
  v_lshl_add_u32 v8, v61, 5, v8
  v_bfe_u32 v61, v60, 1, 2
  v_lshl_add_u32 v8, v61, 2, v8
  v_add_u32 v8, s71, v8
  v_add_u32 v8, 11264, v8
  v_bfe_u32 v61, v60, 4, 2
  v_lshlrev_b32 v62, 0, v61
  v_mul_u32_u24 v9, 288, v62
  v_bfe_u32 v61, v60, 0, 3
  v_lshl_add_u32 v9, v61, 2, v9
  s_lshl_b32 s71, s64, 5
  s_add_u32 s71, s71, 13312
  v_add_u32 v9, s71, v9
  v_bfe_u32 v61, v60, 0, 3
  v_lshlrev_b32_e64 v62, 0, v61
  v_mul_u32_u24 v10, 144, v62
  v_bfe_u32 v61, v60, 4, 2
  v_lshl_add_u32 v10, v61, 5, v10
  v_bfe_u32 v61, v60, 3, 1
  v_lshl_add_u32 v10, v61, 4, v10
  v_bfe_u32 v61, v60, 3, 1
  v_lshlrev_b32_e64 v11, 12, v61
  v_bfe_u32 v61, v60, 4, 2
  v_lshl_add_u32 v11, v61, 9, v11
  v_bfe_u32 v61, v60, 2, 1
  v_lshl_add_u32 v11, v61, 7, v11
  v_bfe_u32 v61, v60, 0, 2
  v_lshl_add_u32 v11, v61, 4, v11
  v_bfe_u32 v61, v60, 4, 2
  v_lshlrev_b32 v12, 9, v61
  v_bfe_u32 v61, v60, 0, 4
  v_lshl_add_u32 v12, v61, 4, v12
  s_lshl_b32 s71, s64, 11
  s_add_u32 s71, s71, 16777216
  v_add_u32 v12, s71, v12
  v_bfe_u32 v61, v60, 3, 3
  v_lshlrev_b32 v13, 12, v61
  v_bfe_u32 v61, v60, 0, 3
  v_lshl_add_u32 v13, v61, 4, v13
  s_lshl_b32 s71, s64, 15
  v_add_u32 v13, s71, v13
  v_bfe_u32 v61, v60, 5, 1
  v_lshlrev_b32 v14, 12, v61
  v_bfe_u32 v61, v60, 0, 5
  v_lshl_add_u32 v14, v61, 2, v14
  s_lshl_b32 s71, s64, 13
  s_add_u32 s71, s71, 262144
  v_add_u32 v14, s71, v14
  v_bfe_u32 v61, v60, 2, 2
  v_lshlrev_b32 v15, 8, v61
  v_bfe_u32 v61, v60, 4, 2
  v_lshl_add_u32 v15, v61, 6, v15
  v_bfe_u32 v61, v60, 0, 1
  v_lshl_add_u32 v15, v61, 5, v15
  v_bfe_u32 v61, v60, 1, 1
  v_lshl_add_u32 v15, v61, 4, v15
  v_bfe_u32 v61, v60, 2, 1
  v_lshlrev_b32 v61, 4, v61
  v_mov_b32 v62, 0x3f80
  v_lshlrev_b32 v62, v61, v62
  v_and_b32 v61, 1, v60
  v_bfe_u32 v63, v60, 3, 1
  v_lshl_add_u32 v61, v63, 1, v61
  v_cmp_eq_u32 vcc, 0, v61
  s_nop 1
  v_cndmask_b32 v16, 0, v62, vcc
  v_cmp_eq_u32 vcc, 1, v61
  s_nop 1
  v_cndmask_b32 v17, 0, v62, vcc
  v_cmp_eq_u32 vcc, 2, v61
  s_nop 1
  v_cndmask_b32 v18, 0, v62, vcc
  v_cmp_eq_u32 vcc, 3, v61
  s_nop 1
  v_cndmask_b32 v19, 0, v62, vcc
  ds_write_b128 v2, v[16:19] offset:14464
  v_mov_b64 v[20:21], 0
  v_mov_b64_e64 v[22:23], 0
  ds_write_b128 v3, v[20:23] offset:15744
  s_mov_b32 s2, 0xff00ff00
  s_mov_b32 s3, 0xff00ff00
  s_mov_b32 s78, 1040356334
  s_mov_b32 s79, 1040356334
  s_add_u32 s81, s94, 31457280
  s_add_u32 s95, s82, 0x80000
  s_mul_i32 s69, s65, 4294964224
  s_add_u32 s69, s69, 262144
  s_mov_b32 s83, 131072
  s_mov_b32 s84, 140288
  s_mov_b32 s85, 149504
  s_lshl_b32 s86, s65, 13
  s_add_u32 s86, s86, 50331648
  s_lshl_b32 s87, s65, 12
  s_add_u32 s87, s87, 22937600
  s_mov_b32 s92, 1040356334
  s_mov_b32 s73, 0
  s_mov_b32 s72, 32768
WC_5:
  buffer_load_dword v61, v64, s[40:43], 0 offen offset:12 sc1
  s_waitcnt vmcnt(0)
  v_cmp_gt_u32 vcc, 136, v61
  s_cbranch_vccz WCD_6
  s_sleep 2
  s_sub_u32 s72, s72, 1
  s_cmp_lg_u32 s72, 0
  s_cbranch_scc1 WC_5
  s_mov_b32 s68, 1
  s_branch L_ABORT
WCD_6:
  s_cmp_lg_u32 s64, 3
  s_cbranch_scc1 L_T_W0
  s_mov_b64 exec, 0xff
  s_mov_b32 s89, 2
  s_mov_b32 s72, 32768
TF_7:
  buffer_load_dword v5, v2, s[36:39], s94 offen offset:0 sc1
  s_waitcnt vmcnt(0)
  v_cmp_gt_u32 vcc, s89, v5
  s_cbranch_vccz TFD_8
  s_sub_u32 s72, s72, 1
  s_cmp_lg_u32 s72, 0
  s_cbranch_scc1 TF_7
  s_mov_b32 s68, 2
  s_branch L_ABORT
TFD_8:
  v_cmp_gt_u32 vcc, 3, v5
  s_nop 0
  s_cmp_eq_u64 vcc, 0
  s_mov_b32 s76, 262144
  s_cselect_b32 s76, 524288, s76
  s_mov_b64 exec, -1
  v_lshlrev_b32_e64 v6, 3, v2
  s_mov_b32 m0, 15488
  s_add_u32 s71, s86, 0
  s_add_u32 s89, s71, 0
  buffer_load_dword v6, s[36:39], s89 offen sc1 lds
  s_add_u32 s89, s71, 16777216
  buffer_load_dword v6, s[36:39], s89 offen sc1 lds
  v_lshlrev_b32 v6, 3, v2
  s_mov_b32 m0, 15488
  s_add_u32 s71, s86, 262144
  s_add_u32 s89, s71, 0
  buffer_load_dword v6, s[36:39], s89 offen sc1 lds
  s_add_u32 s89, s71, 16777216
  buffer_load_dword v6, s[36:39], s89 offen sc1 lds
  s_waitcnt vmcnt(2)
L_T_W0:
  s_waitcnt lgkmcnt(0)
  s_barrier
  s_cmp_eq_u32 s64, 1
  s_cbranch_scc1 L_T_PRE1
  s_cmp_eq_u32 s64, 2
  s_cbranch_scc1 L_T_PRE2
  s_cmp_eq_u32 s64, 3
  s_cbranch_scc1 L_T_PRE3
L_T_PRE0:
  ds_read_b128 v[36:39], v4 offset:2048
  ds_read_b128 v[40:43], v4 offset:3072
  v_lshrrev_b32 v34, 2, v2
  v_bfe_u32 v6, v2, 9, 1
  v_lshlrev_b32_e64 v33, 7, v6
  v_bfe_u32 v6, v2, 6, 1
  v_lshl_add_u32 v33, v6, 6, v33
  v_bfe_u32 v6, v2, 7, 2
  v_lshl_add_u32 v33, v6, 4, v33
  v_bfe_u32 v6, v2, 4, 2
  v_lshl_add_u32 v33, v6, 2, v33
  v_mov_b64 v[56:57], 0
  v_mov_b64 v[58:59], 0
  v_mov_b64 v[60:61], 0
  v_mov_b64 v[62:63], 0
  ds_read_b128 v[24:27], v4 offset:0
  ds_read_b128 v[28:31], v4 offset:1024
  ds_read_b128 v[72:75], v4 offset:4096
  ds_read_b128 v[76:79], v4 offset:5120
  v_mov_b64 v[64:65], 0
  v_mov_b64 v[66:67], 0
  v_mov_b64 v[68:69], 0
  v_mov_b64 v[70:71], 0
  s_add_u32 s89, s83, 4096
  s_add_u32 s71, s83, 8192
  s_mov_b32 s72, 32768
L_T_LOOP0:
  buffer_load_dwordx4 v[16:19], v15, s[36:39], s83 offen offset:0 sc1
  buffer_load_dwordx4 v[20:23], v15, s[36:39], s89 offen offset:0 sc1
  buffer_load_dword v35, v34, s[36:39], s71 offen offset:0 sc1
  s_sub_u32 s72, s72, 1
  s_cmp_eq_u32 s72, 0
  s_cbranch_scc1 L_T_TO2
  s_waitcnt vmcnt(2) lgkmcnt(0)
  v_cmp_eq_u32 vcc, -1, v16
  ds_write_b128 v2, v[16:19] offset:0
  s_cbranch_vccnz L_T_LOOP0
  v_smfmac_f32_16x16x64_bf16 v[56:59], v[16:19], v[24:31], v0
  v_smfmac_f32_16x16x64_bf16 v[60:63], v[16:19], v[36:43], v0
L_T_CHK2B0:
  s_waitcnt vmcnt(1)
  ds_write_b128 v2, v[20:23] offset:4096
  s_waitcnt vmcnt(0)
  v_max_u32 v6, v20, v35
  v_cmp_eq_u32 vcc, -1, v6
  ds_write_b32 v33, v35 offset:8192
  s_cbranch_vccnz L_T_POLL2B0
  v_smfmac_f32_16x16x64_bf16 v[64:67], v[16:19], a[0:7], v0
  buffer_load_dwordx4 v[44:47], v11, s[36:39], s86 offen offset:0 sc1
  ds_read_b128 v[36:39], v4 offset:6144
  v_smfmac_f32_16x16x64_bf16 v[68:71], v[16:19], a[8:15], v0
  ds_read_b128 v[40:43], v4 offset:7168
  v_smfmac_f32_16x16x64_bf16 v[56:59], v[20:23], a[144:151], v0
  buffer_load_dwordx4 v[48:51], v11, s[36:39], s86 offen offset:2048 sc1
  s_waitcnt lgkmcnt(2)
  s_cmp_eq_u32 s73, 63
  s_barrier
  s_cbranch_scc1 L_T_LAST0
  ds_read_b128 v[24:27], v2 offset:1024
  v_smfmac_f32_16x16x64_bf16 v[60:63], v[20:23], a[152:159], v0
  ds_read_b128 v[28:31], v2 offset:2048
  v_smfmac_f32_16x16x64_bf16 v[64:67], v[20:23], a[64:71], v0
  ds_read_b128 v[32:35], v2 offset:3072
  v_smfmac_f32_16x16x64_bf16 v[68:71], v[20:23], a[72:79], v0
  ds_read_b128 v[16:19], v2 offset:8192
  s_waitcnt lgkmcnt(3)
  v_smfmac_f32_16x16x64_bf16 v[56:59], v[24:27], v[72:79], v0
  ds_read_b128 v[72:75], v4 offset:8192
  buffer_store_dwordx4 v[52:55], v2, s[36:39], s87 offen offset:0 sc1
  v_smfmac_f32_16x16x64_bf16 v[60:63], v[24:27], v[36:43], v0
  ds_read_b128 v[76:79], v4 offset:9216
  v_smfmac_f32_16x16x64_bf16 v[64:67], v[24:27], a[16:23], v0
  ds_read_b128 v[36:39], v4 offset:10240
  v_smfmac_f32_16x16x64_bf16 v[68:71], v[24:27], a[24:31], v0
  ds_read_b128 v[40:43], v4 offset:11264
  s_waitcnt lgkmcnt(6)
  v_smfmac_f32_16x16x64_bf16 v[64:67], v[28:31], a[32:39], v0
  ds_read_b128 v[24:27], v2 offset:5120
  v_smfmac_f32_16x16x64_bf16 v[68:71], v[28:31], a[40:47], v0
  s_waitcnt lgkmcnt(3)
  v_smfmac_f32_16x16x64_bf16 v[56:59], v[28:31], v[72:79], v0
  ds_read_b128 v[72:75], v4 offset:12288
  v_smfmac_f32_16x16x64_bf16 v[64:67], v[32:35], a[48:55], v0
  ds_read_b128 v[76:79], v4 offset:13312
  s_waitcnt lgkmcnt(3)
  v_smfmac_f32_16x16x64_bf16 v[60:63], v[28:31], v[36:43], v0
  ds_read_b128 v[36:39], v4 offset:14336
  v_smfmac_f32_16x16x64_bf16 v[68:71], v[32:35], a[56:63], v0
  ds_read_b128 v[40:43], v4 offset:15360
  v_smfmac_f32_16x16x64_bf16 v[64:67], v[16:19], a[128:135], v0
  ds_read_b128 v[28:31], v2 offset:6144
  v_smfmac_f32_16x16x64_bf16 v[68:71], v[16:19], a[136:143], v0
  s_waitcnt lgkmcnt(3)
  v_smfmac_f32_16x16x64_bf16 v[56:59], v[32:35], v[72:79], v0
  ds_read_b128 v[72:75], v4 offset:16384
  v_smfmac_f32_16x16x64_bf16 v[60:63], v[24:27], a[168:175], v0
  ds_read_b128 v[76:79], v4 offset:17408
  s_waitcnt lgkmcnt(3)
  v_smfmac_f32_16x16x64_bf16 v[60:63], v[32:35], v[36:43], v0
  ds_read_b128 v[32:35], v2 offset:7168
  v_smfmac_f32_16x16x64_bf16 v[56:59], v[24:27], a[160:167], v0
  ds_read_b128 v[36:39], v4 offset:18432
  s_waitcnt lgkmcnt(4)
  v_smfmac_f32_16x16x64_bf16 v[60:63], v[28:31], a[184:191], v0
  ds_read_b128 v[40:43], v4 offset:19456
  v_smfmac_f32_16x16x64_bf16 v[56:59], v[28:31], a[176:183], v0
  s_waitcnt lgkmcnt(3)
  v_smfmac_f32_16x16x64_bf16 v[56:59], v[16:19], v[72:79], v0
  s_waitcnt lgkmcnt(2)
  v_smfmac_f32_16x16x64_bf16 v[60:63], v[32:35], a[200:207], v0
  ds_read_b128 v[72:75], v3 offset:15744
  v_smfmac_f32_16x16x64_bf16 v[56:59], v[32:35], a[192:199], v0
  ds_read_b128 v[76:79], v3 offset:15744
  s_waitcnt lgkmcnt(2)
  v_smfmac_f32_16x16x64_bf16 v[60:63], v[16:19], v[36:43], v0
  ds_read_b128 v[36:39], v3 offset:15744
  v_smfmac_f32_16x16x64_bf16 v[64:67], v[24:27], a[80:87], v0
  ds_read_b128 v[40:43], v3 offset:15744
  s_nop 0
  v_smfmac_f32_16x16x64_bf16 v[68:71], v[24:27], a[88:95], v0
  s_nop 1
  v_add_f32 v56, v56, v58
  v_add_f32 v57, v57, v59
  v_add_f32 v60, v60, v62
  v_add_f32 v61, v61, v63
  v_cvt_pk_bf16_f32 v56, v56, v60
  v_cvt_pk_bf16_f32 v57, v57, v61
  v_smfmac_f32_16x16x64_bf16 v[64:67], v[28:31], a[96:103], v0
  ds_write2_b32 v7, v56, v57 offset0:0 offset1:4
  s_waitcnt lgkmcnt(3)
  v_smfmac_f32_16x16x64_bf16 v[68:71], v[28:31], a[104:111], v0
  v_smfmac_f32_16x16x64_bf16 v[64:67], v[32:35], a[112:119], v0
  v_smfmac_f32_16x16x64_bf16 v[68:71], v[32:35], a[120:127], v0
  s_nop 1
  v_smfmac_f32_16x16x64_bf16 v[72:75], v[24:27], v[112:119], v0
  s_nop 1
  v_smfmac_f32_16x16x64_bf16 v[76:79], v[24:27], v[120:127], v0
  s_nop 0
  v_add_f32 v64, v64, v66
  v_add_f32 v65, v65, v67
  v_add_f32 v68, v68, v70
  v_add_f32 v69, v69, v71
  v_cvt_pk_bf16_f32 v52, v64, v68
  v_cvt_pk_bf16_f32 v53, v65, v69
  v_smfmac_f32_16x16x64_bf16 v[72:75], v[28:31], v[128:135], v0
  ds_write2_b32 v8, v52, v53 offset0:0 offset1:4
  v_smfmac_f32_16x16x64_bf16 v[76:79], v[28:31], v[136:143], v0
  v_smfmac_f32_16x16x64_bf16 v[72:75], v[32:35], v[144:151], v0
  v_smfmac_f32_16x16x64_bf16 v[76:79], v[32:35], v[152:159], v0
  ds_read_b128 v[32:35], v3 offset:15744
  v_smfmac_f32_16x16x64_bf16 v[72:75], v[16:19], v[160:167], v0
  s_waitcnt lgkmcnt(1)
  s_barrier
  ds_read_b128 v[60:63], v1 offset:10240
  v_smfmac_f32_16x16x64_bf16 v[76:79], v[16:19], v[168:175], v0
  ds_read_b128 v[56:59], v1 offset:9216
  ds_read_b128 v[16:19], v2 offset:0
  v_smfmac_f32_16x16x64_bf16 v[72:75], v[20:23], v[96:103], v0
  ds_read_b128 v[68:71], v1 offset:12288
  v_smfmac_f32_16x16x64_bf16 v[76:79], v[20:23], v[104:111], v0
  ds_read_b128 v[24:27], v3 offset:10240
  ds_read_b128 v[28:31], v3 offset:10752
  s_waitcnt lgkmcnt(4)
  s_waitcnt vmcnt(1)
  v_smfmac_f32_16x16x64_bf16 v[40:43], v[60:63], v[44:51], v0
  ds_read_b128 v[20:23], v2 offset:1024
  v_smfmac_f32_16x16x64_bf16 v[36:39], v[56:59], v[44:51], v0
  ds_read_b128 v[60:63], v3 offset:9728
  s_waitcnt lgkmcnt(5)
  v_smfmac_f32_16x16x64_bf16 v[72:75], v[16:19], a[208:215], v0
  buffer_load_dwordx4 v[44:47], v12, s[36:39], s86 offen sc1
  ds_read_b128 v[56:59], v3 offset:9216
  v_smfmac_f32_16x16x64_bf16 v[76:79], v[16:19], a[216:223], v0
  buffer_load_dwordx4 v[48:51], v12, s[36:39], s86 offen offset:256 sc1
  ds_read_b128 v[64:67], v1 offset:11264
  v_add_f32 v40, v40, v42
  v_add_f32 v41, v41, v43
  v_add_f32 v36, v36, v38
  v_add_f32 v37, v37, v39
  s_nop 0
  v_add_f32_dpp v36, v40, v36 row_ror:8 row_mask:0xf bank_mask:0xf
  v_add_f32_dpp v37, v41, v37 row_ror:8 row_mask:0xf bank_mask:0xf
  s_mov_b64 exec, s[16:17]
  ds_write2_b32 v9, v36, v37 offset0:0 offset1:36
  s_mov_b64 exec, -1
  s_waitcnt lgkmcnt(5)
  v_smfmac_f32_16x16x64_bf16 v[32:35], v[68:71], v[24:31], v0
  ds_read_b128 v[16:19], v2 offset:2048
  s_waitcnt lgkmcnt(5)
  v_smfmac_f32_16x16x64_bf16 v[72:75], v[20:23], a[224:231], v0
  v_smfmac_f32_16x16x64_bf16 v[76:79], v[20:23], a[232:239], v0
  ds_read_b128 v[20:23], v2 offset:3072
  s_waitcnt lgkmcnt(3)
  v_smfmac_f32_16x16x64_bf16 v[32:35], v[64:67], v[56:63], v0
  s_waitcnt lgkmcnt(2)
  s_barrier
  ds_read_b128 v[36:39], v10 offset:13312
  s_waitcnt lgkmcnt(2)
  v_smfmac_f32_16x16x64_bf16 v[72:75], v[16:19], a[240:247], v0
  ds_read_b128 v[64:67], v3 offset:15744
  v_smfmac_f32_16x16x64_bf16 v[76:79], v[16:19], a[248:255], v0
  ds_read_b128 v[68:71], v3 offset:15744
  v_add_f32 v32, v32, v34
  v_add_f32 v33, v33, v35
  s_waitcnt lgkmcnt(3)
  v_smfmac_f32_16x16x64_bf16 v[72:75], v[20:23], v[80:87], v0
  ds_read_b128 v[24:27], v4 offset:20480
  s_waitcnt lgkmcnt(3)
  v_max3_f32 v56, v36, v37, v38
  v_max3_f32 v57, v39, v32, v33
  v_max_f32 v56, v56, v57
  v_smfmac_f32_16x16x64_bf16 v[76:79], v[20:23], v[88:95], v0
  ds_read_b128 v[28:31], v4 offset:21504
  v_max_f32_dpp v56, v56, v56 row_ror:8 row_mask:0xf bank_mask:0xf
  v_mov_b32 v57, v56
  s_nop 1
  v_permlane16_swap_b32 v56, v57
  v_max_f32 v56, v56, v57
  v_mov_b32 v57, v56
  s_add_u32 s87, s87, 131072
  s_nop 0
  v_permlane32_swap_b32 v56, v57
  v_max_f32 v56, v56, v57
  v_mul_f32_e64 v56, s92, v56
  v_pk_fma_f32 v[36:37], v[36:37], s[78:79], v[56:57] op_sel_hi:[1,1,0] neg_lo:[0,0,1] neg_hi:[0,0,1]
  v_pk_fma_f32 v[38:39], v[38:39], s[78:79], v[56:57] op_sel_hi:[1,1,0] neg_lo:[0,0,1] neg_hi:[0,0,1]
  v_pk_fma_f32 v[32:33], v[32:33], s[78:79], v[56:57] op_sel_hi:[1,1,0] neg_lo:[0,0,1] neg_hi:[0,0,1]
  v_exp_f32 v36, v36
  v_exp_f32 v37, v37
  v_exp_f32 v38, v38
  v_exp_f32 v39, v39
  v_exp_f32 v32, v32
  v_exp_f32 v33, v33
  v_pk_add_f32 v[72:73], v[72:73], v[74:75]
  v_pk_add_f32 v[76:77], v[76:77], v[78:79]
  s_waitcnt lgkmcnt(2)
  s_mov_b64 exec, s[16:17]
  v_cvt_pk_bf16_f32 v66, v36, v37
  v_cvt_pk_bf16_f32 v67, v38, v39
  v_cvt_pk_bf16_f32 v64, v32, v33
  s_mov_b64 exec, s[2:3]
  v_cvt_pk_bf16_f32 v68, v36, v37
  v_cvt_pk_bf16_f32 v69, v38, v39
  v_cvt_pk_bf16_f32 v65, v32, v33
  s_mov_b64 exec, -1
  v_cvt_pk_bf16_f32 v42, v72, v73
  v_cvt_pk_bf16_f32 v43, v76, v77
  s_waitcnt vmcnt(0)
  v_mfma_f32_16x16x16_bf16 v[20:23], v[50:51], v[68:69], 0
  v_mov_b32_dpp v16, v68 row_ror:8 row_mask:0xf bank_mask:0xf
  v_mov_b32_dpp v17, v69 row_ror:8 row_mask:0xf bank_mask:0xf
  v_mov_b32_dpp v18, v66 row_ror:8 row_mask:0xf bank_mask:0xf
  v_mov_b32_dpp v19, v67 row_ror:8 row_mask:0xf bank_mask:0xf
  v_add_f32 v58, v36, v37
  v_add_f32 v59, v38, v39
  v_mfma_f32_16x16x32_bf16 v[20:23], v[42:45], v[64:67], v[20:23]
  v_add_f32 v58, v58, v59
  v_add_f32 v59, v32, v33
  v_mfma_f32_16x16x32_bf16 v[20:23], v[46:49], v[16:19], v[20:23]
  v_mov_b64 v[54:55], v[42:43]
  v_add_f32_dpp v58, v58, v58 row_ror:8 row_mask:0xf bank_mask:0xf
  v_add_f32 v58, v58, v59
  v_mov_b32 v59, v58
  v_mov_b64 v[72:73], 0
  v_mov_b64 v[74:75], 0
  v_permlane16_swap_b32 v58, v59
  v_add_f32 v58, v58, v59
  v_mov_b32 v59, v58
  v_mov_b64 v[76:77], 0
  v_mov_b64 v[78:79], 0
  v_permlane32_swap_b32 v58, v59
  v_add_f32 v58, v58, v59
  v_rcp_f32_e64 v58, v58
  s_nop 0
  v_pk_mul_f32 v[20:21], v[20:21], v[58:59] op_sel_hi:[1,0]
  v_pk_mul_f32 v[22:23], v[22:23], v[58:59] op_sel_hi:[1,0]
  v_cvt_pk_bf16_f32 v60, v20, v21
  v_cvt_pk_bf16_f32 v61, v22, v23
  ds_write_b64 v2, v[60:61] offset:9216
  v_mov_b64 v[64:65], 0
  v_mov_b64 v[66:67], 0
  v_mov_b64 v[68:69], 0
  v_mov_b64 v[70:71], 0
  ds_read_b128 v[36:39], v4 offset:22528
  v_mov_b64 v[16:17], 0
  v_mov_b64 v[18:19], 0
  v_mov_b64 v[20:21], 0
  v_mov_b64 v[22:23], 0
  ds_read_b128 v[40:43], v4 offset:23552
  v_mov_b64 v[32:33], 0
  v_mov_b64 v[34:35], 0
  v_mov_b64 v[44:45], 0
  v_mov_b64 v[46:47], 0
  v_mov_b64 v[48:49], 0
  v_mov_b64 v[50:51], 0
  s_waitcnt lgkmcnt(2)
  s_barrier
  ds_read_b128 v[56:59], v1 offset:9216
  ds_read_b128 v[60:63], v1 offset:10240
  s_add_u32 s71, s81, 131072
  s_mov_b32 s89, s82
  s_and_b32 s95, s73, 1
  s_mov_b32 s72, 32768
  s_waitcnt lgkmcnt(1)
  v_smfmac_f32_16x16x64_bf16 v[64:67], v[56:59], v[24:31], v0
  ds_read_b128 v[24:27], v4 offset:24576
  v_smfmac_f32_16x16x64_bf16 v[68:71], v[56:59], v[36:43], v0
  ds_read_b128 v[28:31], v4 offset:25600
  s_waitcnt lgkmcnt(2)
  v_smfmac_f32_16x16x64_bf16 v[64:67], v[60:63], v[176:183], v0
  ds_read_b128 v[36:39], v4 offset:26624
  v_smfmac_f32_16x16x64_bf16 v[68:71], v[60:63], v[184:191], v0
  ds_read_b128 v[40:43], v4 offset:27648
  v_smfmac_f32_16x16x64_bf16 v[72:75], v[60:63], v[192:199], v0
  v_smfmac_f32_16x16x64_bf16 v[76:79], v[60:63], v[200:207], v0
  s_waitcnt lgkmcnt(2)
  v_smfmac_f32_16x16x64_bf16 v[72:75], v[56:59], v[24:31], v0
  ds_read_b128 v[24:27], v4 offset:28672
  v_smfmac_f32_16x16x64_bf16 v[20:23], v[56:59], v[240:247], v0
  ds_read_b128 v[28:31], v4 offset:29696
  s_waitcnt lgkmcnt(2)
  v_smfmac_f32_16x16x64_bf16 v[76:79], v[56:59], v[36:43], v0
  ds_read_b128 v[36:39], v4 offset:30720
  v_smfmac_f32_16x16x64_bf16 v[20:23], v[60:63], v[248:255], v0
  ds_read_b128 v[40:43], v4 offset:31744
  v_add_f32 v64, v64, v66
  v_add_f32 v65, v65, v67
  v_cvt_pk_bf16_f32 v64, v64, v65
  v_and_or_b32 v64, v64, -2, s95
  v_pk_add_f32 v[68:69], v[68:69], v[70:71]
  v_cvt_pk_bf16_f32 v65, v68, v69
  v_pk_add_f32 v[72:73], v[72:73], v[74:75]
  v_cvt_pk_bf16_f32 v66, v72, v73
  v_pk_add_f32 v[76:77], v[76:77], v[78:79]
  v_cvt_pk_bf16_f32 v67, v76, v77
  v_smfmac_f32_16x16x64_bf16 v[16:19], v[60:63], v[208:215], v0
  buffer_store_dwordx4 v[64:67], v13, s[36:39], s81 offen
  ds_read_b128 v[72:75], v4 offset:32768
  ds_read_b128 v[76:79], v4 offset:33792
  v_add_f32 v20, v20, v22
  v_add_f32 v21, v21, v23
  v_cvt_pk_bf16_f32 v20, v20, v21
  v_and_or_b32 v20, v20, -2, s95
  v_smfmac_f32_16x16x64_bf16 v[32:35], v[60:63], v[216:223], v0
  ds_read_b128 v[64:67], v4 offset:34816
  ds_read_b128 v[68:71], v4 offset:35840
  buffer_store_dword v20, v14, s[36:39], s81 offen
  s_waitcnt lgkmcnt(6)
  v_smfmac_f32_16x16x64_bf16 v[16:19], v[56:59], v[24:31], v0
  s_waitcnt lgkmcnt(4)
  v_smfmac_f32_16x16x64_bf16 v[32:35], v[56:59], v[36:43], v0
  v_smfmac_f32_16x16x64_bf16 v[44:47], v[60:63], v[224:231], v0
  v_smfmac_f32_16x16x64_bf16 v[48:51], v[60:63], v[232:239], v0
  s_waitcnt lgkmcnt(2)
  v_smfmac_f32_16x16x64_bf16 v[44:47], v[56:59], v[72:79], v0
  s_waitcnt lgkmcnt(0)
  v_smfmac_f32_16x16x64_bf16 v[48:51], v[56:59], v[64:71], v0
  ds_read_b128 v[24:27], v2 offset:14464
  v_add_f32 v16, v16, v18
  v_add_f32 v17, v17, v19
  v_cvt_pk_bf16_f32 v16, v16, v17
  v_and_or_b32 v16, v16, -2, s95
  v_pk_add_f32 v[32:33], v[32:33], v[34:35]
  v_cvt_pk_bf16_f32 v17, v32, v33
  v_pk_add_f32 v[44:45], v[44:45], v[46:47]
  v_cvt_pk_bf16_f32 v18, v44, v45
  v_pk_add_f32 v[48:49], v[48:49], v[50:51]
  v_cvt_pk_bf16_f32 v19, v48, v49
  buffer_store_dwordx4 v[16:19], v13, s[36:39], s71 offen
  ds_read_b128 v[36:39], v4 offset:2048
  ds_read_b128 v[40:43], v4 offset:3072
  v_lshrrev_b32 v34, 2, v2
  v_bfe_u32 v6, v2, 9, 1
  v_lshlrev_b32 v33, 7, v6
  v_bfe_u32 v6, v2, 6, 1
  v_lshl_add_u32 v33, v6, 6, v33
  v_bfe_u32 v6, v2, 7, 2
  v_lshl_add_u32 v33, v6, 4, v33
  v_bfe_u32 v6, v2, 4, 2
  v_lshl_add_u32 v33, v6, 2, v33
  v_mov_b64 v[56:57], 0
  v_mov_b64 v[58:59], 0
  v_mov_b64 v[60:61], 0
  v_mov_b64 v[62:63], 0
  s_add_u32 s71, s84, s93
  s_add_u32 s91, s83, s93
  v_bfe_u32 v6, v2, 8, 2
  v_lshlrev_b32 v32, 5, v6
  v_bfe_u32 v6, v2, 4, 3
  v_lshl_add_u32 v32, v6, 2, v32
  v_mov_b32_e64 v35, -1
  s_waitcnt vmcnt(0) lgkmcnt(0)
L_T_POLL10:
  buffer_load_dwordx4 v[64:67], v2, s[36:39], s89 offen offset:0 sc1
  buffer_load_dwordx4 v[68:71], v2, s[36:39], s89 offen offset:1024 sc1
  buffer_load_dwordx4 v[72:75], v2, s[36:39], s89 offen offset:2048 sc1
  buffer_load_dwordx4 v[76:79], v2, s[36:39], s89 offen offset:3072 sc1
  s_sub_u32 s72, s72, 1
  s_cmp_eq_u32 s72, 0
  s_cbranch_scc1 L_T_TO1
  s_waitcnt vmcnt(3)
  v_mfma_f32_16x16x32_bf16 v[28:31], v[24:27], v[64:67], 0
  v_xor_b32 v6, s95, v64
  s_waitcnt vmcnt(2)
  v_mfma_f32_16x16x32_bf16 v[28:31], v[24:27], v[68:71], v[28:31]
  v_bitop3_b32 v6, v6, v68, s95 bitop3:0xf6
  s_waitcnt vmcnt(1)
  v_mfma_f32_16x16x32_bf16 v[28:31], v[24:27], v[72:75], v[28:31]
  v_bitop3_b32 v6, v6, v72, s95 bitop3:0xf6
  s_waitcnt vmcnt(0)
  v_mfma_f32_16x16x32_bf16 v[28:31], v[24:27], v[76:79], v[28:31]
  v_bitop3_b32 v6, v6, v76, s95 bitop3:0xf6
  v_and_b32 v6, 1, v6
  v_cmp_ne_u32 vcc, 0, v6
  s_cbranch_vccnz L_T_POLL10
  s_nop 3
  v_add_f32_dpp v30, v28, v28 row_ror:8 row_mask:0xf bank_mask:0xf
  v_add_f32_dpp v31, v29, v29 row_ror:8 row_mask:0xf bank_mask:0xf
  s_mov_b64 exec, s[16:17]
  v_cvt_pk_bf16_f32 v28, v30, v31
  v_min_u32 v28, -2, v28
  buffer_store_dword v28, v32, s[36:39], s71 offen
  buffer_store_dword v35, v32, s[36:39], s91 offen
  s_mov_b64 exec, -1
  s_mov_b32 s71, s85
  s_mov_b32 s85, s83
  s_mov_b32 s83, s84
  s_mov_b32 s84, s71
  s_add_u32 s73, s73, 1
  s_add_u32 s86, s86, 262144
  s_add_u32 s89, s83, 4096
  s_add_u32 s71, s83, 8192
  s_mov_b32 s72, 32768
  ds_read_b128 v[24:27], v4 offset:0
  ds_read_b128 v[28:31], v4 offset:1024
  ds_read_b128 v[72:75], v4 offset:4096
  ds_read_b128 v[76:79], v4 offset:5120
  v_mov_b64 v[64:65], 0
  v_mov_b64 v[66:67], 0
  v_mov_b64 v[68:69], 0
  v_mov_b64 v[70:71], 0
  s_barrier
  s_branch L_T_LOOP0
L_T_POLL2B0:
  buffer_load_dwordx4 v[20:23], v15, s[36:39], s89 offen offset:0 sc1
  buffer_load_dword v35, v34, s[36:39], s71 offen offset:0 sc1
  s_sub_u32 s72, s72, 1
  s_cmp_eq_u32 s72, 0
  s_cbranch_scc1 L_T_TO2
  s_branch L_T_CHK2B0
L_T_LAST0:
  s_waitcnt lgkmcnt(0)
  buffer_store_dwordx4 v[52:55], v2, s[36:39], s87 offen offset:0 sc1
  s_nop 5
  ds_read_b128 v[24:27], v2 offset:1024
  ds_read_b128 v[28:31], v2 offset:5120
  ds_read_b128 v[32:35], v2 offset:2048
  ds_read_b128 v[36:39], v2 offset:6144
  ds_read_b128 v[40:43], v2 offset:3072
  ds_read_b128 v[56:59], v2 offset:7168
  ds_read_b128 v[60:63], v2 offset:8192
  v_mov_b64 v[72:73], 0
  v_mov_b64 v[74:75], 0
  v_mov_b64 v[76:77], 0
  v_mov_b64 v[78:79], 0
  s_add_u32 s87, s87, 131072
  v_smfmac_f32_16x16x64_bf16 v[64:67], v[20:23], a[64:71], v0
  v_smfmac_f32_16x16x64_bf16 v[68:71], v[20:23], a[72:79], v0
  v_smfmac_f32_16x16x64_bf16 v[72:75], v[16:19], a[208:215], v0
  v_smfmac_f32_16x16x64_bf16 v[76:79], v[16:19], a[216:223], v0
  v_smfmac_f32_16x16x64_bf16 v[72:75], v[20:23], v[96:103], v0
  v_smfmac_f32_16x16x64_bf16 v[76:79], v[20:23], v[104:111], v0
  s_waitcnt lgkmcnt(6)
  v_smfmac_f32_16x16x64_bf16 v[64:67], v[24:27], a[16:23], v0
  v_smfmac_f32_16x16x64_bf16 v[68:71], v[24:27], a[24:31], v0
  v_smfmac_f32_16x16x64_bf16 v[72:75], v[24:27], a[224:231], v0
  v_smfmac_f32_16x16x64_bf16 v[76:79], v[24:27], a[232:239], v0
  s_waitcnt lgkmcnt(5)
  v_smfmac_f32_16x16x64_bf16 v[64:67], v[28:31], a[80:87], v0
  v_smfmac_f32_16x16x64_bf16 v[68:71], v[28:31], a[88:95], v0
  v_smfmac_f32_16x16x64_bf16 v[72:75], v[28:31], v[112:119], v0
  v_smfmac_f32_16x16x64_bf16 v[76:79], v[28:31], v[120:127], v0
  s_waitcnt lgkmcnt(4)
  v_smfmac_f32_16x16x64_bf16 v[64:67], v[32:35], a[32:39], v0
  v_smfmac_f32_16x16x64_bf16 v[68:71], v[32:35], a[40:47], v0
  v_smfmac_f32_16x16x64_bf16 v[72:75], v[32:35], a[240:247], v0
  v_smfmac_f32_16x16x64_bf16 v[76:79], v[32:35], a[248:255], v0
  s_waitcnt lgkmcnt(3)
  v_smfmac_f32_16x16x64_bf16 v[64:67], v[36:39], a[96:103], v0
  v_smfmac_f32_16x16x64_bf16 v[68:71], v[36:39], a[104:111], v0
  v_smfmac_f32_16x16x64_bf16 v[72:75], v[36:39], v[128:135], v0
  v_smfmac_f32_16x16x64_bf16 v[76:79], v[36:39], v[136:143], v0
  s_waitcnt lgkmcnt(2)
  v_smfmac_f32_16x16x64_bf16 v[64:67], v[40:43], a[48:55], v0
  v_smfmac_f32_16x16x64_bf16 v[68:71], v[40:43], a[56:63], v0
  v_smfmac_f32_16x16x64_bf16 v[72:75], v[40:43], v[80:87], v0
  v_smfmac_f32_16x16x64_bf16 v[76:79], v[40:43], v[88:95], v0
  s_waitcnt lgkmcnt(1)
  v_smfmac_f32_16x16x64_bf16 v[64:67], v[56:59], a[112:119], v0
  v_smfmac_f32_16x16x64_bf16 v[68:71], v[56:59], a[120:127], v0
  v_smfmac_f32_16x16x64_bf16 v[72:75], v[56:59], v[144:151], v0
  v_smfmac_f32_16x16x64_bf16 v[76:79], v[56:59], v[152:159], v0
  s_waitcnt lgkmcnt(0)
  v_smfmac_f32_16x16x64_bf16 v[64:67], v[60:63], a[128:135], v0
  v_smfmac_f32_16x16x64_bf16 v[68:71], v[60:63], a[136:143], v0
  v_smfmac_f32_16x16x64_bf16 v[72:75], v[60:63], v[160:167], v0
  v_smfmac_f32_16x16x64_bf16 v[76:79], v[60:63], v[168:175], v0
  s_nop 4
  v_add_f32 v64, v64, v66
  v_add_f32 v65, v65, v67
  v_add_f32 v68, v68, v70
  v_add_f32 v69, v69, v71
  v_add_f32 v72, v72, v74
  v_add_f32 v73, v73, v75
  v_add_f32 v76, v76, v78
  v_add_f32 v77, v77, v79
  v_cvt_pk_bf16_f32 v52, v64, v68
  v_cvt_pk_bf16_f32 v53, v65, v69
  v_cvt_pk_bf16_f32 v54, v72, v73
  v_cvt_pk_bf16_f32 v55, v76, v77
  buffer_store_dwordx4 v[52:55], v2, s[36:39], s87 offen offset:0 sc1
  s_waitcnt vmcnt(0)
  s_barrier
  s_endpgm
L_T_PRE1:
  ds_read_b128 v[36:39], v4 offset:6144
  ds_read_b128 v[40:43], v4 offset:7168
  v_lshrrev_b32 v34, 2, v2
  v_bfe_u32 v6, v2, 9, 1
  v_lshlrev_b32_e64 v33, 7, v6
  v_bfe_u32 v6, v2, 6, 1
  v_lshl_add_u32 v33, v6, 6, v33
  v_bfe_u32 v6, v2, 7, 2
  v_lshl_add_u32 v33, v6, 4, v33
  v_bfe_u32 v6, v2, 4, 2
  v_lshl_add_u32 v33, v6, 2, v33
  v_mov_b64 v[56:57], 0
  v_mov_b64 v[58:59], 0
  v_mov_b64 v[60:61], 0
  v_mov_b64 v[62:63], 0
  s_add_u32 s89, s83, 4096
  s_add_u32 s71, s83, 8192
  s_mov_b32 s72, 32768
L_T_LOOP1:
  buffer_load_dwordx4 v[16:19], v15, s[36:39], s83 offen offset:1024 sc1
  buffer_load_dwordx4 v[20:23], v15, s[36:39], s89 offen offset:1024 sc1
  buffer_load_dword v35, v34, s[36:39], s71 offen offset:256 sc1
  s_sub_u32 s72, s72, 1
  s_cmp_eq_u32 s72, 0
  s_cbranch_scc1 L_T_TO2
  ds_read_b128 v[24:27], v4 offset:4096
  ds_read_b128 v[28:31], v4 offset:5120
  ds_read_b128 v[72:75], v4 offset:0
  ds_read_b128 v[76:79], v4 offset:1024
  v_mov_b64 v[64:65], 0
  v_mov_b64 v[66:67], 0
  v_mov_b64 v[68:69], 0
  v_mov_b64 v[70:71], 0
  s_waitcnt vmcnt(2) lgkmcnt(0)
  v_cmp_eq_u32 vcc, -1, v16
  ds_write_b128 v2, v[16:19] offset:1024
  s_cbranch_vccnz L_T_LOOP1
  v_smfmac_f32_16x16x64_bf16 v[56:59], v[16:19], v[24:31], v0
  v_smfmac_f32_16x16x64_bf16 v[60:63], v[16:19], v[36:43], v0
L_T_CHK2B1:
  s_waitcnt vmcnt(1)
  ds_write_b128 v2, v[20:23] offset:5120
  s_waitcnt vmcnt(0)
  v_max_u32 v6, v20, v35
  v_cmp_eq_u32 vcc, -1, v6
  ds_write_b32 v33, v35 offset:8448
  s_cbranch_vccnz L_T_POLL2B1
  v_smfmac_f32_16x16x64_bf16 v[64:67], v[16:19], a[16:23], v0
  buffer_load_dwordx4 v[44:47], v11, s[36:39], s86 offen offset:64 sc1
  ds_read_b128 v[36:39], v4 offset:2048
  v_smfmac_f32_16x16x64_bf16 v[68:71], v[16:19], a[24:31], v0
  ds_read_b128 v[40:43], v4 offset:3072
  v_smfmac_f32_16x16x64_bf16 v[56:59], v[20:23], a[160:167], v0
  buffer_load_dwordx4 v[48:51], v11, s[36:39], s86 offen offset:2112 sc1
  s_waitcnt lgkmcnt(2)
  s_cmp_eq_u32 s73, 63
  s_barrier
  s_cbranch_scc1 L_T_LAST1
  ds_read_b128 v[24:27], v2 offset:0
  v_smfmac_f32_16x16x64_bf16 v[60:63], v[20:23], a[168:175], v0
  ds_read_b128 v[28:31], v2 offset:3072
  v_smfmac_f32_16x16x64_bf16 v[64:67], v[20:23], a[80:87], v0
  ds_read_b128 v[32:35], v2 offset:2048
  v_smfmac_f32_16x16x64_bf16 v[68:71], v[20:23], a[88:95], v0
  ds_read_b128 v[16:19], v2 offset:8192
  s_waitcnt lgkmcnt(3)
  v_smfmac_f32_16x16x64_bf16 v[56:59], v[24:27], v[72:79], v0
  ds_read_b128 v[72:75], v4 offset:12288
  v_smfmac_f32_16x16x64_bf16 v[60:63], v[24:27], v[36:43], v0
  ds_read_b128 v[76:79], v4 offset:13312
  v_smfmac_f32_16x16x64_bf16 v[64:67], v[24:27], a[0:7], v0
  ds_read_b128 v[36:39], v4 offset:14336
  buffer_store_dwordx4 v[52:55], v2, s[36:39], s87 offen offset:1024 sc1
  v_smfmac_f32_16x16x64_bf16 v[68:71], v[24:27], a[8:15], v0
  ds_read_b128 v[40:43], v4 offset:15360
  s_waitcnt lgkmcnt(6)
  v_smfmac_f32_16x16x64_bf16 v[64:67], v[28:31], a[48:55], v0
  ds_read_b128 v[24:27], v2 offset:4096
  v_smfmac_f32_16x16x64_bf16 v[68:71], v[28:31], a[56:63], v0
  s_waitcnt lgkmcnt(3)
  v_smfmac_f32_16x16x64_bf16 v[56:59], v[28:31], v[72:79], v0
  ds_read_b128 v[72:75], v4 offset:8192
  v_smfmac_f32_16x16x64_bf16 v[64:67], v[32:35], a[32:39], v0
  ds_read_b128 v[76:79], v4 offset:9216
  s_waitcnt lgkmcnt(3)
  v_smfmac_f32_16x16x64_bf16 v[60:63], v[28:31], v[36:43], v0
  ds_read_b128 v[36:39], v4 offset:10240
  v_smfmac_f32_16x16x64_bf16 v[68:71], v[32:35], a[40:47], v0
  ds_read_b128 v[40:43], v4 offset:11264
  v_smfmac_f32_16x16x64_bf16 v[64:67], v[16:19], a[128:135], v0
  ds_read_b128 v[28:31], v2 offset:7168
  v_smfmac_f32_16x16x64_bf16 v[68:71], v[16:19], a[136:143], v0
  s_waitcnt lgkmcnt(3)
  v_smfmac_f32_16x16x64_bf16 v[56:59], v[32:35], v[72:79], v0
  ds_read_b128 v[72:75], v4 offset:16384
  v_smfmac_f32_16x16x64_bf16 v[60:63], v[24:27], a[152:159], v0
  ds_read_b128 v[76:79], v4 offset:17408
  s_waitcnt lgkmcnt(3)
  v_smfmac_f32_16x16x64_bf16 v[60:63], v[32:35], v[36:43], v0
  ds_read_b128 v[32:35], v2 offset:6144
  v_smfmac_f32_16x16x64_bf16 v[56:59], v[24:27], a[144:151], v0
  ds_read_b128 v[36:39], v4 offset:18432
  s_waitcnt lgkmcnt(4)
  v_smfmac_f32_16x16x64_bf16 v[60:63], v[28:31], a[200:207], v0
  ds_read_b128 v[40:43], v4 offset:19456
  v_smfmac_f32_16x16x64_bf16 v[56:59], v[28:31], a[192:199], v0
  s_waitcnt lgkmcnt(3)
  v_smfmac_f32_16x16x64_bf16 v[56:59], v[16:19], v[72:79], v0
  s_waitcnt lgkmcnt(2)
  v_smfmac_f32_16x16x64_bf16 v[60:63], v[32:35], a[184:191], v0
  ds_read_b128 v[72:75], v3 offset:15744
  v_smfmac_f32_16x16x64_bf16 v[56:59], v[32:35], a[176:183], v0
  ds_read_b128 v[76:79], v3 offset:15744
  s_waitcnt lgkmcnt(2)
  v_smfmac_f32_16x16x64_bf16 v[60:63], v[16:19], v[36:43], v0
  ds_read_b128 v[36:39], v3 offset:15744
  v_smfmac_f32_16x16x64_bf16 v[64:67], v[24:27], a[64:71], v0
  ds_read_b128 v[40:43], v3 offset:15744
  s_nop 0
  v_smfmac_f32_16x16x64_bf16 v[68:71], v[24:27], a[72:79], v0
  s_nop 1
  v_add_f32 v56, v56, v58
  v_add_f32 v57, v57, v59
  v_add_f32 v60, v60, v62
  v_add_f32 v61, v61, v63
  v_cvt_pk_bf16_f32 v56, v56, v60
  v_cvt_pk_bf16_f32 v57, v57, v61
  v_smfmac_f32_16x16x64_bf16 v[64:67], v[28:31], a[112:119], v0
  ds_write2_b32 v7, v56, v57 offset0:0 offset1:4
  s_waitcnt lgkmcnt(3)
  v_smfmac_f32_16x16x64_bf16 v[68:71], v[28:31], a[120:127], v0
  v_smfmac_f32_16x16x64_bf16 v[64:67], v[32:35], a[96:103], v0
  v_smfmac_f32_16x16x64_bf16 v[68:71], v[32:35], a[104:111], v0
  s_nop 1
  v_smfmac_f32_16x16x64_bf16 v[72:75], v[24:27], v[96:103], v0
  s_nop 1
  v_smfmac_f32_16x16x64_bf16 v[76:79], v[24:27], v[104:111], v0
  s_nop 0
  v_add_f32 v64, v64, v66
  v_add_f32 v65, v65, v67
  v_add_f32 v68, v68, v70
  v_add_f32 v69, v69, v71
  v_cvt_pk_bf16_f32 v52, v64, v68
  v_cvt_pk_bf16_f32 v53, v65, v69
  v_smfmac_f32_16x16x64_bf16 v[72:75], v[28:31], v[144:151], v0
  ds_write2_b32 v8, v52, v53 offset0:0 offset1:4
  v_smfmac_f32_16x16x64_bf16 v[76:79], v[28:31], v[152:159], v0
  v_smfmac_f32_16x16x64_bf16 v[72:75], v[32:35], v[128:135], v0
  v_smfmac_f32_16x16x64_bf16 v[76:79], v[32:35], v[136:143], v0
  ds_read_b128 v[32:35], v3 offset:15744
  v_smfmac_f32_16x16x64_bf16 v[72:75], v[16:19], v[160:167], v0
  s_waitcnt lgkmcnt(1)
  s_barrier
  ds_read_b128 v[60:63], v1 offset:10240
  v_smfmac_f32_16x16x64_bf16 v[76:79], v[16:19], v[168:175], v0
  ds_read_b128 v[56:59], v1 offset:9216
  ds_read_b128 v[16:19], v2 offset:1024
  v_smfmac_f32_16x16x64_bf16 v[72:75], v[20:23], v[112:119], v0
  ds_read_b128 v[68:71], v1 offset:12288
  v_smfmac_f32_16x16x64_bf16 v[76:79], v[20:23], v[120:127], v0
  ds_read_b128 v[24:27], v3 offset:10240
  ds_read_b128 v[28:31], v3 offset:10752
  s_waitcnt lgkmcnt(4)
  s_waitcnt vmcnt(1)
  v_smfmac_f32_16x16x64_bf16 v[40:43], v[60:63], v[44:51], v0
  ds_read_b128 v[20:23], v2 offset:0
  v_smfmac_f32_16x16x64_bf16 v[36:39], v[56:59], v[44:51], v0
  ds_read_b128 v[60:63], v3 offset:9728
  s_waitcnt lgkmcnt(5)
  v_smfmac_f32_16x16x64_bf16 v[72:75], v[16:19], a[224:231], v0
  buffer_load_dwordx4 v[44:47], v12, s[36:39], s86 offen sc1
  ds_read_b128 v[56:59], v3 offset:9216
  v_smfmac_f32_16x16x64_bf16 v[76:79], v[16:19], a[232:239], v0
  buffer_load_dwordx4 v[48:51], v12, s[36:39], s86 offen offset:256 sc1
  ds_read_b128 v[64:67], v1 offset:11264
  v_add_f32 v40, v40, v42
  v_add_f32 v41, v41, v43
  v_add_f32 v36, v36, v38
  v_add_f32 v37, v37, v39
  s_nop 0
  v_add_f32_dpp v36, v40, v36 row_ror:8 row_mask:0xf bank_mask:0xf
  v_add_f32_dpp v37, v41, v37 row_ror:8 row_mask:0xf bank_mask:0xf
  s_mov_b64 exec, s[16:17]
  ds_write2_b32 v9, v36, v37 offset0:0 offset1:36
  s_mov_b64 exec, -1
  s_waitcnt lgkmcnt(5)
  v_smfmac_f32_16x16x64_bf16 v[32:35], v[68:71], v[24:31], v0
  ds_read_b128 v[16:19], v2 offset:3072
  s_waitcnt lgkmcnt(5)
  v_smfmac_f32_16x16x64_bf16 v[72:75], v[20:23], a[208:215], v0
  v_smfmac_f32_16x16x64_bf16 v[76:79], v[20:23], a[216:223], v0
  ds_read_b128 v[20:23], v2 offset:2048
  s_waitcnt lgkmcnt(3)
  v_smfmac_f32_16x16x64_bf16 v[32:35], v[64:67], v[56:63], v0
  s_waitcnt lgkmcnt(2)
  s_barrier
  ds_read_b128 v[36:39], v10 offset:13312
  s_waitcnt lgkmcnt(2)
  v_smfmac_f32_16x16x64_bf16 v[72:75], v[16:19], v[80:87], v0
  ds_read_b128 v[64:67], v3 offset:15744
  v_smfmac_f32_16x16x64_bf16 v[76:79], v[16:19], v[88:95], v0
  ds_read_b128 v[68:71], v3 offset:15744
  v_add_f32 v32, v32, v34
  v_add_f32 v33, v33, v35
  s_waitcnt lgkmcnt(3)
  v_smfmac_f32_16x16x64_bf16 v[72:75], v[20:23], a[240:247], v0
  ds_read_b128 v[24:27], v4 offset:20480
  s_waitcnt lgkmcnt(3)
  v_max3_f32 v56, v36, v37, v38
  v_max3_f32 v57, v39, v32, v33
  v_max_f32 v56, v56, v57
  v_smfmac_f32_16x16x64_bf16 v[76:79], v[20:23], a[248:255], v0
  ds_read_b128 v[28:31], v4 offset:21504
  v_max_f32_dpp v56, v56, v56 row_ror:8 row_mask:0xf bank_mask:0xf
  v_mov_b32 v57, v56
  s_nop 1
  v_permlane16_swap_b32 v56, v57
  v_max_f32 v56, v56, v57
  v_mov_b32 v57, v56
  s_add_u32 s87, s87, 131072
  s_nop 0
  v_permlane32_swap_b32 v56, v57
  v_max_f32 v56, v56, v57
  v_mul_f32_e64 v56, s92, v56
  v_pk_fma_f32 v[36:37], v[36:37], s[78:79], v[56:57] op_sel_hi:[1,1,0] neg_lo:[0,0,1] neg_hi:[0,0,1]
  v_pk_fma_f32 v[38:39], v[38:39], s[78:79], v[56:57] op_sel_hi:[1,1,0] neg_lo:[0,0,1] neg_hi:[0,0,1]
  v_pk_fma_f32 v[32:33], v[32:33], s[78:79], v[56:57] op_sel_hi:[1,1,0] neg_lo:[0,0,1] neg_hi:[0,0,1]
  v_exp_f32 v36, v36
  v_exp_f32 v37, v37
  v_exp_f32 v38, v38
  v_exp_f32 v39, v39
  v_exp_f32 v32, v32
  v_exp_f32 v33, v33
  v_pk_add_f32 v[72:73], v[72:73], v[74:75]
  v_pk_add_f32 v[76:77], v[76:77], v[78:79]
  s_waitcnt lgkmcnt(2)
  s_mov_b64 exec, s[16:17]
  v_cvt_pk_bf16_f32 v66, v36, v37
  v_cvt_pk_bf16_f32 v67, v38, v39
  v_cvt_pk_bf16_f32 v64, v32, v33
  s_mov_b64 exec, s[2:3]
  v_cvt_pk_bf16_f32 v68, v36, v37
  v_cvt_pk_bf16_f32 v69, v38, v39
  v_cvt_pk_bf16_f32 v65, v32, v33
  s_mov_b64 exec, -1
  v_cvt_pk_bf16_f32 v42, v72, v73
  v_cvt_pk_bf16_f32 v43, v76, v77
  s_waitcnt vmcnt(0)
  v_mfma_f32_16x16x16_bf16 v[20:23], v[50:51], v[68:69], 0
  v_mov_b32_dpp v16, v68 row_ror:8 row_mask:0xf bank_mask:0xf
  v_mov_b32_dpp v17, v69 row_ror:8 row_mask:0xf bank_mask:0xf
  v_mov_b32_dpp v18, v66 row_ror:8 row_mask:0xf bank_mask:0xf
  v_mov_b32_dpp v19, v67 row_ror:8 row_mask:0xf bank_mask:0xf
  v_add_f32 v58, v36, v37
  v_add_f32 v59, v38, v39
  v_mfma_f32_16x16x32_bf16 v[20:23], v[42:45], v[64:67], v[20:23]
  v_add_f32 v58, v58, v59
  v_add_f32 v59, v32, v33
  v_mfma_f32_16x16x32_bf16 v[20:23], v[46:49], v[16:19], v[20:23]
  v_mov_b64 v[54:55], v[42:43]
  v_add_f32_dpp v58, v58, v58 row_ror:8 row_mask:0xf bank_mask:0xf
  v_add_f32 v58, v58, v59
  v_mov_b32 v59, v58
  v_mov_b64 v[72:73], 0
  v_mov_b64 v[74:75], 0
  v_permlane16_swap_b32 v58, v59
  v_add_f32 v58, v58, v59
  v_mov_b32 v59, v58
  v_mov_b64 v[76:77], 0
  v_mov_b64 v[78:79], 0
  v_permlane32_swap_b32 v58, v59
  v_add_f32 v58, v58, v59
  v_rcp_f32_e64 v58, v58
  s_nop 0
  v_pk_mul_f32 v[20:21], v[20:21], v[58:59] op_sel_hi:[1,0]
  v_pk_mul_f32 v[22:23], v[22:23], v[58:59] op_sel_hi:[1,0]
  v_cvt_pk_bf16_f32 v60, v20, v21
  v_cvt_pk_bf16_f32 v61, v22, v23
  ds_write_b64 v2, v[60:61] offset:9224
  v_mov_b64 v[64:65], 0
  v_mov_b64 v[66:67], 0
  v_mov_b64 v[68:69], 0
  v_mov_b64 v[70:71], 0
  ds_read_b128 v[36:39], v4 offset:22528
  v_mov_b64 v[16:17], 0
  v_mov_b64 v[18:19], 0
  v_mov_b64 v[20:21], 0
  v_mov_b64 v[22:23], 0
  ds_read_b128 v[40:43], v4 offset:23552
  v_mov_b64 v[32:33], 0
  v_mov_b64 v[34:35], 0
  v_mov_b64 v[44:45], 0
  v_mov_b64 v[46:47], 0
  v_mov_b64 v[48:49], 0
  v_mov_b64 v[50:51], 0
  s_waitcnt lgkmcnt(2)
  s_barrier
  ds_read_b128 v[56:59], v1 offset:9216
  ds_read_b128 v[60:63], v1 offset:10240
  s_add_u32 s71, s81, 131072
  s_mov_b32 s89, s82
  s_and_b32 s95, s73, 1
  s_mov_b32 s72, 32768
  s_waitcnt lgkmcnt(1)
  v_smfmac_f32_16x16x64_bf16 v[64:67], v[56:59], v[24:31], v0
  ds_read_b128 v[24:27], v4 offset:24576
  v_smfmac_f32_16x16x64_bf16 v[68:71], v[56:59], v[36:43], v0
  ds_read_b128 v[28:31], v4 offset:25600
  s_waitcnt lgkmcnt(2)
  v_smfmac_f32_16x16x64_bf16 v[64:67], v[60:63], v[176:183], v0
  ds_read_b128 v[36:39], v4 offset:26624
  v_smfmac_f32_16x16x64_bf16 v[68:71], v[60:63], v[184:191], v0
  ds_read_b128 v[40:43], v4 offset:27648
  v_smfmac_f32_16x16x64_bf16 v[72:75], v[60:63], v[192:199], v0
  v_smfmac_f32_16x16x64_bf16 v[76:79], v[60:63], v[200:207], v0
  s_waitcnt lgkmcnt(2)
  v_smfmac_f32_16x16x64_bf16 v[72:75], v[56:59], v[24:31], v0
  ds_read_b128 v[24:27], v4 offset:28672
  v_smfmac_f32_16x16x64_bf16 v[20:23], v[56:59], v[240:247], v0
  ds_read_b128 v[28:31], v4 offset:29696
  s_waitcnt lgkmcnt(2)
  v_smfmac_f32_16x16x64_bf16 v[76:79], v[56:59], v[36:43], v0
  ds_read_b128 v[36:39], v4 offset:30720
  v_smfmac_f32_16x16x64_bf16 v[20:23], v[60:63], v[248:255], v0
  ds_read_b128 v[40:43], v4 offset:31744
  v_smfmac_f32_16x16x64_bf16 v[16:19], v[60:63], v[208:215], v0
  v_add_f32 v64, v64, v66
  v_add_f32 v65, v65, v67
  v_cvt_pk_bf16_f32 v64, v64, v65
  v_and_or_b32 v64, v64, -2, s95
  v_pk_add_f32 v[68:69], v[68:69], v[70:71]
  v_cvt_pk_bf16_f32 v65, v68, v69
  v_pk_add_f32 v[72:73], v[72:73], v[74:75]
  v_cvt_pk_bf16_f32 v66, v72, v73
  v_pk_add_f32 v[76:77], v[76:77], v[78:79]
  v_cvt_pk_bf16_f32 v67, v76, v77
  v_smfmac_f32_16x16x64_bf16 v[32:35], v[60:63], v[216:223], v0
  buffer_store_dwordx4 v[64:67], v13, s[36:39], s81 offen
  ds_read_b128 v[72:75], v4 offset:32768
  ds_read_b128 v[76:79], v4 offset:33792
  v_add_f32 v20, v20, v22
  v_add_f32_e64 v21, v21, v23
  v_cvt_pk_bf16_f32 v20, v20, v21
  v_and_or_b32 v20, v20, -2, s95
  s_waitcnt lgkmcnt(4)
  v_smfmac_f32_16x16x64_bf16 v[16:19], v[56:59], v[24:31], v0
  ds_read_b128 v[64:67], v4 offset:34816
  ds_read_b128 v[68:71], v4 offset:35840
  buffer_store_dword v20, v14, s[36:39], s81 offen
  s_waitcnt lgkmcnt(4)
  v_smfmac_f32_16x16x64_bf16 v[32:35], v[56:59], v[36:43], v0
  v_smfmac_f32_16x16x64_bf16 v[44:47], v[60:63], v[224:231], v0
  v_smfmac_f32_16x16x64_bf16 v[48:51], v[60:63], v[232:239], v0
  s_waitcnt lgkmcnt(2)
  v_smfmac_f32_16x16x64_bf16 v[44:47], v[56:59], v[72:79], v0
  s_waitcnt lgkmcnt(0)
  v_smfmac_f32_16x16x64_bf16 v[48:51], v[56:59], v[64:71], v0
  ds_read_b128 v[24:27], v2 offset:14464
  v_add_f32 v16, v16, v18
  v_add_f32_e64 v17, v17, v19
  v_cvt_pk_bf16_f32 v16, v16, v17
  v_and_or_b32 v16, v16, -2, s95
  v_pk_add_f32 v[32:33], v[32:33], v[34:35]
  v_cvt_pk_bf16_f32 v17, v32, v33
  v_pk_add_f32 v[44:45], v[44:45], v[46:47]
  v_cvt_pk_bf16_f32 v18, v44, v45
  v_pk_add_f32 v[48:49], v[48:49], v[50:51]
  v_cvt_pk_bf16_f32 v19, v48, v49
  buffer_store_dwordx4 v[16:19], v13, s[36:39], s71 offen
  ds_read_b128 v[36:39], v4 offset:6144
  ds_read_b128 v[40:43], v4 offset:7168
  v_lshrrev_b32 v34, 2, v2
  v_bfe_u32 v6, v2, 9, 1
  v_lshlrev_b32 v33, 7, v6
  v_bfe_u32 v6, v2, 6, 1
  v_lshl_add_u32 v33, v6, 6, v33
  v_bfe_u32 v6, v2, 7, 2
  v_lshl_add_u32 v33, v6, 4, v33
  v_bfe_u32 v6, v2, 4, 2
  v_lshl_add_u32 v33, v6, 2, v33
  v_mov_b64 v[56:57], 0
  v_mov_b64 v[58:59], 0
  v_mov_b64 v[60:61], 0
  v_mov_b64 v[62:63], 0
  s_add_u32 s71, s84, s93
  s_add_u32 s91, s83, s93
  v_bfe_u32 v6, v2, 8, 2
  v_lshlrev_b32 v32, 5, v6
  v_bfe_u32 v6, v2, 4, 3
  v_lshl_add_u32 v32, v6, 2, v32
  v_mov_b32_e64 v35, -1
  s_waitcnt vmcnt(0) lgkmcnt(0)
L_T_POLL11:
  buffer_load_dwordx4 v[64:67], v2, s[36:39], s89 offen offset:0 sc1
  buffer_load_dwordx4 v[68:71], v2, s[36:39], s89 offen offset:1024 sc1
  buffer_load_dwordx4 v[72:75], v2, s[36:39], s89 offen offset:2048 sc1
  buffer_load_dwordx4 v[76:79], v2, s[36:39], s89 offen offset:3072 sc1
  s_sub_u32 s72, s72, 1
  s_cmp_eq_u32 s72, 0
  s_cbranch_scc1 L_T_TO1
  s_waitcnt vmcnt(3)
  v_mfma_f32_16x16x32_bf16 v[28:31], v[24:27], v[64:67], 0
  v_xor_b32 v6, s95, v64
  s_waitcnt vmcnt(2)
  v_mfma_f32_16x16x32_bf16 v[28:31], v[24:27], v[68:71], v[28:31]
  v_bitop3_b32 v6, v6, v68, s95 bitop3:0xf6
  s_waitcnt vmcnt(1)
  v_mfma_f32_16x16x32_bf16 v[28:31], v[24:27], v[72:75], v[28:31]
  v_bitop3_b32 v6, v6, v72, s95 bitop3:0xf6
  s_waitcnt vmcnt(0)
  v_mfma_f32_16x16x32_bf16 v[28:31], v[24:27], v[76:79], v[28:31]
  v_bitop3_b32 v6, v6, v76, s95 bitop3:0xf6
  v_and_b32_e64 v6, 1, v6
  v_cmp_ne_u32 vcc, 0, v6
  s_cbranch_vccnz L_T_POLL11
  s_nop 3
  v_add_f32_dpp v30, v28, v28 row_ror:8 row_mask:0xf bank_mask:0xf
  v_add_f32_dpp v31, v29, v29 row_ror:8 row_mask:0xf bank_mask:0xf
  s_mov_b64 exec, s[16:17]
  v_cvt_pk_bf16_f32 v28, v30, v31
  v_min_u32 v28, -2, v28
  buffer_store_dword v28, v32, s[36:39], s71 offen
  buffer_store_dword v35, v32, s[36:39], s91 offen
  s_mov_b64 exec, -1
  s_barrier
  s_mov_b32 s71, s85
  s_mov_b32 s85, s83
  s_mov_b32 s83, s84
  s_mov_b32 s84, s71
  s_add_u32 s73, s73, 1
  s_add_u32 s86, s86, 262144
  s_add_u32 s89, s83, 4096
  s_add_u32 s71, s83, 8192
  s_mov_b32 s72, 32768
  s_branch L_T_LOOP1
L_T_POLL2B1:
  buffer_load_dwordx4 v[20:23], v15, s[36:39], s89 offen offset:1024 sc1
  buffer_load_dword v35, v34, s[36:39], s71 offen offset:256 sc1
  s_sub_u32 s72, s72, 1
  s_cmp_eq_u32 s72, 0
  s_cbranch_scc1 L_T_TO2
  s_branch L_T_CHK2B1
L_T_LAST1:
  s_waitcnt lgkmcnt(0)
  buffer_store_dwordx4 v[52:55], v2, s[36:39], s87 offen offset:1024 sc1
  s_nop 5
  ds_read_b128 v[24:27], v2 offset:0
  ds_read_b128 v[28:31], v2 offset:4096
  ds_read_b128 v[32:35], v2 offset:3072
  ds_read_b128 v[36:39], v2 offset:7168
  ds_read_b128 v[40:43], v2 offset:2048
  ds_read_b128 v[56:59], v2 offset:6144
  ds_read_b128 v[60:63], v2 offset:8192
  v_mov_b64 v[72:73], 0
  v_mov_b64 v[74:75], 0
  v_mov_b64 v[76:77], 0
  v_mov_b64 v[78:79], 0
  s_add_u32 s87, s87, 131072
  v_smfmac_f32_16x16x64_bf16 v[64:67], v[20:23], a[80:87], v0
  v_smfmac_f32_16x16x64_bf16 v[68:71], v[20:23], a[88:95], v0
  v_smfmac_f32_16x16x64_bf16 v[72:75], v[16:19], a[224:231], v0
  v_smfmac_f32_16x16x64_bf16 v[76:79], v[16:19], a[232:239], v0
  v_smfmac_f32_16x16x64_bf16 v[72:75], v[20:23], v[112:119], v0
  v_smfmac_f32_16x16x64_bf16 v[76:79], v[20:23], v[120:127], v0
  s_waitcnt lgkmcnt(6)
  v_smfmac_f32_16x16x64_bf16 v[64:67], v[24:27], a[0:7], v0
  v_smfmac_f32_16x16x64_bf16 v[68:71], v[24:27], a[8:15], v0
  v_smfmac_f32_16x16x64_bf16 v[72:75], v[24:27], a[208:215], v0
  v_smfmac_f32_16x16x64_bf16 v[76:79], v[24:27], a[216:223], v0
  s_waitcnt lgkmcnt(5)
  v_smfmac_f32_16x16x64_bf16 v[64:67], v[28:31], a[64:71], v0
  v_smfmac_f32_16x16x64_bf16 v[68:71], v[28:31], a[72:79], v0
  v_smfmac_f32_16x16x64_bf16 v[72:75], v[28:31], v[96:103], v0
  v_smfmac_f32_16x16x64_bf16 v[76:79], v[28:31], v[104:111], v0
  s_waitcnt lgkmcnt(4)
  v_smfmac_f32_16x16x64_bf16 v[64:67], v[32:35], a[48:55], v0
  v_smfmac_f32_16x16x64_bf16 v[68:71], v[32:35], a[56:63], v0
  v_smfmac_f32_16x16x64_bf16 v[72:75], v[32:35], v[80:87], v0
  v_smfmac_f32_16x16x64_bf16 v[76:79], v[32:35], v[88:95], v0
  s_waitcnt lgkmcnt(3)
  v_smfmac_f32_16x16x64_bf16 v[64:67], v[36:39], a[112:119], v0
  v_smfmac_f32_16x16x64_bf16 v[68:71], v[36:39], a[120:127], v0
  v_smfmac_f32_16x16x64_bf16 v[72:75], v[36:39], v[144:151], v0
  v_smfmac_f32_16x16x64_bf16 v[76:79], v[36:39], v[152:159], v0
  s_waitcnt lgkmcnt(2)
  v_smfmac_f32_16x16x64_bf16 v[64:67], v[40:43], a[32:39], v0
  v_smfmac_f32_16x16x64_bf16 v[68:71], v[40:43], a[40:47], v0
  v_smfmac_f32_16x16x64_bf16 v[72:75], v[40:43], a[240:247], v0
  v_smfmac_f32_16x16x64_bf16 v[76:79], v[40:43], a[248:255], v0
  s_waitcnt lgkmcnt(1)
  v_smfmac_f32_16x16x64_bf16 v[64:67], v[56:59], a[96:103], v0
  v_smfmac_f32_16x16x64_bf16 v[68:71], v[56:59], a[104:111], v0
  v_smfmac_f32_16x16x64_bf16 v[72:75], v[56:59], v[128:135], v0
  v_smfmac_f32_16x16x64_bf16 v[76:79], v[56:59], v[136:143], v0
  s_waitcnt lgkmcnt(0)
  v_smfmac_f32_16x16x64_bf16 v[64:67], v[60:63], a[128:135], v0
  v_smfmac_f32_16x16x64_bf16 v[68:71], v[60:63], a[136:143], v0
  v_smfmac_f32_16x16x64_bf16 v[72:75], v[60:63], v[160:167], v0
  v_smfmac_f32_16x16x64_bf16 v[76:79], v[60:63], v[168:175], v0
  s_nop 4
  v_add_f32 v64, v64, v66
  v_add_f32 v65, v65, v67
  v_add_f32 v68, v68, v70
  v_add_f32 v69, v69, v71
  v_add_f32 v72, v72, v74
  v_add_f32 v73, v73, v75
  v_add_f32 v76, v76, v78
  v_add_f32_e64 v77, v77, v79
  v_cvt_pk_bf16_f32 v52, v64, v68
  v_cvt_pk_bf16_f32 v53, v65, v69
  v_cvt_pk_bf16_f32 v54, v72, v73
  v_cvt_pk_bf16_f32 v55, v76, v77
  buffer_store_dwordx4 v[52:55], v2, s[36:39], s87 offen offset:1024 sc1
  s_waitcnt vmcnt(0)
  s_barrier
  s_endpgm
L_T_PRE2:
  v_mov_b32 v5, 0
  ds_read_b128 v[36:39], v4 offset:10240
  ds_read_b128 v[40:43], v4 offset:11264
  v_lshrrev_b32 v34, 2, v2
  v_bfe_u32 v6, v2, 9, 1
  v_lshlrev_b32 v33, 7, v6
  v_bfe_u32 v6, v2, 6, 1
  v_lshl_add_u32 v33, v6, 6, v33
  v_bfe_u32 v6, v2, 7, 2
  v_lshl_add_u32 v33, v6, 4, v33
  v_bfe_u32 v6, v2, 4, 2
  v_lshl_add_u32 v33, v6, 2, v33
  v_mov_b64 v[56:57], 0
  v_mov_b64 v[58:59], 0
  v_mov_b64 v[60:61], 0
  v_mov_b64 v[62:63], 0
  ds_read_b128 v[24:27], v4 offset:8192
  ds_read_b128 v[28:31], v4 offset:9216
  ds_read_b128 v[72:75], v4 offset:12288
  ds_read_b128 v[76:79], v4 offset:13312
  v_mov_b64 v[64:65], 0
  v_mov_b64 v[66:67], 0
  v_mov_b64 v[68:69], 0
  v_mov_b64 v[70:71], 0
  s_add_u32 s89, s83, 4096
  s_add_u32 s71, s83, 8192
  s_mov_b32 s72, 32768
L_T_LOOP2:
  buffer_load_dwordx4 v[16:19], v15, s[36:39], s83 offen offset:2048 sc1
  buffer_load_dwordx4 v[20:23], v15, s[36:39], s89 offen offset:2048 sc1
  buffer_load_dword v35, v34, s[36:39], s71 offen offset:512 sc1
  s_sub_u32 s72, s72, 1
  s_cmp_eq_u32 s72, 0
  s_cbranch_scc1 L_T_TO2
  s_waitcnt vmcnt(2) lgkmcnt(0)
  v_cmp_eq_u32 vcc, -1, v16
  ds_write_b128 v2, v[16:19] offset:2048
  s_cbranch_vccnz L_T_LOOP2
  v_smfmac_f32_16x16x64_bf16 v[56:59], v[16:19], v[24:31], v0
  v_smfmac_f32_16x16x64_bf16 v[60:63], v[16:19], v[36:43], v0
L_T_CHK2B2:
  s_waitcnt vmcnt(1)
  ds_write_b128 v2, v[20:23] offset:6144
  s_waitcnt vmcnt(0)
  v_max_u32 v6, v20, v35
  v_cmp_eq_u32 vcc, -1, v6
  ds_write_b32 v33, v35 offset:8704
  s_cbranch_vccnz L_T_POLL2B2
  v_smfmac_f32_16x16x64_bf16 v[64:67], v[16:19], a[32:39], v0
  buffer_load_dwordx4 v[44:47], v11, s[36:39], s86 offen offset:256 sc1
  ds_read_b128 v[36:39], v4 offset:14336
  v_smfmac_f32_16x16x64_bf16 v[68:71], v[16:19], a[40:47], v0
  ds_read_b128 v[40:43], v4 offset:15360
  v_smfmac_f32_16x16x64_bf16 v[56:59], v[20:23], a[176:183], v0
  buffer_load_dwordx4 v[48:51], v11, s[36:39], s86 offen offset:2304 sc1
  s_waitcnt lgkmcnt(2)
  s_cmp_eq_u32 s73, 63
  s_barrier
  s_cbranch_scc1 L_T_LAST2
  ds_read_b128 v[24:27], v2 offset:3072
  v_smfmac_f32_16x16x64_bf16 v[60:63], v[20:23], a[184:191], v0
  ds_read_b128 v[28:31], v2 offset:0
  v_smfmac_f32_16x16x64_bf16 v[64:67], v[20:23], a[96:103], v0
  ds_read_b128 v[32:35], v2 offset:1024
  v_smfmac_f32_16x16x64_bf16 v[68:71], v[20:23], a[104:111], v0
  ds_read_b128 v[16:19], v2 offset:8192
  s_waitcnt lgkmcnt(3)
  v_smfmac_f32_16x16x64_bf16 v[56:59], v[24:27], v[72:79], v0
  ds_read_b128 v[72:75], v4 offset:0
  v_smfmac_f32_16x16x64_bf16 v[60:63], v[24:27], v[36:43], v0
  ds_read_b128 v[76:79], v4 offset:1024
  v_smfmac_f32_16x16x64_bf16 v[64:67], v[24:27], a[48:55], v0
  ds_read_b128 v[36:39], v4 offset:2048
  v_smfmac_f32_16x16x64_bf16 v[68:71], v[24:27], a[56:63], v0
  ds_read_b128 v[40:43], v4 offset:3072
  s_waitcnt lgkmcnt(6)
  v_smfmac_f32_16x16x64_bf16 v[64:67], v[28:31], a[0:7], v0
  ds_read_b128 v[24:27], v2 offset:7168
  buffer_store_dwordx4 v[52:55], v2, s[36:39], s87 offen offset:2048 sc1
  v_smfmac_f32_16x16x64_bf16 v[68:71], v[28:31], a[8:15], v0
  s_waitcnt lgkmcnt(3)
  v_smfmac_f32_16x16x64_bf16 v[56:59], v[28:31], v[72:79], v0
  ds_read_b128 v[72:75], v4 offset:4096
  v_smfmac_f32_16x16x64_bf16 v[64:67], v[32:35], a[16:23], v0
  ds_read_b128 v[76:79], v4 offset:5120
  s_waitcnt lgkmcnt(3)
  v_smfmac_f32_16x16x64_bf16 v[60:63], v[28:31], v[36:43], v0
  ds_read_b128 v[36:39], v4 offset:6144
  s_mov_b64 exec, 1
  buffer_store_dword v5, v2, s[36:39], s88 offen sc1
  s_mov_b64 exec, -1
  v_smfmac_f32_16x16x64_bf16 v[68:71], v[32:35], a[24:31], v0
  ds_read_b128 v[40:43], v4 offset:7168
  v_smfmac_f32_16x16x64_bf16 v[64:67], v[16:19], a[128:135], v0
  ds_read_b128 v[28:31], v2 offset:4096
  v_smfmac_f32_16x16x64_bf16 v[68:71], v[16:19], a[136:143], v0
  s_waitcnt lgkmcnt(3)
  v_smfmac_f32_16x16x64_bf16 v[56:59], v[32:35], v[72:79], v0
  ds_read_b128 v[72:75], v4 offset:16384
  v_smfmac_f32_16x16x64_bf16 v[60:63], v[24:27], a[200:207], v0
  ds_read_b128 v[76:79], v4 offset:17408
  s_waitcnt lgkmcnt(3)
  v_smfmac_f32_16x16x64_bf16 v[60:63], v[32:35], v[36:43], v0
  ds_read_b128 v[32:35], v2 offset:5120
  v_smfmac_f32_16x16x64_bf16 v[56:59], v[24:27], a[192:199], v0
  ds_read_b128 v[36:39], v4 offset:18432
  s_waitcnt lgkmcnt(4)
  v_smfmac_f32_16x16x64_bf16 v[60:63], v[28:31], a[152:159], v0
  ds_read_b128 v[40:43], v4 offset:19456
  v_smfmac_f32_16x16x64_bf16 v[56:59], v[28:31], a[144:151], v0
  s_waitcnt lgkmcnt(3)
  v_smfmac_f32_16x16x64_bf16 v[56:59], v[16:19], v[72:79], v0
  s_waitcnt lgkmcnt(2)
  v_smfmac_f32_16x16x64_bf16 v[60:63], v[32:35], a[168:175], v0
  ds_read_b128 v[72:75], v3 offset:15744
  v_smfmac_f32_16x16x64_bf16 v[56:59], v[32:35], a[160:167], v0
  ds_read_b128 v[76:79], v3 offset:15744
  s_waitcnt lgkmcnt(2)
  v_smfmac_f32_16x16x64_bf16 v[60:63], v[16:19], v[36:43], v0
  ds_read_b128 v[36:39], v3 offset:15744
  v_smfmac_f32_16x16x64_bf16 v[64:67], v[24:27], a[112:119], v0
  ds_read_b128 v[40:43], v3 offset:15744
  s_nop 0
  v_smfmac_f32_16x16x64_bf16 v[68:71], v[24:27], a[120:127], v0
  s_nop 1
  v_add_f32 v56, v56, v58
  v_add_f32 v57, v57, v59
  v_add_f32 v60, v60, v62
  v_add_f32 v61, v61, v63
  v_cvt_pk_bf16_f32 v56, v56, v60
  v_cvt_pk_bf16_f32 v57, v57, v61
  v_smfmac_f32_16x16x64_bf16 v[64:67], v[28:31], a[64:71], v0
  ds_write2_b32 v7, v56, v57 offset0:0 offset1:4
  s_waitcnt lgkmcnt(3)
  v_smfmac_f32_16x16x64_bf16 v[68:71], v[28:31], a[72:79], v0
  v_smfmac_f32_16x16x64_bf16 v[64:67], v[32:35], a[80:87], v0
  v_smfmac_f32_16x16x64_bf16 v[68:71], v[32:35], a[88:95], v0
  s_nop 1
  v_smfmac_f32_16x16x64_bf16 v[72:75], v[24:27], v[144:151], v0
  s_nop 1
  v_smfmac_f32_16x16x64_bf16 v[76:79], v[24:27], v[152:159], v0
  s_nop 0
  v_add_f32 v64, v64, v66
  v_add_f32 v65, v65, v67
  v_add_f32 v68, v68, v70
  v_add_f32 v69, v69, v71
  v_cvt_pk_bf16_f32 v52, v64, v68
  v_cvt_pk_bf16_f32 v53, v65, v69
  v_smfmac_f32_16x16x64_bf16 v[72:75], v[28:31], v[96:103], v0
  ds_write2_b32 v8, v52, v53 offset0:0 offset1:4
  v_smfmac_f32_16x16x64_bf16 v[76:79], v[28:31], v[104:111], v0
  v_smfmac_f32_16x16x64_bf16 v[72:75], v[32:35], v[112:119], v0
  v_smfmac_f32_16x16x64_bf16 v[76:79], v[32:35], v[120:127], v0
  ds_read_b128 v[32:35], v3 offset:15744
  v_smfmac_f32_16x16x64_bf16 v[72:75], v[16:19], v[160:167], v0
  s_waitcnt lgkmcnt(1)
  s_barrier
  ds_read_b128 v[60:63], v1 offset:10240
  v_smfmac_f32_16x16x64_bf16 v[76:79], v[16:19], v[168:175], v0
  ds_read_b128 v[56:59], v1 offset:9216
  ds_read_b128 v[16:19], v2 offset:2048
  v_smfmac_f32_16x16x64_bf16 v[72:75], v[20:23], v[128:135], v0
  ds_read_b128 v[68:71], v1 offset:12288
  v_smfmac_f32_16x16x64_bf16 v[76:79], v[20:23], v[136:143], v0
  ds_read_b128 v[24:27], v3 offset:10240
  ds_read_b128 v[28:31], v3 offset:10752
  s_waitcnt lgkmcnt(4)
  s_waitcnt vmcnt(2)
  v_smfmac_f32_16x16x64_bf16 v[40:43], v[60:63], v[44:51], v0
  ds_read_b128 v[20:23], v2 offset:3072
  v_smfmac_f32_16x16x64_bf16 v[36:39], v[56:59], v[44:51], v0
  ds_read_b128 v[60:63], v3 offset:9728
  s_waitcnt lgkmcnt(5)
  v_smfmac_f32_16x16x64_bf16 v[72:75], v[16:19], a[240:247], v0
  buffer_load_dwordx4 v[44:47], v12, s[36:39], s86 offen sc1
  ds_read_b128 v[56:59], v3 offset:9216
  v_smfmac_f32_16x16x64_bf16 v[76:79], v[16:19], a[248:255], v0
  buffer_load_dwordx4 v[48:51], v12, s[36:39], s86 offen offset:256 sc1
  ds_read_b128 v[64:67], v1 offset:11264
  v_add_f32 v40, v40, v42
  v_add_f32 v41, v41, v43
  v_add_f32 v36, v36, v38
  v_add_f32 v37, v37, v39
  s_nop 0
  v_add_f32_dpp v36, v40, v36 row_ror:8 row_mask:0xf bank_mask:0xf
  v_add_f32_dpp v37, v41, v37 row_ror:8 row_mask:0xf bank_mask:0xf
  s_mov_b64 exec, s[16:17]
  ds_write2_b32 v9, v36, v37 offset0:0 offset1:36
  s_mov_b64 exec, -1
  s_waitcnt lgkmcnt(5)
  v_smfmac_f32_16x16x64_bf16 v[32:35], v[68:71], v[24:31], v0
  ds_read_b128 v[16:19], v2 offset:0
  s_waitcnt lgkmcnt(5)
  v_smfmac_f32_16x16x64_bf16 v[72:75], v[20:23], v[80:87], v0
  v_smfmac_f32_16x16x64_bf16 v[76:79], v[20:23], v[88:95], v0
  ds_read_b128 v[20:23], v2 offset:1024
  s_waitcnt lgkmcnt(3)
  v_smfmac_f32_16x16x64_bf16 v[32:35], v[64:67], v[56:63], v0
  s_waitcnt lgkmcnt(2)
  s_barrier
  ds_read_b128 v[36:39], v10 offset:13312
  s_waitcnt lgkmcnt(2)
  v_smfmac_f32_16x16x64_bf16 v[72:75], v[16:19], a[208:215], v0
  ds_read_b128 v[64:67], v3 offset:15744
  v_smfmac_f32_16x16x64_bf16 v[76:79], v[16:19], a[216:223], v0
  ds_read_b128 v[68:71], v3 offset:15744
  v_add_f32 v32, v32, v34
  v_add_f32 v33, v33, v35
  s_waitcnt lgkmcnt(3)
  v_smfmac_f32_16x16x64_bf16 v[72:75], v[20:23], a[224:231], v0
  ds_read_b128 v[24:27], v4 offset:20480
  s_waitcnt lgkmcnt(3)
  v_max3_f32 v56, v36, v37, v38
  v_max3_f32 v57, v39, v32, v33
  v_max_f32 v56, v56, v57
  v_smfmac_f32_16x16x64_bf16 v[76:79], v[20:23], a[232:239], v0
  ds_read_b128 v[28:31], v4 offset:21504
  v_max_f32_dpp v56, v56, v56 row_ror:8 row_mask:0xf bank_mask:0xf
  v_mov_b32 v57, v56
  s_nop 1
  v_permlane16_swap_b32 v56, v57
  v_max_f32 v56, v56, v57
  v_mov_b32 v57, v56
  s_add_u32 s87, s87, 131072
  s_nop 0
  v_permlane32_swap_b32 v56, v57
  v_max_f32 v56, v56, v57
  v_mul_f32_e64 v56, s92, v56
  v_pk_fma_f32 v[36:37], v[36:37], s[78:79], v[56:57] op_sel_hi:[1,1,0] neg_lo:[0,0,1] neg_hi:[0,0,1]
  v_pk_fma_f32 v[38:39], v[38:39], s[78:79], v[56:57] op_sel_hi:[1,1,0] neg_lo:[0,0,1] neg_hi:[0,0,1]
  v_pk_fma_f32 v[32:33], v[32:33], s[78:79], v[56:57] op_sel_hi:[1,1,0] neg_lo:[0,0,1] neg_hi:[0,0,1]
  v_exp_f32 v36, v36
  v_exp_f32 v37, v37
  v_exp_f32 v38, v38
  v_exp_f32 v39, v39
  v_exp_f32 v32, v32
  v_exp_f32 v33, v33
  v_pk_add_f32 v[72:73], v[72:73], v[74:75]
  v_pk_add_f32 v[76:77], v[76:77], v[78:79]
  s_waitcnt lgkmcnt(2)
  s_mov_b64 exec, s[16:17]
  v_cvt_pk_bf16_f32 v66, v36, v37
  v_cvt_pk_bf16_f32 v67, v38, v39
  v_cvt_pk_bf16_f32 v64, v32, v33
  s_mov_b64 exec, s[2:3]
  v_cvt_pk_bf16_f32 v68, v36, v37
  v_cvt_pk_bf16_f32 v69, v38, v39
  v_cvt_pk_bf16_f32 v65, v32, v33
  s_mov_b64 exec, -1
  v_cvt_pk_bf16_f32 v42, v72, v73
  v_cvt_pk_bf16_f32 v43, v76, v77
  s_waitcnt vmcnt(0)
  v_mfma_f32_16x16x16_bf16 v[20:23], v[50:51], v[68:69], 0
  v_mov_b32_dpp v16, v68 row_ror:8 row_mask:0xf bank_mask:0xf
  v_mov_b32_dpp v17, v69 row_ror:8 row_mask:0xf bank_mask:0xf
  v_mov_b32_dpp v18, v66 row_ror:8 row_mask:0xf bank_mask:0xf
  v_mov_b32_dpp v19, v67 row_ror:8 row_mask:0xf bank_mask:0xf
  v_add_f32 v58, v36, v37
  v_add_f32 v59, v38, v39
  v_mfma_f32_16x16x32_bf16 v[20:23], v[42:45], v[64:67], v[20:23]
  v_add_f32 v58, v58, v59
  v_add_f32 v59, v32, v33
  v_mfma_f32_16x16x32_bf16 v[20:23], v[46:49], v[16:19], v[20:23]
  v_mov_b64 v[54:55], v[42:43]
  v_add_f32_dpp v58, v58, v58 row_ror:8 row_mask:0xf bank_mask:0xf
  v_add_f32 v58, v58, v59
  v_mov_b32 v59, v58
  v_mov_b64 v[72:73], 0
  v_mov_b64 v[74:75], 0
  v_permlane16_swap_b32 v58, v59
  v_add_f32 v58, v58, v59
  v_mov_b32 v59, v58
  v_mov_b64 v[76:77], 0
  v_mov_b64 v[78:79], 0
  v_permlane32_swap_b32 v58, v59
  v_add_f32 v58, v58, v59
  v_rcp_f32_e64 v58, v58
  s_nop 0
  v_pk_mul_f32 v[20:21], v[20:21], v[58:59] op_sel_hi:[1,0]
  v_pk_mul_f32 v[22:23], v[22:23], v[58:59] op_sel_hi:[1,0]
  v_cvt_pk_bf16_f32 v60, v20, v21
  v_cvt_pk_bf16_f32 v61, v22, v23
  ds_write_b64 v2, v[60:61] offset:10240
  v_mov_b64 v[64:65], 0
  v_mov_b64 v[66:67], 0
  v_mov_b64 v[68:69], 0
  v_mov_b64 v[70:71], 0
  ds_read_b128 v[36:39], v4 offset:22528
  v_mov_b64 v[16:17], 0
  v_mov_b64 v[18:19], 0
  v_mov_b64 v[20:21], 0
  v_mov_b64 v[22:23], 0
  ds_read_b128 v[40:43], v4 offset:23552
  v_mov_b64 v[32:33], 0
  v_mov_b64 v[34:35], 0
  v_mov_b64 v[44:45], 0
  v_mov_b64 v[46:47], 0
  v_mov_b64 v[48:49], 0
  v_mov_b64 v[50:51], 0
  s_waitcnt lgkmcnt(2)
  s_barrier
  ds_read_b128 v[56:59], v1 offset:9216
  ds_read_b128 v[60:63], v1 offset:10240
  s_add_u32 s71, s81, 131072
  s_mov_b32 s89, s82
  s_and_b32 s95, s73, 1
  s_mov_b32 s72, 32768
  s_waitcnt lgkmcnt(1)
  v_smfmac_f32_16x16x64_bf16 v[64:67], v[56:59], v[24:31], v0
  ds_read_b128 v[24:27], v4 offset:24576
  v_smfmac_f32_16x16x64_bf16 v[68:71], v[56:59], v[36:43], v0
  ds_read_b128 v[28:31], v4 offset:25600
  s_waitcnt lgkmcnt(2)
  v_smfmac_f32_16x16x64_bf16 v[64:67], v[60:63], v[176:183], v0
  ds_read_b128 v[36:39], v4 offset:26624
  v_smfmac_f32_16x16x64_bf16 v[68:71], v[60:63], v[184:191], v0
  ds_read_b128 v[40:43], v4 offset:27648
  v_smfmac_f32_16x16x64_bf16 v[72:75], v[60:63], v[192:199], v0
  v_smfmac_f32_16x16x64_bf16 v[76:79], v[60:63], v[200:207], v0
  s_waitcnt lgkmcnt(2)
  v_smfmac_f32_16x16x64_bf16 v[72:75], v[56:59], v[24:31], v0
  ds_read_b128 v[24:27], v4 offset:28672
  v_smfmac_f32_16x16x64_bf16 v[20:23], v[56:59], v[240:247], v0
  ds_read_b128 v[28:31], v4 offset:29696
  s_waitcnt lgkmcnt(2)
  v_smfmac_f32_16x16x64_bf16 v[76:79], v[56:59], v[36:43], v0
  ds_read_b128 v[36:39], v4 offset:30720
  v_smfmac_f32_16x16x64_bf16 v[20:23], v[60:63], v[248:255], v0
  ds_read_b128 v[40:43], v4 offset:31744
  v_smfmac_f32_16x16x64_bf16 v[16:19], v[60:63], v[208:215], v0
  v_smfmac_f32_16x16x64_bf16 v[32:35], v[60:63], v[216:223], v0
  v_add_f32 v64, v64, v66
  v_add_f32 v65, v65, v67
  v_cvt_pk_bf16_f32 v64, v64, v65
  v_and_or_b32 v64, v64, -2, s95
  v_pk_add_f32 v[68:69], v[68:69], v[70:71]
  v_cvt_pk_bf16_f32 v65, v68, v69
  v_pk_add_f32 v[72:73], v[72:73], v[74:75]
  v_cvt_pk_bf16_f32 v66, v72, v73
  v_pk_add_f32 v[76:77], v[76:77], v[78:79]
  v_cvt_pk_bf16_f32 v67, v76, v77
  s_waitcnt lgkmcnt(2)
  v_smfmac_f32_16x16x64_bf16 v[16:19], v[56:59], v[24:31], v0
  buffer_store_dwordx4 v[64:67], v13, s[36:39], s81 offen
  ds_read_b128 v[72:75], v4 offset:32768
  ds_read_b128 v[76:79], v4 offset:33792
  v_add_f32 v20, v20, v22
  v_add_f32 v21, v21, v23
  v_cvt_pk_bf16_f32 v20, v20, v21
  v_and_or_b32 v20, v20, -2, s95
  s_waitcnt lgkmcnt(2)
  v_smfmac_f32_16x16x64_bf16 v[32:35], v[56:59], v[36:43], v0
  ds_read_b128 v[64:67], v4 offset:34816
  ds_read_b128 v[68:71], v4 offset:35840
  buffer_store_dword v20, v14, s[36:39], s81 offen
  v_smfmac_f32_16x16x64_bf16 v[44:47], v[60:63], v[224:231], v0
  v_smfmac_f32_16x16x64_bf16 v[48:51], v[60:63], v[232:239], v0
  s_waitcnt lgkmcnt(2)
  v_smfmac_f32_16x16x64_bf16 v[44:47], v[56:59], v[72:79], v0
  s_waitcnt lgkmcnt(0)
  v_smfmac_f32_16x16x64_bf16 v[48:51], v[56:59], v[64:71], v0
  ds_read_b128 v[24:27], v2 offset:14464
  v_add_f32 v16, v16, v18
  v_add_f32 v17, v17, v19
  v_cvt_pk_bf16_f32 v16, v16, v17
  v_and_or_b32 v16, v16, -2, s95
  v_pk_add_f32 v[32:33], v[32:33], v[34:35]
  v_cvt_pk_bf16_f32 v17, v32, v33
  v_pk_add_f32 v[44:45], v[44:45], v[46:47]
  v_cvt_pk_bf16_f32 v18, v44, v45
  v_pk_add_f32 v[48:49], v[48:49], v[50:51]
  v_cvt_pk_bf16_f32 v19, v48, v49
  buffer_store_dwordx4 v[16:19], v13, s[36:39], s71 offen
  ds_read_b128 v[36:39], v4 offset:10240
  ds_read_b128 v[40:43], v4 offset:11264
  v_lshrrev_b32 v34, 2, v2
  v_bfe_u32 v6, v2, 9, 1
  v_lshlrev_b32 v33, 7, v6
  v_bfe_u32 v6, v2, 6, 1
  v_lshl_add_u32 v33, v6, 6, v33
  v_bfe_u32 v6, v2, 7, 2
  v_lshl_add_u32 v33, v6, 4, v33
  v_bfe_u32 v6, v2, 4, 2
  v_lshl_add_u32 v33, v6, 2, v33
  v_mov_b64 v[56:57], 0
  v_mov_b64 v[58:59], 0
  v_mov_b64 v[60:61], 0
  v_mov_b64 v[62:63], 0
  s_cmp_eq_u32 s90, 0
  s_cbranch_scc1 L_T_NORED2
  s_add_u32 s71, s84, s93
  s_add_u32 s91, s83, s93
  v_bfe_u32 v6, v2, 8, 2
  v_lshlrev_b32 v32, 5, v6
  v_bfe_u32 v6, v2, 4, 3
  v_lshl_add_u32 v32, v6, 2, v32
  v_mov_b32_e64 v35, -1
  s_waitcnt vmcnt(0) lgkmcnt(0)
L_T_POLL12:
  buffer_load_dwordx4 v[64:67], v2, s[36:39], s89 offen offset:0 sc1
  buffer_load_dwordx4 v[68:71], v2, s[36:39], s89 offen offset:1024 sc1
  buffer_load_dwordx4 v[72:75], v2, s[36:39], s89 offen offset:2048 sc1
  buffer_load_dwordx4 v[76:79], v2, s[36:39], s89 offen offset:3072 sc1
  s_sub_u32 s72, s72, 1
  s_cmp_eq_u32 s72, 0
  s_cbranch_scc1 L_T_TO1
  s_waitcnt vmcnt(3)
  v_mfma_f32_16x16x32_bf16 v[28:31], v[24:27], v[64:67], 0
  v_xor_b32 v6, s95, v64
  s_waitcnt vmcnt(2)
  v_mfma_f32_16x16x32_bf16 v[28:31], v[24:27], v[68:71], v[28:31]
  v_bitop3_b32 v6, v6, v68, s95 bitop3:0xf6
  s_waitcnt vmcnt(1)
  v_mfma_f32_16x16x32_bf16 v[28:31], v[24:27], v[72:75], v[28:31]
  v_bitop3_b32 v6, v6, v72, s95 bitop3:0xf6
  s_waitcnt vmcnt(0)
  v_mfma_f32_16x16x32_bf16 v[28:31], v[24:27], v[76:79], v[28:31]
  v_bitop3_b32 v6, v6, v76, s95 bitop3:0xf6
  v_and_b32 v6, 1, v6
  v_cmp_ne_u32 vcc, 0, v6
  s_cbranch_vccnz L_T_POLL12
  s_nop 3
  v_add_f32_dpp v30, v28, v28 row_ror:8 row_mask:0xf bank_mask:0xf
  v_add_f32_dpp v31, v29, v29 row_ror:8 row_mask:0xf bank_mask:0xf
  s_mov_b64 exec, s[16:17]
  v_cvt_pk_bf16_f32 v28, v30, v31
  v_min_u32 v28, -2, v28
  buffer_store_dword v28, v32, s[36:39], s71 offen
  buffer_store_dword v35, v32, s[36:39], s91 offen
  s_mov_b64 exec, -1
L_T_NORED2:
  s_mov_b32 s71, s85
  s_mov_b32 s85, s83
  s_mov_b32 s83, s84
  s_mov_b32 s84, s71
  s_add_u32 s73, s73, 1
  s_add_u32 s86, s86, 262144
  s_add_u32 s89, s83, 4096
  s_add_u32 s71, s83, 8192
  s_mov_b32 s72, 32768
  v_mov_b32 v5, s73
  v_subrev_u32 v5, 1, v5
  ds_read_b128 v[24:27], v4 offset:8192
  ds_read_b128 v[28:31], v4 offset:9216
  ds_read_b128 v[72:75], v4 offset:12288
  ds_read_b128 v[76:79], v4 offset:13312
  v_mov_b64 v[64:65], 0
  v_mov_b64 v[66:67], 0
  v_mov_b64 v[68:69], 0
  v_mov_b64 v[70:71], 0
  s_barrier
  s_branch L_T_LOOP2
L_T_POLL2B2:
  buffer_load_dwordx4 v[20:23], v15, s[36:39], s89 offen offset:2048 sc1
  buffer_load_dword v35, v34, s[36:39], s71 offen offset:512 sc1
  s_sub_u32 s72, s72, 1
  s_cmp_eq_u32 s72, 0
  s_cbranch_scc1 L_T_TO2
  s_branch L_T_CHK2B2
L_T_LAST2:
  s_waitcnt lgkmcnt(0)
  buffer_store_dwordx4 v[52:55], v2, s[36:39], s87 offen offset:2048 sc1
  s_nop 5
  ds_read_b128 v[24:27], v2 offset:3072
  ds_read_b128 v[28:31], v2 offset:7168
  ds_read_b128 v[32:35], v2 offset:0
  ds_read_b128 v[36:39], v2 offset:4096
  ds_read_b128 v[40:43], v2 offset:1024
  ds_read_b128 v[56:59], v2 offset:5120
  ds_read_b128 v[60:63], v2 offset:8192
  v_mov_b64 v[72:73], 0
  v_mov_b64 v[74:75], 0
  v_mov_b64 v[76:77], 0
  v_mov_b64 v[78:79], 0
  s_add_u32 s87, s87, 131072
  v_smfmac_f32_16x16x64_bf16 v[64:67], v[20:23], a[96:103], v0
  v_smfmac_f32_16x16x64_bf16 v[68:71], v[20:23], a[104:111], v0
  v_smfmac_f32_16x16x64_bf16 v[72:75], v[16:19], a[240:247], v0
  v_smfmac_f32_16x16x64_bf16 v[76:79], v[16:19], a[248:255], v0
  v_smfmac_f32_16x16x64_bf16 v[72:75], v[20:23], v[128:135], v0
  v_smfmac_f32_16x16x64_bf16 v[76:79], v[20:23], v[136:143], v0
  s_waitcnt lgkmcnt(6)
  v_smfmac_f32_16x16x64_bf16 v[64:67], v[24:27], a[48:55], v0
  v_smfmac_f32_16x16x64_bf16 v[68:71], v[24:27], a[56:63], v0
  v_smfmac_f32_16x16x64_bf16 v[72:75], v[24:27], v[80:87], v0
  v_smfmac_f32_16x16x64_bf16 v[76:79], v[24:27], v[88:95], v0
  s_waitcnt lgkmcnt(5)
  v_smfmac_f32_16x16x64_bf16 v[64:67], v[28:31], a[112:119], v0
  v_smfmac_f32_16x16x64_bf16 v[68:71], v[28:31], a[120:127], v0
  v_smfmac_f32_16x16x64_bf16 v[72:75], v[28:31], v[144:151], v0
  v_smfmac_f32_16x16x64_bf16 v[76:79], v[28:31], v[152:159], v0
  s_waitcnt lgkmcnt(4)
  v_smfmac_f32_16x16x64_bf16 v[64:67], v[32:35], a[0:7], v0
  v_smfmac_f32_16x16x64_bf16 v[68:71], v[32:35], a[8:15], v0
  v_smfmac_f32_16x16x64_bf16 v[72:75], v[32:35], a[208:215], v0
  v_smfmac_f32_16x16x64_bf16 v[76:79], v[32:35], a[216:223], v0
  s_waitcnt lgkmcnt(3)
  v_smfmac_f32_16x16x64_bf16 v[64:67], v[36:39], a[64:71], v0
  v_smfmac_f32_16x16x64_bf16 v[68:71], v[36:39], a[72:79], v0
  v_smfmac_f32_16x16x64_bf16 v[72:75], v[36:39], v[96:103], v0
  v_smfmac_f32_16x16x64_bf16 v[76:79], v[36:39], v[104:111], v0
  s_waitcnt lgkmcnt(2)
  v_smfmac_f32_16x16x64_bf16 v[64:67], v[40:43], a[16:23], v0
  v_smfmac_f32_16x16x64_bf16 v[68:71], v[40:43], a[24:31], v0
  v_smfmac_f32_16x16x64_bf16 v[72:75], v[40:43], a[224:231], v0
  v_smfmac_f32_16x16x64_bf16 v[76:79], v[40:43], a[232:239], v0
  s_waitcnt lgkmcnt(1)
  v_smfmac_f32_16x16x64_bf16 v[64:67], v[56:59], a[80:87], v0
  v_smfmac_f32_16x16x64_bf16 v[68:71], v[56:59], a[88:95], v0
  v_smfmac_f32_16x16x64_bf16 v[72:75], v[56:59], v[112:119], v0
  v_smfmac_f32_16x16x64_bf16 v[76:79], v[56:59], v[120:127], v0
  s_waitcnt lgkmcnt(0)
  v_smfmac_f32_16x16x64_bf16 v[64:67], v[60:63], a[128:135], v0
  v_smfmac_f32_16x16x64_bf16 v[68:71], v[60:63], a[136:143], v0
  v_smfmac_f32_16x16x64_bf16 v[72:75], v[60:63], v[160:167], v0
  v_smfmac_f32_16x16x64_bf16 v[76:79], v[60:63], v[168:175], v0
  s_nop 4
  v_add_f32 v64, v64, v66
  v_add_f32 v65, v65, v67
  v_add_f32 v68, v68, v70
  v_add_f32 v69, v69, v71
  v_add_f32 v72, v72, v74
  v_add_f32 v73, v73, v75
  v_add_f32 v76, v76, v78
  v_add_f32 v77, v77, v79
  v_cvt_pk_bf16_f32 v52, v64, v68
  v_cvt_pk_bf16_f32 v53, v65, v69
  v_cvt_pk_bf16_f32 v54, v72, v73
  v_cvt_pk_bf16_f32 v55, v76, v77
  buffer_store_dwordx4 v[52:55], v2, s[36:39], s87 offen offset:2048 sc1
  s_waitcnt vmcnt(0)
  s_barrier
  v_mov_b32 v5, 64
  s_mov_b64 exec, 1
  buffer_store_dword v5, v2, s[36:39], s88 offen sc1
  s_mov_b64 exec, -1
  s_endpgm
L_T_PRE3:
  s_add_u32 s76, s86, s76
  ds_read_b128 v[36:39], v4 offset:14336
  ds_read_b128 v[40:43], v4 offset:15360
  v_lshrrev_b32 v34, 2, v2
  v_bfe_u32 v6, v2, 9, 1
  v_lshlrev_b32_e64 v33, 7, v6
  v_bfe_u32 v6, v2, 6, 1
  v_lshl_add_u32 v33, v6, 6, v33
  v_bfe_u32 v6, v2, 7, 2
  v_lshl_add_u32 v33, v6, 4, v33
  v_bfe_u32 v6, v2, 4, 2
  v_lshl_add_u32 v33, v6, 2, v33
  v_mov_b64 v[56:57], 0
  v_mov_b64 v[58:59], 0
  v_mov_b64 v[60:61], 0
  v_mov_b64 v[62:63], 0
  ds_read_b128 v[24:27], v4 offset:12288
  ds_read_b128 v[28:31], v4 offset:13312
  ds_read_b128 v[72:75], v4 offset:8192
  ds_read_b128 v[76:79], v4 offset:9216
  v_mov_b64 v[64:65], 0
  v_mov_b64 v[66:67], 0
  v_mov_b64 v[68:69], 0
  v_mov_b64 v[70:71], 0
  s_add_u32 s89, s83, 4096
  s_add_u32 s71, s83, 8192
  s_mov_b32 s72, 32768
L_T_LOOP3:
  buffer_load_dwordx4 v[16:19], v15, s[36:39], s83 offen offset:3072 sc1
  buffer_load_dwordx4 v[20:23], v15, s[36:39], s89 offen offset:3072 sc1
  buffer_load_dword v35, v34, s[36:39], s71 offen offset:768 sc1
  s_sub_u32 s72, s72, 1
  s_cmp_eq_u32 s72, 0
  s_cbranch_scc1 L_T_TO2
  s_waitcnt vmcnt(2) lgkmcnt(0)
  v_cmp_eq_u32 vcc, -1, v16
  ds_write_b128 v2, v[16:19] offset:3072
  s_cbranch_vccnz L_T_LOOP3
  v_smfmac_f32_16x16x64_bf16 v[56:59], v[16:19], v[24:31], v0
  v_smfmac_f32_16x16x64_bf16 v[60:63], v[16:19], v[36:43], v0
L_T_CHK2B3:
  s_waitcnt vmcnt(1)
  ds_write_b128 v2, v[20:23] offset:7168
  s_waitcnt vmcnt(0)
  v_max_u32 v6, v20, v35
  v_cmp_eq_u32 vcc, -1, v6
  ds_write_b32 v33, v35 offset:8960
  s_cbranch_vccnz L_T_POLL2B3
  v_smfmac_f32_16x16x64_bf16 v[64:67], v[16:19], a[48:55], v0
  buffer_load_dwordx4 v[44:47], v11, s[36:39], s86 offen offset:320 sc1
  ds_read_b128 v[36:39], v4 offset:10240
  v_smfmac_f32_16x16x64_bf16 v[68:71], v[16:19], a[56:63], v0
  ds_read_b128 v[40:43], v4 offset:11264
  v_smfmac_f32_16x16x64_bf16 v[56:59], v[20:23], a[192:199], v0
  buffer_load_dwordx4 v[48:51], v11, s[36:39], s86 offen offset:2368 sc1
  s_waitcnt lgkmcnt(2)
  s_cmp_eq_u32 s73, 63
  s_barrier
  s_cbranch_scc1 L_T_LAST3
  ds_read_b128 v[24:27], v2 offset:2048
  v_smfmac_f32_16x16x64_bf16 v[60:63], v[20:23], a[200:207], v0
  ds_read_b128 v[28:31], v2 offset:1024
  v_smfmac_f32_16x16x64_bf16 v[64:67], v[20:23], a[112:119], v0
  ds_read_b128 v[32:35], v2 offset:0
  v_smfmac_f32_16x16x64_bf16 v[68:71], v[20:23], a[120:127], v0
  ds_read_b128 v[16:19], v2 offset:8192
  s_waitcnt lgkmcnt(3)
  v_smfmac_f32_16x16x64_bf16 v[56:59], v[24:27], v[72:79], v0
  ds_read_b128 v[72:75], v4 offset:4096
  v_smfmac_f32_16x16x64_bf16 v[60:63], v[24:27], v[36:43], v0
  ds_read_b128 v[76:79], v4 offset:5120
  s_mov_b64 exec, 0xff
  buffer_load_dword v5, v2, s[36:39], s94 offen offset:0 sc1
  s_mov_b64 exec, -1
  v_smfmac_f32_16x16x64_bf16 v[64:67], v[24:27], a[32:39], v0
  ds_read_b128 v[36:39], v4 offset:6144
  v_smfmac_f32_16x16x64_bf16 v[68:71], v[24:27], a[40:47], v0
  ds_read_b128 v[40:43], v4 offset:7168
  s_waitcnt lgkmcnt(6)
  v_smfmac_f32_16x16x64_bf16 v[64:67], v[28:31], a[16:23], v0
  ds_read_b128 v[24:27], v2 offset:6144
  v_smfmac_f32_16x16x64_bf16 v[68:71], v[28:31], a[24:31], v0
  s_waitcnt lgkmcnt(3)
  v_smfmac_f32_16x16x64_bf16 v[56:59], v[28:31], v[72:79], v0
  ds_read_b128 v[72:75], v4 offset:0
  buffer_store_dwordx4 v[52:55], v2, s[36:39], s87 offen offset:3072 sc1
  v_smfmac_f32_16x16x64_bf16 v[64:67], v[32:35], a[0:7], v0
  ds_read_b128 v[76:79], v4 offset:1024
  s_waitcnt lgkmcnt(3)
  v_smfmac_f32_16x16x64_bf16 v[60:63], v[28:31], v[36:43], v0
  ds_read_b128 v[36:39], v4 offset:2048
  v_smfmac_f32_16x16x64_bf16 v[68:71], v[32:35], a[8:15], v0
  ds_read_b128 v[40:43], v4 offset:3072
  v_smfmac_f32_16x16x64_bf16 v[64:67], v[16:19], a[128:135], v0
  ds_read_b128 v[28:31], v2 offset:5120
  v_smfmac_f32_16x16x64_bf16 v[68:71], v[16:19], a[136:143], v0
  s_waitcnt lgkmcnt(3)
  v_smfmac_f32_16x16x64_bf16 v[56:59], v[32:35], v[72:79], v0
  ds_read_b128 v[72:75], v4 offset:16384
  v_smfmac_f32_16x16x64_bf16 v[60:63], v[24:27], a[184:191], v0
  ds_read_b128 v[76:79], v4 offset:17408
  s_waitcnt lgkmcnt(3)
  v_smfmac_f32_16x16x64_bf16 v[60:63], v[32:35], v[36:43], v0
  ds_read_b128 v[32:35], v2 offset:4096
  v_smfmac_f32_16x16x64_bf16 v[56:59], v[24:27], a[176:183], v0
  ds_read_b128 v[36:39], v4 offset:18432
  s_waitcnt lgkmcnt(4)
  v_smfmac_f32_16x16x64_bf16 v[60:63], v[28:31], a[168:175], v0
  ds_read_b128 v[40:43], v4 offset:19456
  v_smfmac_f32_16x16x64_bf16 v[56:59], v[28:31], a[160:167], v0
  s_waitcnt lgkmcnt(3)
  v_smfmac_f32_16x16x64_bf16 v[56:59], v[16:19], v[72:79], v0
  s_waitcnt lgkmcnt(2)
  v_smfmac_f32_16x16x64_bf16 v[60:63], v[32:35], a[152:159], v0
  ds_read_b128 v[72:75], v3 offset:15744
  v_smfmac_f32_16x16x64_bf16 v[56:59], v[32:35], a[144:151], v0
  ds_read_b128 v[76:79], v3 offset:15744
  s_waitcnt lgkmcnt(2)
  v_smfmac_f32_16x16x64_bf16 v[60:63], v[16:19], v[36:43], v0
  ds_read_b128 v[36:39], v3 offset:15744
  v_smfmac_f32_16x16x64_bf16 v[64:67], v[24:27], a[96:103], v0
  ds_read_b128 v[40:43], v3 offset:15744
  s_nop 0
  v_smfmac_f32_16x16x64_bf16 v[68:71], v[24:27], a[104:111], v0
  s_nop 1
  v_add_f32 v56, v56, v58
  v_add_f32 v57, v57, v59
  v_add_f32 v60, v60, v62
  v_add_f32 v61, v61, v63
  v_cvt_pk_bf16_f32 v56, v56, v60
  v_cvt_pk_bf16_f32 v57, v57, v61
  v_smfmac_f32_16x16x64_bf16 v[64:67], v[28:31], a[80:87], v0
  ds_write2_b32 v7, v56, v57 offset0:0 offset1:4
  s_waitcnt lgkmcnt(3)
  v_smfmac_f32_16x16x64_bf16 v[68:71], v[28:31], a[88:95], v0
  v_smfmac_f32_16x16x64_bf16 v[64:67], v[32:35], a[64:71], v0
  v_smfmac_f32_16x16x64_bf16 v[68:71], v[32:35], a[72:79], v0
  s_nop 1
  v_smfmac_f32_16x16x64_bf16 v[72:75], v[24:27], v[128:135], v0
  s_nop 1
  v_smfmac_f32_16x16x64_bf16 v[76:79], v[24:27], v[136:143], v0
  s_nop 0
  v_add_f32 v64, v64, v66
  v_add_f32 v65, v65, v67
  v_add_f32 v68, v68, v70
  v_add_f32 v69, v69, v71
  v_cvt_pk_bf16_f32 v52, v64, v68
  v_cvt_pk_bf16_f32 v53, v65, v69
  v_smfmac_f32_16x16x64_bf16 v[72:75], v[28:31], v[112:119], v0
  ds_write2_b32 v8, v52, v53 offset0:0 offset1:4
  v_smfmac_f32_16x16x64_bf16 v[76:79], v[28:31], v[120:127], v0
  v_smfmac_f32_16x16x64_bf16 v[72:75], v[32:35], v[96:103], v0
  v_smfmac_f32_16x16x64_bf16 v[76:79], v[32:35], v[104:111], v0
  ds_read_b128 v[32:35], v3 offset:15744
  v_smfmac_f32_16x16x64_bf16 v[72:75], v[16:19], v[160:167], v0
  s_waitcnt lgkmcnt(1)
  s_barrier
  ds_read_b128 v[60:63], v1 offset:10240
  v_smfmac_f32_16x16x64_bf16 v[76:79], v[16:19], v[168:175], v0
  ds_read_b128 v[56:59], v1 offset:9216
  ds_read_b128 v[16:19], v2 offset:3072
  v_smfmac_f32_16x16x64_bf16 v[72:75], v[20:23], v[144:151], v0
  ds_read_b128 v[68:71], v1 offset:12288
  v_smfmac_f32_16x16x64_bf16 v[76:79], v[20:23], v[152:159], v0
  ds_read_b128 v[24:27], v3 offset:10240
  ds_read_b128 v[28:31], v3 offset:10752
  s_waitcnt lgkmcnt(4)
  s_waitcnt vmcnt(2)
  v_smfmac_f32_16x16x64_bf16 v[40:43], v[60:63], v[44:51], v0
  ds_read_b128 v[20:23], v2 offset:2048
  v_smfmac_f32_16x16x64_bf16 v[36:39], v[56:59], v[44:51], v0
  ds_read_b128 v[60:63], v3 offset:9728
  s_waitcnt lgkmcnt(5)
  v_smfmac_f32_16x16x64_bf16 v[72:75], v[16:19], v[80:87], v0
  buffer_load_dwordx4 v[44:47], v12, s[36:39], s86 offen sc1
  ds_read_b128 v[56:59], v3 offset:9216
  v_smfmac_f32_16x16x64_bf16 v[76:79], v[16:19], v[88:95], v0
  buffer_load_dwordx4 v[48:51], v12, s[36:39], s86 offen offset:256 sc1
  ds_read_b128 v[64:67], v1 offset:11264
  v_add_f32 v40, v40, v42
  v_add_f32 v41, v41, v43
  v_add_f32 v36, v36, v38
  v_add_f32 v37, v37, v39
  v_lshlrev_b32 v6, 3, v2
  v_add_f32_dpp v36, v40, v36 row_ror:8 row_mask:0xf bank_mask:0xf
  v_add_f32_dpp v37, v41, v37 row_ror:8 row_mask:0xf bank_mask:0xf
  s_mov_b64 exec, s[16:17]
  ds_write2_b32 v9, v36, v37 offset0:0 offset1:36
  s_mov_b64 exec, -1
  s_waitcnt lgkmcnt(5)
  v_smfmac_f32_16x16x64_bf16 v[32:35], v[68:71], v[24:31], v0
  ds_read_b128 v[16:19], v2 offset:1024
  s_waitcnt lgkmcnt(5)
  v_smfmac_f32_16x16x64_bf16 v[72:75], v[20:23], a[240:247], v0
  s_mov_b32 m0, 15488
  s_add_u32 s71, s76, 0
  buffer_load_dword v6, s[36:39], s71 offen sc1 lds
  v_smfmac_f32_16x16x64_bf16 v[76:79], v[20:23], a[248:255], v0
  ds_read_b128 v[20:23], v2 offset:0
  s_waitcnt lgkmcnt(3)
  v_smfmac_f32_16x16x64_bf16 v[32:35], v[64:67], v[56:63], v0
  s_mov_b32 m0, 15488
  s_add_u32 s71, s76, 16777216
  buffer_load_dword v6, s[36:39], s71 offen sc1 lds
  s_waitcnt lgkmcnt(2)
  s_barrier
  ds_read_b128 v[36:39], v10 offset:13312
  s_waitcnt lgkmcnt(2)
  v_smfmac_f32_16x16x64_bf16 v[72:75], v[16:19], a[224:231], v0
  ds_read_b128 v[64:67], v3 offset:15744
  v_smfmac_f32_16x16x64_bf16 v[76:79], v[16:19], a[232:239], v0
  ds_read_b128 v[68:71], v3 offset:15744
  v_add_f32 v32, v32, v34
  v_add_f32 v33, v33, v35
  s_waitcnt lgkmcnt(3)
  v_smfmac_f32_16x16x64_bf16 v[72:75], v[20:23], a[208:215], v0
  ds_read_b128 v[24:27], v4 offset:20480
  s_waitcnt lgkmcnt(3)
  v_max3_f32 v56, v36, v37, v38
  v_max3_f32 v57, v39, v32, v33
  v_max_f32 v56, v56, v57
  v_smfmac_f32_16x16x64_bf16 v[76:79], v[20:23], a[216:223], v0
  ds_read_b128 v[28:31], v4 offset:21504
  v_max_f32_dpp v56, v56, v56 row_ror:8 row_mask:0xf bank_mask:0xf
  v_mov_b32 v57, v56
  s_nop 1
  v_permlane16_swap_b32 v56, v57
  v_max_f32 v56, v56, v57
  v_mov_b32 v57, v56
  s_add_u32 s87, s87, 131072
  s_nop 0
  v_permlane32_swap_b32 v56, v57
  v_max_f32 v56, v56, v57
  v_mul_f32_e64 v56, s92, v56
  v_pk_fma_f32 v[36:37], v[36:37], s[78:79], v[56:57] op_sel_hi:[1,1,0] neg_lo:[0,0,1] neg_hi:[0,0,1]
  v_pk_fma_f32 v[38:39], v[38:39], s[78:79], v[56:57] op_sel_hi:[1,1,0] neg_lo:[0,0,1] neg_hi:[0,0,1]
  v_pk_fma_f32 v[32:33], v[32:33], s[78:79], v[56:57] op_sel_hi:[1,1,0] neg_lo:[0,0,1] neg_hi:[0,0,1]
  v_exp_f32 v36, v36
  v_exp_f32 v37, v37
  v_exp_f32 v38, v38
  v_exp_f32 v39, v39
  v_exp_f32 v32, v32
  v_exp_f32 v33, v33
  v_pk_add_f32 v[72:73], v[72:73], v[74:75]
  v_pk_add_f32 v[76:77], v[76:77], v[78:79]
  s_waitcnt lgkmcnt(2)
  s_mov_b64 exec, s[16:17]
  v_cvt_pk_bf16_f32 v66, v36, v37
  v_cvt_pk_bf16_f32 v67, v38, v39
  v_cvt_pk_bf16_f32 v64, v32, v33
  s_mov_b64 exec, s[2:3]
  v_cvt_pk_bf16_f32 v68, v36, v37
  v_cvt_pk_bf16_f32 v69, v38, v39
  v_cvt_pk_bf16_f32 v65, v32, v33
  s_mov_b64 exec, -1
  v_cvt_pk_bf16_f32 v42, v72, v73
  v_cvt_pk_bf16_f32 v43, v76, v77
  s_waitcnt vmcnt(2)
  v_mfma_f32_16x16x16_bf16 v[20:23], v[50:51], v[68:69], 0
  v_mov_b32_dpp v16, v68 row_ror:8 row_mask:0xf bank_mask:0xf
  v_mov_b32_dpp v17, v69 row_ror:8 row_mask:0xf bank_mask:0xf
  v_mov_b32_dpp v18, v66 row_ror:8 row_mask:0xf bank_mask:0xf
  v_mov_b32_dpp v19, v67 row_ror:8 row_mask:0xf bank_mask:0xf
  v_add_f32 v58, v36, v37
  v_add_f32 v59, v38, v39
  v_mfma_f32_16x16x32_bf16 v[20:23], v[42:45], v[64:67], v[20:23]
  v_add_f32 v58, v58, v59
  v_add_f32 v59, v32, v33
  v_mfma_f32_16x16x32_bf16 v[20:23], v[46:49], v[16:19], v[20:23]
  v_mov_b64 v[54:55], v[42:43]
  v_add_f32_dpp v58, v58, v58 row_ror:8 row_mask:0xf bank_mask:0xf
  v_add_f32 v58, v58, v59
  v_mov_b32 v59, v58
  v_mov_b64 v[72:73], 0
  v_mov_b64 v[74:75], 0
  v_permlane16_swap_b32 v58, v59
  v_add_f32 v58, v58, v59
  v_mov_b32 v59, v58
  v_mov_b64 v[76:77], 0
  v_mov_b64 v[78:79], 0
  v_permlane32_swap_b32 v58, v59
  v_add_f32 v58, v58, v59
  v_rcp_f32_e64 v58, v58
  s_nop 0
  v_pk_mul_f32 v[20:21], v[20:21], v[58:59] op_sel_hi:[1,0]
  v_pk_mul_f32 v[22:23], v[22:23], v[58:59] op_sel_hi:[1,0]
  v_cvt_pk_bf16_f32 v60, v20, v21
  v_cvt_pk_bf16_f32 v61, v22, v23
  ds_write_b64 v2, v[60:61] offset:10248
  v_mov_b64 v[64:65], 0
  v_mov_b64 v[66:67], 0
  v_mov_b64 v[68:69], 0
  v_mov_b64 v[70:71], 0
  ds_read_b128 v[36:39], v4 offset:22528
  v_mov_b64 v[16:17], 0
  v_mov_b64 v[18:19], 0
  v_mov_b64 v[20:21], 0
  v_mov_b64 v[22:23], 0
  ds_read_b128 v[40:43], v4 offset:23552
  v_mov_b64 v[32:33], 0
  v_mov_b64 v[34:35], 0
  v_mov_b64 v[44:45], 0
  v_mov_b64 v[46:47], 0
  v_mov_b64 v[48:49], 0
  v_mov_b64 v[50:51], 0
  s_waitcnt lgkmcnt(2)
  s_barrier
  ds_read_b128 v[56:59], v1 offset:9216
  ds_read_b128 v[60:63], v1 offset:10240
  s_add_u32 s71, s81, 131072
  s_mov_b32 s89, s82
  s_and_b32 s95, s73, 1
  s_mov_b32 s72, 32768
  s_waitcnt lgkmcnt(1)
  v_smfmac_f32_16x16x64_bf16 v[64:67], v[56:59], v[24:31], v0
  ds_read_b128 v[24:27], v4 offset:24576
  v_smfmac_f32_16x16x64_bf16 v[68:71], v[56:59], v[36:43], v0
  ds_read_b128 v[28:31], v4 offset:25600
  s_waitcnt lgkmcnt(2)
  v_smfmac_f32_16x16x64_bf16 v[64:67], v[60:63], v[176:183], v0
  ds_read_b128 v[36:39], v4 offset:26624
  v_smfmac_f32_16x16x64_bf16 v[68:71], v[60:63], v[184:191], v0
  ds_read_b128 v[40:43], v4 offset:27648
  v_smfmac_f32_16x16x64_bf16 v[72:75], v[60:63], v[192:199], v0
  v_smfmac_f32_16x16x64_bf16 v[76:79], v[60:63], v[200:207], v0
  s_waitcnt lgkmcnt(2)
  v_smfmac_f32_16x16x64_bf16 v[72:75], v[56:59], v[24:31], v0
  ds_read_b128 v[24:27], v4 offset:28672
  v_smfmac_f32_16x16x64_bf16 v[20:23], v[56:59], v[240:247], v0
  ds_read_b128 v[28:31], v4 offset:29696
  s_waitcnt lgkmcnt(2)
  v_smfmac_f32_16x16x64_bf16 v[76:79], v[56:59], v[36:43], v0
  ds_read_b128 v[36:39], v4 offset:30720
  v_smfmac_f32_16x16x64_bf16 v[20:23], v[60:63], v[248:255], v0
  ds_read_b128 v[40:43], v4 offset:31744
  v_smfmac_f32_16x16x64_bf16 v[16:19], v[60:63], v[208:215], v0
  v_smfmac_f32_16x16x64_bf16 v[32:35], v[60:63], v[216:223], v0
  v_add_f32 v64, v64, v66
  v_add_f32 v65, v65, v67
  v_cvt_pk_bf16_f32 v64, v64, v65
  v_and_or_b32 v64, v64, -2, s95
  v_pk_add_f32 v[68:69], v[68:69], v[70:71]
  v_cvt_pk_bf16_f32 v65, v68, v69
  v_pk_add_f32 v[72:73], v[72:73], v[74:75]
  v_cvt_pk_bf16_f32 v66, v72, v73
  v_pk_add_f32 v[76:77], v[76:77], v[78:79]
  v_cvt_pk_bf16_f32 v67, v76, v77
  s_waitcnt lgkmcnt(2)
  v_smfmac_f32_16x16x64_bf16 v[16:19], v[56:59], v[24:31], v0
  buffer_store_dwordx4 v[64:67], v13, s[36:39], s81 offen
  ds_read_b128 v[72:75], v4 offset:32768
  ds_read_b128 v[76:79], v4 offset:33792
  v_add_f32 v20, v20, v22
  v_add_f32 v21, v21, v23
  v_cvt_pk_bf16_f32 v20, v20, v21
  v_and_or_b32 v20, v20, -2, s95
  s_waitcnt lgkmcnt(2)
  v_smfmac_f32_16x16x64_bf16 v[32:35], v[56:59], v[36:43], v0
  ds_read_b128 v[64:67], v4 offset:34816
  ds_read_b128 v[68:71], v4 offset:35840
  buffer_store_dword v20, v14, s[36:39], s81 offen
  v_smfmac_f32_16x16x64_bf16 v[44:47], v[60:63], v[224:231], v0
  v_smfmac_f32_16x16x64_bf16 v[48:51], v[60:63], v[232:239], v0
  s_waitcnt lgkmcnt(2)
  v_smfmac_f32_16x16x64_bf16 v[44:47], v[56:59], v[72:79], v0
  s_waitcnt lgkmcnt(0)
  v_smfmac_f32_16x16x64_bf16 v[48:51], v[56:59], v[64:71], v0
  s_nop 0
  v_add_f32 v16, v16, v18
  v_add_f32_e64 v17, v17, v19
  v_cvt_pk_bf16_f32 v16, v16, v17
  v_and_or_b32 v16, v16, -2, s95
  v_pk_add_f32 v[32:33], v[32:33], v[34:35]
  v_cvt_pk_bf16_f32 v17, v32, v33
  v_pk_add_f32 v[44:45], v[44:45], v[46:47]
  v_cvt_pk_bf16_f32 v18, v44, v45
  v_pk_add_f32 v[48:49], v[48:49], v[50:51]
  v_cvt_pk_bf16_f32 v19, v48, v49
  buffer_store_dwordx4 v[16:19], v13, s[36:39], s71 offen
  s_cmp_lt_u32 s73, 99
  s_cbranch_scc1 L_T_NOEF3
  s_mov_b64 exec, 1
  v_mov_b32 v6, s73
  buffer_store_dword v6, v2, s[36:39], s88 offen offset:4 sc1
  s_mov_b64 exec, -1
L_T_NOEF3:
  ds_read_b128 v[36:39], v4 offset:14336
  ds_read_b128 v[40:43], v4 offset:15360
  v_lshrrev_b32 v34, 2, v2
  v_bfe_u32 v6, v2, 9, 1
  v_lshlrev_b32 v33, 7, v6
  v_bfe_u32 v6, v2, 6, 1
  v_lshl_add_u32 v33, v6, 6, v33
  v_bfe_u32 v6, v2, 7, 2
  v_lshl_add_u32 v33, v6, 4, v33
  v_bfe_u32 v6, v2, 4, 2
  v_lshl_add_u32 v33, v6, 2, v33
  v_mov_b64 v[56:57], 0
  v_mov_b64 v[58:59], 0
  v_mov_b64 v[60:61], 0
  v_mov_b64_e64 v[62:63], 0
  s_add_u32 s75, s73, 4
  s_min_u32 s75, s75, 63
  s_add_u32 s76, s86, 786432
  s_mov_b64 exec, 0xff
  v_cmp_gt_u32 vcc, s75, v5
  s_cbranch_vccz TFD_10
  s_mov_b32 s72, 32768
TF_9:
  buffer_load_dword v5, v2, s[36:39], s94 offen offset:0 sc1
  s_waitcnt vmcnt(0)
  v_cmp_gt_u32 vcc, s75, v5
  s_cbranch_vccz TFD_10
  s_sub_u32 s72, s72, 1
  s_cmp_lg_u32 s72, 0
  s_cbranch_scc1 TF_9
  s_mov_b32 s68, 3
  s_branch L_ABORT
TFD_10:
  s_cmp_lg_u32 s73, 20
  s_cbranch_scc1 L_T_NOI3
  s_mov_b64 exec, 1
  s_mov_b32 s72, 32768
WC_11:
  buffer_load_dword v6, v2, s[40:43], 0 offen offset:204 sc1
  s_waitcnt vmcnt(0)
  v_cmp_gt_u32 vcc, 160, v6
  s_cbranch_vccz WCD_12
  s_sleep 2
  s_sub_u32 s72, s72, 1
  s_cmp_lg_u32 s72, 0
  s_cbranch_scc1 WC_11
  s_mov_b32 s68, 6
  s_branch L_ABORT
WCD_12:
L_T_NOI3:
  s_mov_b64 exec, -1
  s_mov_b32 s71, s85
  s_mov_b32 s85, s83
  s_mov_b32 s83, s84
  s_mov_b32 s84, s71
  s_add_u32 s73, s73, 1
  s_add_u32 s86, s86, 262144
  s_add_u32 s89, s83, 4096
  s_add_u32 s71, s83, 8192
  s_mov_b32 s72, 32768
  ds_read_b128 v[24:27], v4 offset:12288
  ds_read_b128 v[28:31], v4 offset:13312
  ds_read_b128 v[72:75], v4 offset:8192
  ds_read_b128 v[76:79], v4 offset:9216
  v_mov_b64 v[64:65], 0
  v_mov_b64 v[66:67], 0
  v_mov_b64 v[68:69], 0
  v_mov_b64 v[70:71], 0
  s_barrier
  s_branch L_T_LOOP3
L_T_POLL2B3:
  buffer_load_dwordx4 v[20:23], v15, s[36:39], s89 offen offset:3072 sc1
  buffer_load_dword v35, v34, s[36:39], s71 offen offset:768 sc1
  s_sub_u32 s72, s72, 1
  s_cmp_eq_u32 s72, 0
  s_cbranch_scc1 L_T_TO2
  s_branch L_T_CHK2B3
L_T_LAST3:
  s_waitcnt lgkmcnt(0)
  buffer_store_dwordx4 v[52:55], v2, s[36:39], s87 offen offset:3072 sc1
  s_nop 5
  ds_read_b128 v[24:27], v2 offset:2048
  ds_read_b128 v[28:31], v2 offset:6144
  ds_read_b128 v[32:35], v2 offset:1024
  ds_read_b128 v[36:39], v2 offset:5120
  ds_read_b128 v[40:43], v2 offset:0
  ds_read_b128 v[56:59], v2 offset:4096
  ds_read_b128 v[60:63], v2 offset:8192
  v_mov_b64 v[72:73], 0
  v_mov_b64 v[74:75], 0
  v_mov_b64 v[76:77], 0
  v_mov_b64 v[78:79], 0
  s_add_u32 s87, s87, 131072
  v_smfmac_f32_16x16x64_bf16 v[64:67], v[20:23], a[112:119], v0
  v_smfmac_f32_16x16x64_bf16 v[68:71], v[20:23], a[120:127], v0
  v_smfmac_f32_16x16x64_bf16 v[72:75], v[16:19], v[80:87], v0
  v_smfmac_f32_16x16x64_bf16 v[76:79], v[16:19], v[88:95], v0
  v_smfmac_f32_16x16x64_bf16 v[72:75], v[20:23], v[144:151], v0
  v_smfmac_f32_16x16x64_bf16 v[76:79], v[20:23], v[152:159], v0
  s_waitcnt lgkmcnt(6)
  v_smfmac_f32_16x16x64_bf16 v[64:67], v[24:27], a[32:39], v0
  v_smfmac_f32_16x16x64_bf16 v[68:71], v[24:27], a[40:47], v0
  v_smfmac_f32_16x16x64_bf16 v[72:75], v[24:27], a[240:247], v0
  v_smfmac_f32_16x16x64_bf16 v[76:79], v[24:27], a[248:255], v0
  s_waitcnt lgkmcnt(5)
  v_smfmac_f32_16x16x64_bf16 v[64:67], v[28:31], a[96:103], v0
  v_smfmac_f32_16x16x64_bf16 v[68:71], v[28:31], a[104:111], v0
  v_smfmac_f32_16x16x64_bf16 v[72:75], v[28:31], v[128:135], v0
  v_smfmac_f32_16x16x64_bf16 v[76:79], v[28:31], v[136:143], v0
  s_waitcnt lgkmcnt(4)
  v_smfmac_f32_16x16x64_bf16 v[64:67], v[32:35], a[16:23], v0
  v_smfmac_f32_16x16x64_bf16 v[68:71], v[32:35], a[24:31], v0
  v_smfmac_f32_16x16x64_bf16 v[72:75], v[32:35], a[224:231], v0
  v_smfmac_f32_16x16x64_bf16 v[76:79], v[32:35], a[232:239], v0
  s_waitcnt lgkmcnt(3)
  v_smfmac_f32_16x16x64_bf16 v[64:67], v[36:39], a[80:87], v0
  v_smfmac_f32_16x16x64_bf16 v[68:71], v[36:39], a[88:95], v0
  v_smfmac_f32_16x16x64_bf16 v[72:75], v[36:39], v[112:119], v0
  v_smfmac_f32_16x16x64_bf16 v[76:79], v[36:39], v[120:127], v0
  s_waitcnt lgkmcnt(2)
  v_smfmac_f32_16x16x64_bf16 v[64:67], v[40:43], a[0:7], v0
  v_smfmac_f32_16x16x64_bf16 v[68:71], v[40:43], a[8:15], v0
  v_smfmac_f32_16x16x64_bf16 v[72:75], v[40:43], a[208:215], v0
  v_smfmac_f32_16x16x64_bf16 v[76:79], v[40:43], a[216:223], v0
  s_waitcnt lgkmcnt(1)
  v_smfmac_f32_16x16x64_bf16 v[64:67], v[56:59], a[64:71], v0
  v_smfmac_f32_16x16x64_bf16 v[68:71], v[56:59], a[72:79], v0
  v_smfmac_f32_16x16x64_bf16 v[72:75], v[56:59], v[96:103], v0
  v_smfmac_f32_16x16x64_bf16 v[76:79], v[56:59], v[104:111], v0
  s_waitcnt lgkmcnt(0)
  v_smfmac_f32_16x16x64_bf16 v[64:67], v[60:63], a[128:135], v0
  v_smfmac_f32_16x16x64_bf16 v[68:71], v[60:63], a[136:143], v0
  v_smfmac_f32_16x16x64_bf16 v[72:75], v[60:63], v[160:167], v0
  v_smfmac_f32_16x16x64_bf16 v[76:79], v[60:63], v[168:175], v0
  s_nop 4
  v_add_f32 v64, v64, v66
  v_add_f32 v65, v65, v67
  v_add_f32 v68, v68, v70
  v_add_f32 v69, v69, v71
  v_add_f32 v72, v72, v74
  v_add_f32 v73, v73, v75
  v_add_f32 v76, v76, v78
  v_add_f32 v77, v77, v79
  v_cvt_pk_bf16_f32 v52, v64, v68
  v_cvt_pk_bf16_f32 v53, v65, v69
  v_cvt_pk_bf16_f32 v54, v72, v73
  v_cvt_pk_bf16_f32 v55, v76, v77
  buffer_store_dwordx4 v[52:55], v2, s[36:39], s87 offen offset:3072 sc1
  s_waitcnt vmcnt(0)
  s_barrier
  s_endpgm
L_T_TO1:
  s_mov_b32 s68, 0x04
  s_branch L_ABORT
L_T_TO2:
  s_mov_b32 s68, 0x05
  s_branch L_ABORT
L_ROLE_P:
  s_mov_b32 s44, s8
  s_and_b32 s45, s9, 0xffff
  s_mov_b32 s46, 4718592
  s_mov_b32 s47, 0x20000
  s_mov_b32 s48, s10
  s_and_b32 s49, s11, 0xffff
  s_mov_b32 s50, 4718592
  s_mov_b32 s51, 0x20000
  s_mov_b32 s52, s12
  s_and_b32 s53, s13, 0xffff
  s_mov_b32 s54, 4718592
  s_mov_b32 s55, 0x20000
  v_mov_b32 v6, 0
  s_lshl_b32 s76, s65, 1
  s_add_u32 s76, s76, s67
  s_lshl_b32 s76, s76, 6
  s_add_u32 s76, s76, 0
  v_lshlrev_b32 v4, 4, v0
  s_mov_b64 exec, 15
  buffer_store_dword v6, v4, s[36:39], s76 offen sc1
  s_mov_b64 exec, -1
  s_lshl_b32 s71, s64, 4
  s_add_u32 s76, s76, s71
  v_lshrrev_b32 v7, 4, v0
  v_lshlrev_b32 v1, 13, v7
  v_and_b32 v7, 15, v0
  v_lshl_add_u32 v1, v7, 4, v1
  s_lshl_b32 s70, s64, 12
  s_lshl_b32 s72, s65, 8
  s_lshl_b32 s71, s64, 17
  s_add_u32 s72, s72, s71
  v_lshrrev_b32 v7, 5, v0
  v_lshlrev_b32 v7, 3, v7
  v_bfe_u32 v8, v0, 2, 2
  v_add_u32 v7, v7, v8
  v_lshlrev_b32 v7, 8, v7
  s_lshl_b32 s71, s64, 6
  v_add_u32 v7, s71, v7
  v_bfe_u32 v8, v0, 4, 1
  v_lshl_add_u32 v7, v8, 5, v7
  v_and_b32 v8, 3, v0
  v_lshl_add_u32 v3, v8, 3, v7
  v_and_b32_e64 v8, 1, v0
  v_lshl_add_u32 v7, v8, 4, v7
  v_bfe_u32 v8, v0, 1, 1
  v_lshl_add_u32 v2, v8, 3, v7
  v_lshrrev_b32 v15, 1, v0
  v_lshlrev_b32 v15, 13, v15
  v_and_b32_e64 v16, 1, v0
  v_lshl_add_u32 v15, v16, 7, v15
  s_and_b32 s71, s65, 3
  s_lshl_b32 s71, s71, 2
  s_lshr_b32 s79, 0x21f0, s71
  s_and_b32 s79, s79, 15
  s_mul_i32 s71, s64, 3
  s_add_u32 s79, s79, s71
  s_and_b32 s78, s65, 28
  s_add_u32 s78, s78, 1
  s_lshl_b32 s78, s78, 8
  s_add_u32 m0, s70, 0
  s_add_u32 s71, s72, 0
  buffer_load_dwordx4 v1, s[48:51], s71 offen lds
  s_add_u32 m0, s70, 1024
  s_add_u32 s71, s72, 32768
  buffer_load_dwordx4 v1, s[48:51], s71 offen lds
  s_add_u32 m0, s70, 2048
  s_add_u32 s71, s72, 65536
  buffer_load_dwordx4 v1, s[48:51], s71 offen lds
  s_add_u32 m0, s70, 3072
  s_add_u32 s71, s72, 98304
  buffer_load_dwordx4 v1, s[48:51], s71 offen lds
  s_add_u32 m0, s70, 16384
  s_add_u32 s71, s72, 524288
  buffer_load_dwordx4 v1, s[48:51], s71 offen lds
  s_add_u32 m0, s70, 17408
  s_add_u32 s71, s72, 557056
  buffer_load_dwordx4 v1, s[48:51], s71 offen lds
  s_add_u32 m0, s70, 18432
  s_add_u32 s71, s72, 589824
  buffer_load_dwordx4 v1, s[48:51], s71 offen lds
  s_add_u32 m0, s70, 19456
  s_add_u32 s71, s72, 622592
  buffer_load_dwordx4 v1, s[48:51], s71 offen lds
  s_add_u32 m0, s70, 32768
  s_add_u32 s71, s72, 1048576
  buffer_load_dwordx4 v1, s[48:51], s71 offen lds
  s_add_u32 m0, s70, 33792
  s_add_u32 s71, s72, 1081344
  buffer_load_dwordx4 v1, s[48:51], s71 offen lds
  s_add_u32 m0, s70, 34816
  s_add_u32 s71, s72, 1114112
  buffer_load_dwordx4 v1, s[48:51], s71 offen lds
  s_add_u32 m0, s70, 35840
  s_add_u32 s71, s72, 1146880
  buffer_load_dwordx4 v1, s[48:51], s71 offen lds
  s_add_u32 m0, s70, 49152
  s_add_u32 s71, s72, 1572864
  buffer_load_dwordx4 v1, s[48:51], s71 offen lds
  s_add_u32 m0, s70, 50176
  s_add_u32 s71, s72, 1605632
  buffer_load_dwordx4 v1, s[48:51], s71 offen lds
  s_add_u32 m0, s70, 51200
  s_add_u32 s71, s72, 1638400
  buffer_load_dwordx4 v1, s[48:51], s71 offen lds
  s_add_u32 m0, s70, 52224
  s_add_u32 s71, s72, 1671168
  buffer_load_dwordx4 v1, s[48:51], s71 offen lds
  s_add_u32 m0, s70, 65536
  s_add_u32 s71, s72, 2097152
  buffer_load_dwordx4 v1, s[48:51], s71 offen lds
  s_add_u32 m0, s70, 66560
  s_add_u32 s71, s72, 2129920
  buffer_load_dwordx4 v1, s[48:51], s71 offen lds
  s_add_u32 m0, s70, 67584
  s_add_u32 s71, s72, 2162688
  buffer_load_dwordx4 v1, s[48:51], s71 offen lds
  s_add_u32 m0, s70, 68608
  s_add_u32 s71, s72, 2195456
  buffer_load_dwordx4 v1, s[48:51], s71 offen lds
  s_add_u32 m0, s70, 81920
  s_add_u32 s71, s72, 2621440
  buffer_load_dwordx4 v1, s[48:51], s71 offen lds
  s_add_u32 m0, s70, 82944
  s_add_u32 s71, s72, 2654208
  buffer_load_dwordx4 v1, s[48:51], s71 offen lds
  s_add_u32 m0, s70, 83968
  s_add_u32 s71, s72, 2686976
  buffer_load_dwordx4 v1, s[48:51], s71 offen lds
  s_add_u32 m0, s70, 84992
  s_add_u32 s71, s72, 2719744
  buffer_load_dwordx4 v1, s[48:51], s71 offen lds
  s_add_u32 m0, s70, 98304
  s_add_u32 s71, s72, 3145728
  buffer_load_dwordx4 v1, s[48:51], s71 offen lds
  s_add_u32 m0, s70, 99328
  s_add_u32 s71, s72, 3178496
  buffer_load_dwordx4 v1, s[48:51], s71 offen lds
  s_add_u32 m0, s70, 100352
  s_add_u32 s71, s72, 3211264
  buffer_load_dwordx4 v1, s[48:51], s71 offen lds
  s_add_u32 m0, s70, 101376
  s_add_u32 s71, s72, 3244032
  buffer_load_dwordx4 v1, s[48:51], s71 offen lds
  s_add_u32 m0, s70, 114688
  s_add_u32 s71, s72, 3670016
  buffer_load_dwordx4 v1, s[48:51], s71 offen lds
  s_add_u32 m0, s70, 115712
  s_add_u32 s71, s72, 3702784
  buffer_load_dwordx4 v1, s[48:51], s71 offen lds
  s_add_u32 m0, s70, 116736
  s_add_u32 s71, s72, 3735552
  buffer_load_dwordx4 v1, s[48:51], s71 offen lds
  s_add_u32 m0, s70, 117760
  s_add_u32 s71, s72, 3768320
  buffer_load_dwordx4 v1, s[48:51], s71 offen lds
  s_add_u32 m0, s70, 131072
  s_add_u32 s71, s72, 4194304
  buffer_load_dwordx4 v1, s[48:51], s71 offen lds
  s_add_u32 m0, s70, 132096
  s_add_u32 s71, s72, 4227072
  buffer_load_dwordx4 v1, s[48:51], s71 offen lds
  s_add_u32 m0, s70, 133120
  s_add_u32 s71, s72, 4259840
  buffer_load_dwordx4 v1, s[48:51], s71 offen lds
  s_add_u32 m0, s70, 134144
  s_add_u32 s71, s72, 4292608
  buffer_load_dwordx4 v1, s[48:51], s71 offen lds
  s_waitcnt vmcnt(32) lgkmcnt(0)
  s_barrier
  v_add_u32_e64 v9, 0, v2
  ds_read_b64_tr_b16 a[0:1], v9 offset:0
  ds_read_b64_tr_b16 a[2:3], v9 offset:1024
  ds_read_b64_tr_b16 a[4:5], v9 offset:4096
  ds_read_b64_tr_b16 a[6:7], v9 offset:5120
  ds_read_b64_tr_b16 a[8:9], v9 offset:8192
  ds_read_b64_tr_b16 a[10:11], v9 offset:9216
  ds_read_b64_tr_b16 a[12:13], v9 offset:12288
  ds_read_b64_tr_b16 a[14:15], v9 offset:13312
  s_waitcnt vmcnt(28) lgkmcnt(0)
  s_barrier
  s_add_u32 m0, s70, 0
  s_add_u32 s71, s72, 0
  buffer_load_dwordx4 v1, s[52:55], s71 offen lds
  s_add_u32 m0, s70, 1024
  s_add_u32 s71, s72, 32768
  buffer_load_dwordx4 v1, s[52:55], s71 offen lds
  s_add_u32 m0, s70, 2048
  s_add_u32 s71, s72, 65536
  buffer_load_dwordx4 v1, s[52:55], s71 offen lds
  s_add_u32 m0, s70, 3072
  s_add_u32 s71, s72, 98304
  buffer_load_dwordx4 v1, s[52:55], s71 offen lds
  v_add_u32 v9, 16384, v2
  ds_read_b64_tr_b16 a[16:17], v9 offset:0
  ds_read_b64_tr_b16 a[18:19], v9 offset:1024
  ds_read_b64_tr_b16 a[20:21], v9 offset:4096
  ds_read_b64_tr_b16 a[22:23], v9 offset:5120
  ds_read_b64_tr_b16 a[24:25], v9 offset:8192
  ds_read_b64_tr_b16 a[26:27], v9 offset:9216
  ds_read_b64_tr_b16 a[28:29], v9 offset:12288
  ds_read_b64_tr_b16 a[30:31], v9 offset:13312
  s_waitcnt vmcnt(28) lgkmcnt(0)
  s_barrier
  s_add_u32 m0, s70, 16384
  s_add_u32 s71, s72, 524288
  buffer_load_dwordx4 v1, s[52:55], s71 offen lds
  s_add_u32 m0, s70, 17408
  s_add_u32 s71, s72, 557056
  buffer_load_dwordx4 v1, s[52:55], s71 offen lds
  s_add_u32 m0, s70, 18432
  s_add_u32 s71, s72, 589824
  buffer_load_dwordx4 v1, s[52:55], s71 offen lds
  s_add_u32 m0, s70, 19456
  s_add_u32 s71, s72, 622592
  buffer_load_dwordx4 v1, s[52:55], s71 offen lds
  v_add_u32 v9, 32768, v2
  ds_read_b64_tr_b16 a[32:33], v9 offset:0
  ds_read_b64_tr_b16 a[34:35], v9 offset:1024
  ds_read_b64_tr_b16 a[36:37], v9 offset:4096
  ds_read_b64_tr_b16 a[38:39], v9 offset:5120
  ds_read_b64_tr_b16 a[40:41], v9 offset:8192
  ds_read_b64_tr_b16 a[42:43], v9 offset:9216
  ds_read_b64_tr_b16 a[44:45], v9 offset:12288
  ds_read_b64_tr_b16 a[46:47], v9 offset:13312
  s_waitcnt vmcnt(28) lgkmcnt(0)
  s_barrier
  s_cmp_lg_u32 s64, 0
  s_cbranch_scc1 AI_13
  v_mov_b32_e64 v7, 1
  s_mov_b64 exec, 1
  buffer_atomic_add v7, v6, s[40:43], 0 offen offset:12
  s_mov_b64 exec, -1
AI_13:
  s_add_u32 m0, s70, 32768
  s_add_u32 s71, s72, 1048576
  buffer_load_dwordx4 v1, s[52:55], s71 offen lds
  s_add_u32 m0, s70, 33792
  s_add_u32 s71, s72, 1081344
  buffer_load_dwordx4 v1, s[52:55], s71 offen lds
  s_add_u32 m0, s70, 34816
  s_add_u32 s71, s72, 1114112
  buffer_load_dwordx4 v1, s[52:55], s71 offen lds
  s_add_u32 m0, s70, 35840
  s_add_u32 s71, s72, 1146880
  buffer_load_dwordx4 v1, s[52:55], s71 offen lds
  v_add_u32 v9, 49152, v2
  ds_read_b64_tr_b16 a[48:49], v9 offset:0
  ds_read_b64_tr_b16 a[50:51], v9 offset:1024
  ds_read_b64_tr_b16 a[52:53], v9 offset:4096
  ds_read_b64_tr_b16 a[54:55], v9 offset:5120
  ds_read_b64_tr_b16 a[56:57], v9 offset:8192
  ds_read_b64_tr_b16 a[58:59], v9 offset:9216
  ds_read_b64_tr_b16 a[60:61], v9 offset:12288
  ds_read_b64_tr_b16 a[62:63], v9 offset:13312
  s_waitcnt vmcnt(28) lgkmcnt(0)
  s_barrier
  s_add_u32 m0, s70, 49152
  s_add_u32 s71, s72, 1572864
  buffer_load_dwordx4 v1, s[52:55], s71 offen lds
  s_add_u32 m0, s70, 50176
  s_add_u32 s71, s72, 1605632
  buffer_load_dwordx4 v1, s[52:55], s71 offen lds
  s_add_u32 m0, s70, 51200
  s_add_u32 s71, s72, 1638400
  buffer_load_dwordx4 v1, s[52:55], s71 offen lds
  s_add_u32 m0, s70, 52224
  s_add_u32 s71, s72, 1671168
  buffer_load_dwordx4 v1, s[52:55], s71 offen lds
  v_add_u32 v9, 65536, v2
  ds_read_b64_tr_b16 a[64:65], v9 offset:0
  ds_read_b64_tr_b16 a[66:67], v9 offset:1024
  ds_read_b64_tr_b16 a[68:69], v9 offset:4096
  ds_read_b64_tr_b16 a[70:71], v9 offset:5120
  ds_read_b64_tr_b16 a[72:73], v9 offset:8192
  ds_read_b64_tr_b16 a[74:75], v9 offset:9216
  ds_read_b64_tr_b16 a[76:77], v9 offset:12288
  ds_read_b64_tr_b16 a[78:79], v9 offset:13312
  s_waitcnt vmcnt(28) lgkmcnt(0)
  s_barrier
  s_add_u32 m0, s70, 65536
  s_add_u32 s71, s72, 2097152
  buffer_load_dwordx4 v1, s[52:55], s71 offen lds
  s_add_u32 m0, s70, 66560
  s_add_u32 s71, s72, 2129920
  buffer_load_dwordx4 v1, s[52:55], s71 offen lds
  s_add_u32 m0, s70, 67584
  s_add_u32 s71, s72, 2162688
  buffer_load_dwordx4 v1, s[52:55], s71 offen lds
  s_add_u32 m0, s70, 68608
  s_add_u32 s71, s72, 2195456
  buffer_load_dwordx4 v1, s[52:55], s71 offen lds
  v_add_u32 v9, 81920, v2
  ds_read_b64_tr_b16 a[80:81], v9 offset:0
  ds_read_b64_tr_b16 a[82:83], v9 offset:1024
  ds_read_b64_tr_b16 a[84:85], v9 offset:4096
  ds_read_b64_tr_b16 a[86:87], v9 offset:5120
  ds_read_b64_tr_b16 a[88:89], v9 offset:8192
  ds_read_b64_tr_b16 a[90:91], v9 offset:9216
  ds_read_b64_tr_b16 a[92:93], v9 offset:12288
  ds_read_b64_tr_b16 a[94:95], v9 offset:13312
  s_waitcnt vmcnt(28) lgkmcnt(0)
  s_barrier
  s_add_u32 m0, s70, 81920
  s_add_u32 s71, s72, 2621440
  buffer_load_dwordx4 v1, s[52:55], s71 offen lds
  s_add_u32 m0, s70, 82944
  s_add_u32 s71, s72, 2654208
  buffer_load_dwordx4 v1, s[52:55], s71 offen lds
  s_add_u32 m0, s70, 83968
  s_add_u32 s71, s72, 2686976
  buffer_load_dwordx4 v1, s[52:55], s71 offen lds
  s_add_u32 m0, s70, 84992
  s_add_u32 s71, s72, 2719744
  buffer_load_dwordx4 v1, s[52:55], s71 offen lds
  s_cmp_lg_u32 s79, 4
  s_cbranch_scc1 HL_14
  s_add_u32 s71, s78, 2621440
  buffer_load_dword v16, v15, s[52:55], s71 offen
HL_14:
  s_cmp_lg_u32 s79, 5
  s_cbranch_scc1 HL_15
  s_add_u32 s71, s78, 2883584
  buffer_load_dword v16, v15, s[52:55], s71 offen
HL_15:
  v_add_u32 v9, 98304, v2
  ds_read_b64_tr_b16 a[96:97], v9 offset:0
  ds_read_b64_tr_b16 a[98:99], v9 offset:1024
  ds_read_b64_tr_b16 a[100:101], v9 offset:4096
  ds_read_b64_tr_b16 a[102:103], v9 offset:5120
  ds_read_b64_tr_b16 a[104:105], v9 offset:8192
  ds_read_b64_tr_b16 a[106:107], v9 offset:9216
  ds_read_b64_tr_b16 a[108:109], v9 offset:12288
  ds_read_b64_tr_b16 a[110:111], v9 offset:13312
  s_waitcnt vmcnt(28) lgkmcnt(0)
  s_barrier
  s_add_u32 m0, s70, 98304
  s_add_u32 s71, s72, 3145728
  buffer_load_dwordx4 v1, s[52:55], s71 offen lds
  s_add_u32 m0, s70, 99328
  s_add_u32 s71, s72, 3178496
  buffer_load_dwordx4 v1, s[52:55], s71 offen lds
  s_add_u32 m0, s70, 100352
  s_add_u32 s71, s72, 3211264
  buffer_load_dwordx4 v1, s[52:55], s71 offen lds
  s_add_u32 m0, s70, 101376
  s_add_u32 s71, s72, 3244032
  buffer_load_dwordx4 v1, s[52:55], s71 offen lds
  s_cmp_lg_u32 s79, 6
  s_cbranch_scc1 HL_16
  s_add_u32 s71, s78, 3145728
  buffer_load_dword v16, v15, s[52:55], s71 offen
HL_16:
  s_cmp_lg_u32 s79, 7
  s_cbranch_scc1 HL_17
  s_add_u32 s71, s78, 3407872
  buffer_load_dword v16, v15, s[52:55], s71 offen
HL_17:
  v_add_u32 v9, 114688, v2
  ds_read_b64_tr_b16 a[112:113], v9 offset:0
  ds_read_b64_tr_b16 a[114:115], v9 offset:1024
  ds_read_b64_tr_b16 a[116:117], v9 offset:4096
  ds_read_b64_tr_b16 a[118:119], v9 offset:5120
  ds_read_b64_tr_b16 a[120:121], v9 offset:8192
  ds_read_b64_tr_b16 a[122:123], v9 offset:9216
  ds_read_b64_tr_b16 a[124:125], v9 offset:12288
  ds_read_b64_tr_b16 a[126:127], v9 offset:13312
  s_waitcnt vmcnt(28) lgkmcnt(0)
  s_barrier
  s_add_u32 m0, s70, 114688
  s_add_u32 s71, s72, 3670016
  buffer_load_dwordx4 v1, s[52:55], s71 offen lds
  s_add_u32 m0, s70, 115712
  s_add_u32 s71, s72, 3702784
  buffer_load_dwordx4 v1, s[52:55], s71 offen lds
  s_add_u32 m0, s70, 116736
  s_add_u32 s71, s72, 3735552
  buffer_load_dwordx4 v1, s[52:55], s71 offen lds
  s_add_u32 m0, s70, 117760
  s_add_u32 s71, s72, 3768320
  buffer_load_dwordx4 v1, s[52:55], s71 offen lds
  s_cmp_lg_u32 s79, 8
  s_cbranch_scc1 HL_18
  s_add_u32 s71, s78, 3670016
  buffer_load_dword v16, v15, s[52:55], s71 offen
HL_18:
  s_cmp_lg_u32 s79, 9
  s_cbranch_scc1 HL_19
  s_add_u32 s71, s78, 3932160
  buffer_load_dword v16, v15, s[52:55], s71 offen
HL_19:
  v_add_u32 v9, 131072, v2
  ds_read_b64_tr_b16 a[128:129], v9 offset:0
  ds_read_b64_tr_b16 a[130:131], v9 offset:1024
  ds_read_b64_tr_b16 a[132:133], v9 offset:4096
  ds_read_b64_tr_b16 a[134:135], v9 offset:5120
  ds_read_b64_tr_b16 a[136:137], v9 offset:8192
  ds_read_b64_tr_b16 a[138:139], v9 offset:9216
  ds_read_b64_tr_b16 a[140:141], v9 offset:12288
  ds_read_b64_tr_b16 a[142:143], v9 offset:13312
  s_waitcnt vmcnt(28) lgkmcnt(0)
  s_barrier
  s_add_u32 m0, s70, 131072
  s_add_u32 s71, s72, 4194304
  buffer_load_dwordx4 v1, s[52:55], s71 offen lds
  s_add_u32 m0, s70, 132096
  s_add_u32 s71, s72, 4227072
  buffer_load_dwordx4 v1, s[52:55], s71 offen lds
  s_add_u32 m0, s70, 133120
  s_add_u32 s71, s72, 4259840
  buffer_load_dwordx4 v1, s[52:55], s71 offen lds
  s_add_u32 m0, s70, 134144
  s_add_u32 s71, s72, 4292608
  buffer_load_dwordx4 v1, s[52:55], s71 offen lds
  s_cmp_lg_u32 s79, 10
  s_cbranch_scc1 HL_20
  s_add_u32 s71, s78, 4194304
  buffer_load_dword v16, v15, s[52:55], s71 offen
HL_20:
  s_cmp_lg_u32 s79, 11
  s_cbranch_scc1 HL_21
  s_add_u32 s71, s78, 4456448
  buffer_load_dword v16, v15, s[52:55], s71 offen
HL_21:
  v_add_u32_e64 v9, 0, v3
  ds_read_b64_tr_b16 a[144:145], v9 offset:0
  ds_read_b64_tr_b16 a[146:147], v9 offset:1024
  ds_read_b64_tr_b16 a[148:149], v9 offset:4096
  ds_read_b64_tr_b16 a[150:151], v9 offset:5120
  ds_read_b64_tr_b16 a[152:153], v9 offset:8192
  ds_read_b64_tr_b16 a[154:155], v9 offset:9216
  ds_read_b64_tr_b16 a[156:157], v9 offset:12288
  ds_read_b64_tr_b16 a[158:159], v9 offset:13312
  s_waitcnt vmcnt(28) lgkmcnt(0)
  s_barrier
  s_add_u32 m0, s70, 0
  s_add_u32 s71, s72, 0
  buffer_load_dwordx4 v1, s[44:47], s71 offen lds
  s_add_u32 m0, s70, 1024
  s_add_u32 s71, s72, 32768
  buffer_load_dwordx4 v1, s[44:47], s71 offen lds
  s_add_u32 m0, s70, 2048
  s_add_u32 s71, s72, 65536
  buffer_load_dwordx4 v1, s[44:47], s71 offen lds
  s_add_u32 m0, s70, 3072
  s_add_u32 s71, s72, 98304
  buffer_load_dwordx4 v1, s[44:47], s71 offen lds
  s_cmp_lg_u32 s79, 0
  s_cbranch_scc1 HL_22
  s_add_u32 s71, s78, 0
  buffer_load_dword v16, v15, s[44:47], s71 offen
HL_22:
  s_cmp_lg_u32 s79, 1
  s_cbranch_scc1 HL_23
  s_add_u32 s71, s78, 262144
  buffer_load_dword v16, v15, s[44:47], s71 offen
HL_23:
  v_add_u32 v9, 16384, v3
  ds_read_b64_tr_b16 a[160:161], v9 offset:0
  ds_read_b64_tr_b16 a[162:163], v9 offset:1024
  ds_read_b64_tr_b16 a[164:165], v9 offset:4096
  ds_read_b64_tr_b16 a[166:167], v9 offset:5120
  ds_read_b64_tr_b16 a[168:169], v9 offset:8192
  ds_read_b64_tr_b16 a[170:171], v9 offset:9216
  ds_read_b64_tr_b16 a[172:173], v9 offset:12288
  ds_read_b64_tr_b16 a[174:175], v9 offset:13312
  s_waitcnt vmcnt(28) lgkmcnt(0)
  s_barrier
  s_add_u32 m0, s70, 16384
  s_add_u32 s71, s72, 524288
  buffer_load_dwordx4 v1, s[44:47], s71 offen lds
  s_add_u32 m0, s70, 17408
  s_add_u32 s71, s72, 557056
  buffer_load_dwordx4 v1, s[44:47], s71 offen lds
  s_add_u32 m0, s70, 18432
  s_add_u32 s71, s72, 589824
  buffer_load_dwordx4 v1, s[44:47], s71 offen lds
  s_add_u32 m0, s70, 19456
  s_add_u32 s71, s72, 622592
  buffer_load_dwordx4 v1, s[44:47], s71 offen lds
  s_cmp_lg_u32 s79, 2
  s_cbranch_scc1 HL_24
  s_add_u32 s71, s78, 524288
  buffer_load_dword v16, v15, s[44:47], s71 offen
HL_24:
  s_cmp_lg_u32 s79, 3
  s_cbranch_scc1 HL_25
  s_add_u32 s71, s78, 786432
  buffer_load_dword v16, v15, s[44:47], s71 offen
HL_25:
  v_add_u32 v9, 32768, v3
  ds_read_b64_tr_b16 a[176:177], v9 offset:0
  ds_read_b64_tr_b16 a[178:179], v9 offset:1024
  ds_read_b64_tr_b16 a[180:181], v9 offset:4096
  ds_read_b64_tr_b16 a[182:183], v9 offset:5120
  ds_read_b64_tr_b16 a[184:185], v9 offset:8192
  ds_read_b64_tr_b16 a[186:187], v9 offset:9216
  ds_read_b64_tr_b16 a[188:189], v9 offset:12288
  ds_read_b64_tr_b16 a[190:191], v9 offset:13312
  s_waitcnt vmcnt(28) lgkmcnt(0)
  s_barrier
  s_add_u32 m0, s70, 32768
  s_add_u32 s71, s72, 1048576
  buffer_load_dwordx4 v1, s[44:47], s71 offen lds
  s_add_u32 m0, s70, 33792
  s_add_u32 s71, s72, 1081344
  buffer_load_dwordx4 v1, s[44:47], s71 offen lds
  s_add_u32 m0, s70, 34816
  s_add_u32 s71, s72, 1114112
  buffer_load_dwordx4 v1, s[44:47], s71 offen lds
  s_add_u32 m0, s70, 35840
  s_add_u32 s71, s72, 1146880
  buffer_load_dwordx4 v1, s[44:47], s71 offen lds
  s_cmp_lg_u32 s79, 4
  s_cbranch_scc1 HL_26
  s_add_u32 s71, s78, 1048576
  buffer_load_dword v16, v15, s[44:47], s71 offen
HL_26:
  s_cmp_lg_u32 s79, 5
  s_cbranch_scc1 HL_27
  s_add_u32 s71, s78, 1310720
  buffer_load_dword v16, v15, s[44:47], s71 offen
HL_27:
  v_add_u32 v9, 49152, v3
  ds_read_b64_tr_b16 a[192:193], v9 offset:0
  ds_read_b64_tr_b16 a[194:195], v9 offset:1024
  ds_read_b64_tr_b16 a[196:197], v9 offset:4096
  ds_read_b64_tr_b16 a[198:199], v9 offset:5120
  ds_read_b64_tr_b16 a[200:201], v9 offset:8192
  ds_read_b64_tr_b16 a[202:203], v9 offset:9216
  ds_read_b64_tr_b16 a[204:205], v9 offset:12288
  ds_read_b64_tr_b16 a[206:207], v9 offset:13312
  s_waitcnt vmcnt(28) lgkmcnt(0)
  s_barrier
  s_add_u32 m0, s70, 49152
  s_add_u32 s71, s72, 1572864
  buffer_load_dwordx4 v1, s[44:47], s71 offen lds
  s_add_u32 m0, s70, 50176
  s_add_u32 s71, s72, 1605632
  buffer_load_dwordx4 v1, s[44:47], s71 offen lds
  s_add_u32 m0, s70, 51200
  s_add_u32 s71, s72, 1638400
  buffer_load_dwordx4 v1, s[44:47], s71 offen lds
  s_add_u32 m0, s70, 52224
  s_add_u32 s71, s72, 1671168
  buffer_load_dwordx4 v1, s[44:47], s71 offen lds
  s_cmp_lg_u32 s79, 6
  s_cbranch_scc1 HL_28
  s_add_u32 s71, s78, 1572864
  buffer_load_dword v16, v15, s[44:47], s71 offen
HL_28:
  s_cmp_lg_u32 s79, 7
  s_cbranch_scc1 HL_29
  s_add_u32 s71, s78, 1835008
  buffer_load_dword v16, v15, s[44:47], s71 offen
HL_29:
  v_add_u32 v9, 65536, v3
  ds_read_b64_tr_b16 a[208:209], v9 offset:0
  ds_read_b64_tr_b16 a[210:211], v9 offset:1024
  ds_read_b64_tr_b16 a[212:213], v9 offset:4096
  ds_read_b64_tr_b16 a[214:215], v9 offset:5120
  ds_read_b64_tr_b16 a[216:217], v9 offset:8192
  ds_read_b64_tr_b16 a[218:219], v9 offset:9216
  ds_read_b64_tr_b16 a[220:221], v9 offset:12288
  ds_read_b64_tr_b16 a[222:223], v9 offset:13312
  s_waitcnt vmcnt(28) lgkmcnt(0)
  s_barrier
  s_add_u32 m0, s70, 65536
  s_add_u32 s71, s72, 2097152
  buffer_load_dwordx4 v1, s[44:47], s71 offen lds
  s_add_u32 m0, s70, 66560
  s_add_u32 s71, s72, 2129920
  buffer_load_dwordx4 v1, s[44:47], s71 offen lds
  s_add_u32 m0, s70, 67584
  s_add_u32 s71, s72, 2162688
  buffer_load_dwordx4 v1, s[44:47], s71 offen lds
  s_add_u32 m0, s70, 68608
  s_add_u32 s71, s72, 2195456
  buffer_load_dwordx4 v1, s[44:47], s71 offen lds
  s_cmp_lg_u32 s79, 8
  s_cbranch_scc1 HL_30
  s_add_u32 s71, s78, 2097152
  buffer_load_dword v16, v15, s[44:47], s71 offen
HL_30:
  s_cmp_lg_u32 s79, 9
  s_cbranch_scc1 HL_31
  s_add_u32 s71, s78, 2359296
  buffer_load_dword v16, v15, s[44:47], s71 offen
HL_31:
  v_add_u32 v9, 81920, v3
  ds_read_b64_tr_b16 a[224:225], v9 offset:0
  ds_read_b64_tr_b16 a[226:227], v9 offset:1024
  ds_read_b64_tr_b16 a[228:229], v9 offset:4096
  ds_read_b64_tr_b16 a[230:231], v9 offset:5120
  ds_read_b64_tr_b16 a[232:233], v9 offset:8192
  ds_read_b64_tr_b16 a[234:235], v9 offset:9216
  ds_read_b64_tr_b16 a[236:237], v9 offset:12288
  ds_read_b64_tr_b16 a[238:239], v9 offset:13312
  s_waitcnt vmcnt(28) lgkmcnt(0)
  s_barrier
  s_add_u32 m0, s70, 81920
  s_add_u32 s71, s72, 2621440
  buffer_load_dwordx4 v1, s[44:47], s71 offen lds
  s_add_u32 m0, s70, 82944
  s_add_u32 s71, s72, 2654208
  buffer_load_dwordx4 v1, s[44:47], s71 offen lds
  s_add_u32 m0, s70, 83968
  s_add_u32 s71, s72, 2686976
  buffer_load_dwordx4 v1, s[44:47], s71 offen lds
  s_add_u32 m0, s70, 84992
  s_add_u32 s71, s72, 2719744
  buffer_load_dwordx4 v1, s[44:47], s71 offen lds
  s_cmp_lg_u32 s79, 10
  s_cbranch_scc1 HL_32
  s_add_u32 s71, s78, 2621440
  buffer_load_dword v16, v15, s[44:47], s71 offen
HL_32:
  s_cmp_lg_u32 s79, 11
  s_cbranch_scc1 HL_33
  s_add_u32 s71, s78, 2883584
  buffer_load_dword v16, v15, s[44:47], s71 offen
HL_33:
  v_add_u32 v9, 98304, v3
  ds_read_b64_tr_b16 a[240:241], v9 offset:0
  ds_read_b64_tr_b16 a[242:243], v9 offset:1024
  ds_read_b64_tr_b16 a[244:245], v9 offset:4096
  ds_read_b64_tr_b16 a[246:247], v9 offset:5120
  ds_read_b64_tr_b16 a[248:249], v9 offset:8192
  ds_read_b64_tr_b16 a[250:251], v9 offset:9216
  ds_read_b64_tr_b16 a[252:253], v9 offset:12288
  ds_read_b64_tr_b16 a[254:255], v9 offset:13312
  s_waitcnt vmcnt(28) lgkmcnt(0)
  s_barrier
  s_add_u32 m0, s70, 98304
  s_add_u32 s71, s72, 3145728
  buffer_load_dwordx4 v1, s[44:47], s71 offen lds
  s_add_u32 m0, s70, 99328
  s_add_u32 s71, s72, 3178496
  buffer_load_dwordx4 v1, s[44:47], s71 offen lds
  s_add_u32 m0, s70, 100352
  s_add_u32 s71, s72, 3211264
  buffer_load_dwordx4 v1, s[44:47], s71 offen lds
  s_add_u32 m0, s70, 101376
  s_add_u32 s71, s72, 3244032
  buffer_load_dwordx4 v1, s[44:47], s71 offen lds
  s_cmp_lg_u32 s79, 0
  s_cbranch_scc1 HL_34
  s_add_u32 s71, s78, 3145728
  buffer_load_dword v16, v15, s[44:47], s71 offen
HL_34:
  s_cmp_lg_u32 s79, 1
  s_cbranch_scc1 HL_35
  s_add_u32 s71, s78, 3407872
  buffer_load_dword v16, v15, s[44:47], s71 offen
HL_35:
  v_add_u32 v9, 114688, v3
  ds_read_b64_tr_b16 v[80:81], v9 offset:0
  ds_read_b64_tr_b16 v[82:83], v9 offset:1024
  ds_read_b64_tr_b16 v[84:85], v9 offset:4096
  ds_read_b64_tr_b16 v[86:87], v9 offset:5120
  ds_read_b64_tr_b16 v[88:89], v9 offset:8192
  ds_read_b64_tr_b16 v[90:91], v9 offset:9216
  ds_read_b64_tr_b16 v[92:93], v9 offset:12288
  ds_read_b64_tr_b16 v[94:95], v9 offset:13312
  s_waitcnt vmcnt(28) lgkmcnt(0)
  s_barrier
  s_add_u32 m0, s70, 114688
  s_add_u32 s71, s72, 3670016
  buffer_load_dwordx4 v1, s[44:47], s71 offen lds
  s_add_u32 m0, s70, 115712
  s_add_u32 s71, s72, 3702784
  buffer_load_dwordx4 v1, s[44:47], s71 offen lds
  s_add_u32 m0, s70, 116736
  s_add_u32 s71, s72, 3735552
  buffer_load_dwordx4 v1, s[44:47], s71 offen lds
  s_add_u32 m0, s70, 117760
  s_add_u32 s71, s72, 3768320
  buffer_load_dwordx4 v1, s[44:47], s71 offen lds
  s_cmp_lg_u32 s79, 2
  s_cbranch_scc1 HL_36
  s_add_u32 s71, s78, 3670016
  buffer_load_dword v16, v15, s[44:47], s71 offen
HL_36:
  s_cmp_lg_u32 s79, 3
  s_cbranch_scc1 HL_37
  s_add_u32 s71, s78, 3932160
  buffer_load_dword v16, v15, s[44:47], s71 offen
HL_37:
  v_add_u32 v9, 131072, v3
  ds_read_b64_tr_b16 v[96:97], v9 offset:0
  ds_read_b64_tr_b16 v[98:99], v9 offset:1024
  ds_read_b64_tr_b16 v[100:101], v9 offset:4096
  ds_read_b64_tr_b16 v[102:103], v9 offset:5120
  ds_read_b64_tr_b16 v[104:105], v9 offset:8192
  ds_read_b64_tr_b16 v[106:107], v9 offset:9216
  ds_read_b64_tr_b16 v[108:109], v9 offset:12288
  ds_read_b64_tr_b16 v[110:111], v9 offset:13312
  s_waitcnt vmcnt(28) lgkmcnt(0)
  s_barrier
  s_add_u32 m0, s70, 131072
  s_add_u32 s71, s72, 4194304
  buffer_load_dwordx4 v1, s[44:47], s71 offen lds
  s_add_u32 m0, s70, 132096
  s_add_u32 s71, s72, 4227072
  buffer_load_dwordx4 v1, s[44:47], s71 offen lds
  s_add_u32 m0, s70, 133120
  s_add_u32 s71, s72, 4259840
  buffer_load_dwordx4 v1, s[44:47], s71 offen lds
  s_add_u32 m0, s70, 134144
  s_add_u32 s71, s72, 4292608
  buffer_load_dwordx4 v1, s[44:47], s71 offen lds
  s_cmp_lg_u32 s79, 4
  s_cbranch_scc1 HL_38
  s_add_u32 s71, s78, 4194304
  buffer_load_dword v16, v15, s[44:47], s71 offen
HL_38:
  s_cmp_lg_u32 s79, 5
  s_cbranch_scc1 HL_39
  s_add_u32 s71, s78, 4456448
  buffer_load_dword v16, v15, s[44:47], s71 offen
HL_39:
  v_add_u32 v9, 0, v2
  ds_read_b64_tr_b16 v[112:113], v9 offset:0
  ds_read_b64_tr_b16 v[114:115], v9 offset:1024
  ds_read_b64_tr_b16 v[116:117], v9 offset:4096
  ds_read_b64_tr_b16 v[118:119], v9 offset:5120
  ds_read_b64_tr_b16 v[120:121], v9 offset:8192
  ds_read_b64_tr_b16 v[122:123], v9 offset:9216
  ds_read_b64_tr_b16 v[124:125], v9 offset:12288
  ds_read_b64_tr_b16 v[126:127], v9 offset:13312
  s_waitcnt vmcnt(28) lgkmcnt(0)
  s_barrier
  v_add_u32 v9, 16384, v2
  ds_read_b64_tr_b16 v[128:129], v9 offset:0
  ds_read_b64_tr_b16 v[130:131], v9 offset:1024
  ds_read_b64_tr_b16 v[132:133], v9 offset:4096
  ds_read_b64_tr_b16 v[134:135], v9 offset:5120
  ds_read_b64_tr_b16 v[136:137], v9 offset:8192
  ds_read_b64_tr_b16 v[138:139], v9 offset:9216
  ds_read_b64_tr_b16 v[140:141], v9 offset:12288
  ds_read_b64_tr_b16 v[142:143], v9 offset:13312
  s_waitcnt vmcnt(24) lgkmcnt(0)
  s_barrier
  v_add_u32 v9, 32768, v2
  ds_read_b64_tr_b16 v[144:145], v9 offset:0
  ds_read_b64_tr_b16 v[146:147], v9 offset:1024
  ds_read_b64_tr_b16 v[148:149], v9 offset:4096
  ds_read_b64_tr_b16 v[150:151], v9 offset:5120
  ds_read_b64_tr_b16 v[152:153], v9 offset:8192
  ds_read_b64_tr_b16 v[154:155], v9 offset:9216
  ds_read_b64_tr_b16 v[156:157], v9 offset:12288
  ds_read_b64_tr_b16 v[158:159], v9 offset:13312
  s_waitcnt vmcnt(20) lgkmcnt(0)
  s_barrier
  v_add_u32 v9, 49152, v2
  ds_read_b64_tr_b16 v[160:161], v9 offset:0
  ds_read_b64_tr_b16 v[162:163], v9 offset:1024
  ds_read_b64_tr_b16 v[164:165], v9 offset:4096
  ds_read_b64_tr_b16 v[166:167], v9 offset:5120
  ds_read_b64_tr_b16 v[168:169], v9 offset:8192
  ds_read_b64_tr_b16 v[170:171], v9 offset:9216
  ds_read_b64_tr_b16 v[172:173], v9 offset:12288
  ds_read_b64_tr_b16 v[174:175], v9 offset:13312
  s_waitcnt vmcnt(16) lgkmcnt(0)
  s_barrier
  s_getpc_b64 s[60:61]
PC_40:
  s_add_u32 s60, s60, L_P_LOADED-PC_40
  s_addc_u32 s61, s61, 0
  s_and_b32 s61, s61, 0xffff
  s_mov_b32 s62, L_P_END-L_P_LOADED
  s_mov_b32 s63, 0x20000
  v_lshlrev_b32_e64 v13, 7, v0
  s_mul_i32 s97, s64, 8192
  buffer_load_dword v14, v13, s[60:63], s97 offen
  v_add_u32 v9, 65536, v2
  ds_read_b64_tr_b16 v[176:177], v9 offset:0
  ds_read_b64_tr_b16 v[178:179], v9 offset:1024
  ds_read_b64_tr_b16 v[180:181], v9 offset:4096
  ds_read_b64_tr_b16 v[182:183], v9 offset:5120
  ds_read_b64_tr_b16 v[184:185], v9 offset:8192
  ds_read_b64_tr_b16 v[186:187], v9 offset:9216
  ds_read_b64_tr_b16 v[188:189], v9 offset:12288
  ds_read_b64_tr_b16 v[190:191], v9 offset:13312
  s_waitcnt vmcnt(12) lgkmcnt(0)
  s_barrier
  v_add_u32 v9, 81920, v2
  ds_read_b64_tr_b16 v[192:193], v9 offset:0
  ds_read_b64_tr_b16 v[194:195], v9 offset:1024
  ds_read_b64_tr_b16 v[196:197], v9 offset:4096
  ds_read_b64_tr_b16 v[198:199], v9 offset:5120
  ds_read_b64_tr_b16 v[200:201], v9 offset:8192
  ds_read_b64_tr_b16 v[202:203], v9 offset:9216
  ds_read_b64_tr_b16 v[204:205], v9 offset:12288
  ds_read_b64_tr_b16 v[206:207], v9 offset:13312
  s_waitcnt vmcnt(8) lgkmcnt(0)
  s_barrier
  v_add_u32 v9, 98304, v2
  ds_read_b64_tr_b16 v[208:209], v9 offset:0
  ds_read_b64_tr_b16 v[210:211], v9 offset:1024
  ds_read_b64_tr_b16 v[212:213], v9 offset:4096
  ds_read_b64_tr_b16 v[214:215], v9 offset:5120
  ds_read_b64_tr_b16 v[216:217], v9 offset:8192
  ds_read_b64_tr_b16 v[218:219], v9 offset:9216
  ds_read_b64_tr_b16 v[220:221], v9 offset:12288
  ds_read_b64_tr_b16 v[222:223], v9 offset:13312
  s_waitcnt vmcnt(4) lgkmcnt(0)
  s_barrier
  v_add_u32 v9, 114688, v2
  ds_read_b64_tr_b16 v[224:225], v9 offset:0
  ds_read_b64_tr_b16 v[226:227], v9 offset:1024
  ds_read_b64_tr_b16 v[228:229], v9 offset:4096
  ds_read_b64_tr_b16 v[230:231], v9 offset:5120
  ds_read_b64_tr_b16 v[232:233], v9 offset:8192
  ds_read_b64_tr_b16 v[234:235], v9 offset:9216
  ds_read_b64_tr_b16 v[236:237], v9 offset:12288
  ds_read_b64_tr_b16 v[238:239], v9 offset:13312
  s_waitcnt vmcnt(0) lgkmcnt(0)
  s_barrier
  v_add_u32 v9, 131072, v2
  ds_read_b64_tr_b16 v[240:241], v9 offset:0
  ds_read_b64_tr_b16 v[242:243], v9 offset:1024
  ds_read_b64_tr_b16 v[244:245], v9 offset:4096
  ds_read_b64_tr_b16 v[246:247], v9 offset:5120
  ds_read_b64_tr_b16 v[248:249], v9 offset:8192
  ds_read_b64_tr_b16 v[250:251], v9 offset:9216
  ds_read_b64_tr_b16 v[252:253], v9 offset:12288
  ds_read_b64_tr_b16 v[254:255], v9 offset:13312
  s_waitcnt lgkmcnt(0)
  s_barrier
L_P_LOADED:
  s_mov_b32 s77, 32768
WC_41:
  buffer_load_dword v7, v6, s[40:43], 0 offen offset:8 sc1
  s_waitcnt vmcnt(0)
  v_cmp_gt_u32 vcc, 10, v7
  s_cbranch_vccz WCD_42
  s_sleep 2
  s_sub_u32 s77, s77, 1
  s_cmp_lg_u32 s77, 0
  s_cbranch_scc1 WC_41
  s_mov_b32 s68, 18
  s_branch L_ABORT
WCD_42:
  s_barrier
  v_and_b32 v7, 31, v0
  v_lshlrev_b32_e64 v5, 4, v7
  v_lshrrev_b32 v7, 5, v0
  v_lshl_add_u32 v5, v7, 10, v5
  s_mul_i32 s75, s67, 36864
  s_mul_i32 s71, s64, 9216
  s_add_u32 s75, s75, s71
  s_add_u32 s75, s75, 1048576
  s_mov_b32 s70, s71
  s_lshl_b32 s74, s67, 5
  s_add_u32 s74, s74, s65
  s_lshl_b32 s74, s74, 13
  s_lshl_b32 s71, s64, 11
  s_add_u32 s74, s74, s71
  s_mov_b32 s73, s67
  s_cmp_eq_u32 s67, 0
  s_cselect_b32 s79, 64, 64
  s_add_u32 m0, s70, 0
  s_add_u32 s71, s75, 0
  buffer_load_dwordx4 v4, s[36:39], s71 offen sc1 lds
  s_add_u32 m0, s70, 1024
  s_add_u32 s71, s75, 1024
  buffer_load_dwordx4 v4, s[36:39], s71 offen sc1 lds
  s_add_u32 m0, s70, 2048
  s_add_u32 s71, s75, 2048
  buffer_load_dwordx4 v4, s[36:39], s71 offen sc1 lds
  s_add_u32 m0, s70, 3072
  s_add_u32 s71, s75, 3072
  buffer_load_dwordx4 v4, s[36:39], s71 offen sc1 lds
  s_add_u32 m0, s70, 4096
  s_add_u32 s71, s75, 4096
  buffer_load_dwordx4 v4, s[36:39], s71 offen sc1 lds
  s_add_u32 m0, s70, 5120
  s_add_u32 s71, s75, 5120
  buffer_load_dwordx4 v4, s[36:39], s71 offen sc1 lds
  s_add_u32 m0, s70, 6144
  s_add_u32 s71, s75, 6144
  buffer_load_dwordx4 v4, s[36:39], s71 offen sc1 lds
  s_add_u32 m0, s70, 7168
  s_add_u32 s71, s75, 7168
  buffer_load_dwordx4 v4, s[36:39], s71 offen sc1 lds
  s_add_u32 m0, s70, 8192
  s_add_u32 s71, s75, 8192
  buffer_load_dwordx4 v4, s[36:39], s71 offen sc1 lds
  v_mov_b32_e64 v10, v4
  s_waitcnt vmcnt(0)
L_P_LOOP:
  s_waitcnt vmcnt(6)
  s_barrier
  s_xor_b32 s70, s70, 0x10000
  s_cmp_lt_u32 s73, 63
  s_cselect_b32 s78, 2, 1
  s_mul_i32 s71, s78, 36864
  s_add_u32 s75, s75, s71
  ds_read_b128 v[16:19], v10 offset:0
  ds_read_b128 v[20:23], v10 offset:1024
  ds_read_b128 v[24:27], v10 offset:2048
  ds_read_b128 v[28:31], v10 offset:3072
  s_waitcnt lgkmcnt(3)
  v_mfma_f32_32x32x16_bf16 v[32:47], a[0:3], v[16:19], 0
  v_mfma_f32_32x32x16_bf16 v[48:63], v[16:19], a[144:147], 0
  v_mfma_f32_32x32x16_bf16 v[64:79], v[112:115], v[16:19], 0
  ds_read_b128 v[16:19], v10 offset:4096
  s_waitcnt lgkmcnt(3)
  v_mfma_f32_32x32x16_bf16 v[32:47], a[4:7], v[20:23], v[32:47]
  v_mfma_f32_32x32x16_bf16 v[48:63], v[20:23], a[148:151], v[48:63]
  v_mfma_f32_32x32x16_bf16 v[64:79], v[116:119], v[20:23], v[64:79]
  ds_read_b128 v[20:23], v10 offset:5120
  s_waitcnt lgkmcnt(3)
  v_mfma_f32_32x32x16_bf16 v[32:47], a[8:11], v[24:27], v[32:47]
  v_mfma_f32_32x32x16_bf16 v[48:63], v[24:27], a[152:155], v[48:63]
  v_mfma_f32_32x32x16_bf16 v[64:79], v[120:123], v[24:27], v[64:79]
  ds_read_b128 v[24:27], v10 offset:6144
  s_waitcnt lgkmcnt(3)
  v_mfma_f32_32x32x16_bf16 v[32:47], a[12:15], v[28:31], v[32:47]
  v_mfma_f32_32x32x16_bf16 v[48:63], v[28:31], a[156:159], v[48:63]
  v_mfma_f32_32x32x16_bf16 v[64:79], v[124:127], v[28:31], v[64:79]
  ds_read_b128 v[28:31], v10 offset:7168
  s_waitcnt lgkmcnt(3)
  v_mfma_f32_32x32x16_bf16 v[32:47], a[16:19], v[16:19], v[32:47]
  v_mfma_f32_32x32x16_bf16 v[48:63], v[16:19], a[160:163], v[48:63]
  v_mfma_f32_32x32x16_bf16 v[64:79], v[128:131], v[16:19], v[64:79]
  ds_read_b128 v[16:19], v10 offset:8192
  s_waitcnt lgkmcnt(3)
  v_mfma_f32_32x32x16_bf16 v[32:47], a[20:23], v[20:23], v[32:47]
  v_mfma_f32_32x32x16_bf16 v[48:63], v[20:23], a[164:167], v[48:63]
  v_mfma_f32_32x32x16_bf16 v[64:79], v[132:135], v[20:23], v[64:79]
  ds_read_b128 v[20:23], v10 offset:9216
  s_waitcnt lgkmcnt(3)
  v_mfma_f32_32x32x16_bf16 v[32:47], a[24:27], v[24:27], v[32:47]
  v_mfma_f32_32x32x16_bf16 v[48:63], v[24:27], a[168:171], v[48:63]
  v_mfma_f32_32x32x16_bf16 v[64:79], v[136:139], v[24:27], v[64:79]
  ds_read_b128 v[24:27], v10 offset:10240
  s_waitcnt lgkmcnt(3)
  v_mfma_f32_32x32x16_bf16 v[32:47], a[28:31], v[28:31], v[32:47]
  v_mfma_f32_32x32x16_bf16 v[48:63], v[28:31], a[172:175], v[48:63]
  v_mfma_f32_32x32x16_bf16 v[64:79], v[140:143], v[28:31], v[64:79]
  ds_read_b128 v[28:31], v10 offset:11264
  s_waitcnt lgkmcnt(3)
  v_mfma_f32_32x32x16_bf16 v[32:47], a[32:35], v[16:19], v[32:47]
  v_mfma_f32_32x32x16_bf16 v[48:63], v[16:19], a[176:179], v[48:63]
  v_mfma_f32_32x32x16_bf16 v[64:79], v[144:147], v[16:19], v[64:79]
  ds_read_b128 v[16:19], v10 offset:12288
  s_waitcnt lgkmcnt(3)
  v_mfma_f32_32x32x16_bf16 v[32:47], a[36:39], v[20:23], v[32:47]
  v_mfma_f32_32x32x16_bf16 v[48:63], v[20:23], a[180:183], v[48:63]
  v_mfma_f32_32x32x16_bf16 v[64:79], v[148:151], v[20:23], v[64:79]
  ds_read_b128 v[20:23], v10 offset:13312
  s_waitcnt lgkmcnt(3)
  v_mfma_f32_32x32x16_bf16 v[32:47], a[40:43], v[24:27], v[32:47]
  v_mfma_f32_32x32x16_bf16 v[48:63], v[24:27], a[184:187], v[48:63]
  v_mfma_f32_32x32x16_bf16 v[64:79], v[152:155], v[24:27], v[64:79]
  ds_read_b128 v[24:27], v10 offset:14336
  s_waitcnt lgkmcnt(3)
  v_mfma_f32_32x32x16_bf16 v[32:47], a[44:47], v[28:31], v[32:47]
  v_mfma_f32_32x32x16_bf16 v[48:63], v[28:31], a[188:191], v[48:63]
  v_mfma_f32_32x32x16_bf16 v[64:79], v[156:159], v[28:31], v[64:79]
  s_waitcnt vmcnt(0)
  v_mov_b32_e64 v7, s73
  buffer_store_dword v7, v6, s[36:39], s76 offen sc1
  s_lshr_b32 s71, s73, 1
  s_cmp_lg_u32 s71, 4
  s_cbranch_scc1 L_P_NOH
  s_mov_b32 s77, 32768
WC_43:
  buffer_load_dword v8, v6, s[40:43], 0 offen offset:4 sc1
  s_waitcnt vmcnt(0)
  v_cmp_gt_u32 vcc, 54, v8
  s_cbranch_vccz WCD_44
  s_sleep 2
  s_sub_u32 s77, s77, 1
  s_cmp_lg_u32 s77, 0
  s_cbranch_scc1 WC_43
  s_mov_b32 s68, 19
  s_branch L_ABORT
WCD_44:
L_P_NOH:
  ds_read_b128 v[28:31], v10 offset:15360
  s_waitcnt lgkmcnt(3)
  v_mfma_f32_32x32x16_bf16 v[32:47], a[48:51], v[16:19], v[32:47]
  v_mfma_f32_32x32x16_bf16 v[48:63], v[16:19], a[192:195], v[48:63]
  v_mfma_f32_32x32x16_bf16 v[64:79], v[160:163], v[16:19], v[64:79]
  s_add_u32 m0, s70, 0
  s_add_u32 s71, s75, 0
  buffer_load_dwordx4 v4, s[36:39], s71 offen sc1 lds
  ds_read_b128 v[16:19], v10 offset:16384
  s_waitcnt lgkmcnt(3)
  v_mfma_f32_32x32x16_bf16 v[32:47], a[52:55], v[20:23], v[32:47]
  v_mfma_f32_32x32x16_bf16 v[48:63], v[20:23], a[196:199], v[48:63]
  v_mfma_f32_32x32x16_bf16 v[64:79], v[164:167], v[20:23], v[64:79]
  ds_read_b128 v[20:23], v10 offset:17408
  s_waitcnt lgkmcnt(3)
  v_mfma_f32_32x32x16_bf16 v[32:47], a[56:59], v[24:27], v[32:47]
  v_mfma_f32_32x32x16_bf16 v[48:63], v[24:27], a[200:203], v[48:63]
  v_mfma_f32_32x32x16_bf16 v[64:79], v[168:171], v[24:27], v[64:79]
  s_add_u32 m0, s70, 1024
  s_add_u32 s71, s75, 1024
  buffer_load_dwordx4 v4, s[36:39], s71 offen sc1 lds
  ds_read_b128 v[24:27], v10 offset:18432
  s_waitcnt lgkmcnt(3)
  v_mfma_f32_32x32x16_bf16 v[32:47], a[60:63], v[28:31], v[32:47]
  v_mfma_f32_32x32x16_bf16 v[48:63], v[28:31], a[204:207], v[48:63]
  v_mfma_f32_32x32x16_bf16 v[64:79], v[172:175], v[28:31], v[64:79]
  ds_read_b128 v[28:31], v10 offset:19456
  s_waitcnt lgkmcnt(3)
  v_mfma_f32_32x32x16_bf16 v[32:47], a[64:67], v[16:19], v[32:47]
  v_mfma_f32_32x32x16_bf16 v[48:63], v[16:19], a[208:211], v[48:63]
  v_mfma_f32_32x32x16_bf16 v[64:79], v[176:179], v[16:19], v[64:79]
  s_add_u32 m0, s70, 2048
  s_add_u32 s71, s75, 2048
  buffer_load_dwordx4 v4, s[36:39], s71 offen sc1 lds
  ds_read_b128 v[16:19], v10 offset:20480
  s_waitcnt lgkmcnt(3)
  v_mfma_f32_32x32x16_bf16 v[32:47], a[68:71], v[20:23], v[32:47]
  v_mfma_f32_32x32x16_bf16 v[48:63], v[20:23], a[212:215], v[48:63]
  v_mfma_f32_32x32x16_bf16 v[64:79], v[180:183], v[20:23], v[64:79]
  ds_read_b128 v[20:23], v10 offset:21504
  s_waitcnt lgkmcnt(3)
  v_mfma_f32_32x32x16_bf16 v[32:47], a[72:75], v[24:27], v[32:47]
  v_mfma_f32_32x32x16_bf16 v[48:63], v[24:27], a[216:219], v[48:63]
  v_mfma_f32_32x32x16_bf16 v[64:79], v[184:187], v[24:27], v[64:79]
  s_add_u32 m0, s70, 3072
  s_add_u32 s71, s75, 3072
  buffer_load_dwordx4 v4, s[36:39], s71 offen sc1 lds
  ds_read_b128 v[24:27], v10 offset:22528
  s_waitcnt lgkmcnt(3)
  v_mfma_f32_32x32x16_bf16 v[32:47], a[76:79], v[28:31], v[32:47]
  v_mfma_f32_32x32x16_bf16 v[48:63], v[28:31], a[220:223], v[48:63]
  v_mfma_f32_32x32x16_bf16 v[64:79], v[188:191], v[28:31], v[64:79]
  ds_read_b128 v[28:31], v10 offset:23552
  s_waitcnt lgkmcnt(3)
  v_mfma_f32_32x32x16_bf16 v[32:47], a[80:83], v[16:19], v[32:47]
  v_mfma_f32_32x32x16_bf16 v[48:63], v[16:19], a[224:227], v[48:63]
  v_mfma_f32_32x32x16_bf16 v[64:79], v[192:195], v[16:19], v[64:79]
  s_add_u32 m0, s70, 4096
  s_add_u32 s71, s75, 4096
  buffer_load_dwordx4 v4, s[36:39], s71 offen sc1 lds
  ds_read_b128 v[16:19], v10 offset:24576
  s_waitcnt lgkmcnt(3)
  v_mfma_f32_32x32x16_bf16 v[32:47], a[84:87], v[20:23], v[32:47]
  v_mfma_f32_32x32x16_bf16 v[48:63], v[20:23], a[228:231], v[48:63]
  v_mfma_f32_32x32x16_bf16 v[64:79], v[196:199], v[20:23], v[64:79]
  ds_read_b128 v[20:23], v10 offset:25600
  s_waitcnt lgkmcnt(3)
  v_mfma_f32_32x32x16_bf16 v[32:47], a[88:91], v[24:27], v[32:47]
  v_mfma_f32_32x32x16_bf16 v[48:63], v[24:27], a[232:235], v[48:63]
  v_mfma_f32_32x32x16_bf16 v[64:79], v[200:203], v[24:27], v[64:79]
  s_add_u32 m0, s70, 5120
  s_add_u32 s71, s75, 5120
  buffer_load_dwordx4 v4, s[36:39], s71 offen sc1 lds
  ds_read_b128 v[24:27], v10 offset:26624
  s_waitcnt lgkmcnt(3)
  v_mfma_f32_32x32x16_bf16 v[32:47], a[92:95], v[28:31], v[32:47]
  v_mfma_f32_32x32x16_bf16 v[48:63], v[28:31], a[236:239], v[48:63]
  v_mfma_f32_32x32x16_bf16 v[64:79], v[204:207], v[28:31], v[64:79]
  ds_read_b128 v[28:31], v10 offset:27648
  s_waitcnt lgkmcnt(3)
  v_mfma_f32_32x32x16_bf16 v[32:47], a[96:99], v[16:19], v[32:47]
  v_mfma_f32_32x32x16_bf16 v[48:63], v[16:19], a[240:243], v[48:63]
  v_mfma_f32_32x32x16_bf16 v[64:79], v[208:211], v[16:19], v[64:79]
  s_add_u32 m0, s70, 6144
  s_add_u32 s71, s75, 6144
  buffer_load_dwordx4 v4, s[36:39], s71 offen sc1 lds
  ds_read_b128 v[16:19], v10 offset:28672
  s_waitcnt lgkmcnt(3)
  v_mfma_f32_32x32x16_bf16 v[32:47], a[100:103], v[20:23], v[32:47]
  v_mfma_f32_32x32x16_bf16 v[48:63], v[20:23], a[244:247], v[48:63]
  v_mfma_f32_32x32x16_bf16 v[64:79], v[212:215], v[20:23], v[64:79]
  ds_read_b128 v[20:23], v10 offset:29696
  s_waitcnt lgkmcnt(3)
  v_mfma_f32_32x32x16_bf16 v[32:47], a[104:107], v[24:27], v[32:47]
  v_mfma_f32_32x32x16_bf16 v[48:63], v[24:27], a[248:251], v[48:63]
  v_mfma_f32_32x32x16_bf16 v[64:79], v[216:219], v[24:27], v[64:79]
  s_add_u32 m0, s70, 7168
  s_add_u32 s71, s75, 7168
  buffer_load_dwordx4 v4, s[36:39], s71 offen sc1 lds
  ds_read_b128 v[24:27], v10 offset:30720
  s_waitcnt lgkmcnt(3)
  v_mfma_f32_32x32x16_bf16 v[32:47], a[108:111], v[28:31], v[32:47]
  v_mfma_f32_32x32x16_bf16 v[48:63], v[28:31], a[252:255], v[48:63]
  v_mfma_f32_32x32x16_bf16 v[64:79], v[220:223], v[28:31], v[64:79]
  ds_read_b128 v[28:31], v10 offset:31744
  s_waitcnt lgkmcnt(3)
  v_mfma_f32_32x32x16_bf16 v[32:47], a[112:115], v[16:19], v[32:47]
  v_mfma_f32_32x32x16_bf16 v[48:63], v[16:19], v[80:83], v[48:63]
  v_mfma_f32_32x32x16_bf16 v[64:79], v[224:227], v[16:19], v[64:79]
  s_add_u32 m0, s70, 8192
  s_add_u32 s71, s75, 8192
  buffer_load_dwordx4 v4, s[36:39], s71 offen sc1 lds
  ds_read_b128 v[16:19], v10 offset:32768
  s_waitcnt lgkmcnt(3)
  v_mfma_f32_32x32x16_bf16 v[32:47], a[116:119], v[20:23], v[32:47]
  v_mfma_f32_32x32x16_bf16 v[48:63], v[20:23], v[84:87], v[48:63]
  v_mfma_f32_32x32x16_bf16 v[64:79], v[228:231], v[20:23], v[64:79]
  ds_read_b128 v[20:23], v10 offset:33792
  s_waitcnt lgkmcnt(3)
  v_mfma_f32_32x32x16_bf16 v[32:47], a[120:123], v[24:27], v[32:47]
  v_mfma_f32_32x32x16_bf16 v[48:63], v[24:27], v[88:91], v[48:63]
  v_mfma_f32_32x32x16_bf16 v[64:79], v[232:235], v[24:27], v[64:79]
  ds_read_b128 v[24:27], v10 offset:34816
  s_waitcnt lgkmcnt(3)
  v_mfma_f32_32x32x16_bf16 v[32:47], a[124:127], v[28:31], v[32:47]
  v_mfma_f32_32x32x16_bf16 v[48:63], v[28:31], v[92:95], v[48:63]
  v_mfma_f32_32x32x16_bf16 v[64:79], v[236:239], v[28:31], v[64:79]
  ds_read_b128 v[28:31], v10 offset:35840
  s_waitcnt lgkmcnt(3)
  v_mfma_f32_32x32x16_bf16 v[32:47], a[128:131], v[16:19], v[32:47]
  v_mfma_f32_32x32x16_bf16 v[48:63], v[16:19], v[96:99], v[48:63]
  v_mfma_f32_32x32x16_bf16 v[64:79], v[240:243], v[16:19], v[64:79]
  s_waitcnt lgkmcnt(2)
  v_mfma_f32_32x32x16_bf16 v[32:47], a[132:135], v[20:23], v[32:47]
  v_mfma_f32_32x32x16_bf16 v[48:63], v[20:23], v[100:103], v[48:63]
  v_mfma_f32_32x32x16_bf16 v[64:79], v[244:247], v[20:23], v[64:79]
  s_waitcnt lgkmcnt(1)
  v_mfma_f32_32x32x16_bf16 v[32:47], a[136:139], v[24:27], v[32:47]
  v_mfma_f32_32x32x16_bf16 v[48:63], v[24:27], v[104:107], v[48:63]
  v_mfma_f32_32x32x16_bf16 v[64:79], v[248:251], v[24:27], v[64:79]
  s_waitcnt lgkmcnt(0)
  v_mfma_f32_32x32x16_bf16 v[32:47], a[140:143], v[28:31], v[32:47]
  v_mfma_f32_32x32x16_bf16 v[48:63], v[28:31], v[108:111], v[48:63]
  v_mfma_f32_32x32x16_bf16 v[64:79], v[252:255], v[28:31], v[64:79]
  v_xor_b32 v10, 0x10000, v10
  s_nop 8
  v_cvt_pk_bf16_f32 v16, v32, v40
  v_cvt_pk_bf16_f32 v18, v33, v41
  v_cvt_pk_bf16_f32 v20, v34, v42
  v_cvt_pk_bf16_f32 v22, v35, v43
  v_cvt_pk_bf16_f32 v17, v36, v44
  v_cvt_pk_bf16_f32 v19, v37, v45
  v_cvt_pk_bf16_f32 v21, v38, v46
  v_cvt_pk_bf16_f32 v23, v39, v47
  s_add_u32 s71, s74, 50331648
  buffer_store_dwordx4 v[16:19], v5, s[36:39], s71 offen sc1
  buffer_store_dwordx4 v[20:23], v5, s[36:39], s71 offen offset:512 sc1
  v_cvt_pk_bf16_f32 v24, v48, v49
  v_cvt_pk_bf16_f32 v25, v50, v51
  v_cvt_pk_bf16_f32 v26, v52, v53
  v_cvt_pk_bf16_f32 v27, v54, v55
  v_cvt_pk_bf16_f32 v28, v56, v57
  v_cvt_pk_bf16_f32 v29, v58, v59
  v_cvt_pk_bf16_f32 v30, v60, v61
  v_cvt_pk_bf16_f32 v31, v62, v63
  s_add_u32 s71, s74, 67108864
  buffer_store_dwordx4 v[24:27], v4, s[36:39], s71 offen sc1
  buffer_store_dwordx4 v[28:31], v4, s[36:39], s71 offen offset:1024 sc1
  v_cvt_pk_bf16_f32 v32, v64, v72
  v_cvt_pk_bf16_f32 v34, v65, v73
  v_cvt_pk_bf16_f32 v36, v66, v74
  v_cvt_pk_bf16_f32 v38, v67, v75
  v_cvt_pk_bf16_f32 v33, v68, v76
  v_cvt_pk_bf16_f32 v35, v69, v77
  v_cvt_pk_bf16_f32 v37, v70, v78
  v_cvt_pk_bf16_f32 v39, v71, v79
  s_add_u32 s71, s74, 33554432
  buffer_store_dwordx4 v[32:35], v5, s[36:39], s71 offen sc1
  buffer_store_dwordx4 v[36:39], v5, s[36:39], s71 offen offset:512 sc1
  s_lshl_b32 s71, s78, 18
  s_add_u32 s74, s74, s71
  s_add_u32 s73, s73, s78
  s_cmp_lt_u32 s73, s79
  s_cbranch_scc1 L_P_LOOP
  s_waitcnt vmcnt(0)
  v_mov_b32 v7, 64
  buffer_store_dword v7, v6, s[36:39], s76 offen sc1
  s_endpgm
L_P_END:
L_ROLE_A:
  v_mov_b32 v3, 0
  s_lshl_b32 s74, s67, 7
  s_lshl_b32 s89, s65, 2
  s_add_u32 s85, s74, 12288
  s_add_u32 s74, s74, s89
  s_add_u32 s86, s74, 12800
  s_add_u32 s74, s74, 12288
  buffer_store_dword v3, v3, s[36:39], s74 offen
  buffer_store_dword v3, v3, s[36:39], s86 offen sc1
  s_mul_i32 s74, s67, 0x240000
  s_mul_i32 s84, s65, 36864
  s_add_u32 s84, s84, s74
  s_add_u32 s84, s84, 10485760
  s_mov_b32 s44, s4
  s_and_b32 s45, s5, 0xffff
  s_mov_b32 s46, 2359296
  s_mov_b32 s47, 0x20000
  s_mov_b32 s48, s26
  s_and_b32 s49, s27, 0xffff
  s_mov_b32 s50, 1152
  s_mov_b32 s51, 0x20000
  s_mov_b32 s52, s28
  s_and_b32 s53, s29, 0xffff
  s_mov_b32 s54, 3981312
  s_mov_b32 s55, 0x20000
  v_mov_b32 v1, 0
  s_lshl_b32 s70, s67, 5
  s_add_u32 s70, s70, s65
  s_lshl_b32 s71, s64, 6
  v_add_u32 v2, s71, v0
  v_lshlrev_b32 v3, 1, v2
  buffer_load_ushort v8, v3, s[48:51], 0 offen
  buffer_load_ushort v9, v3, s[48:51], 0 offen offset:512
  buffer_load_ushort v10, v3, s[48:51], 0 offen offset:1024
  s_cmp_ge_u32 s70, 54
  s_cbranch_scc1 MODSKIP1_45
  v_lshrrev_b32 v3, 3, v2
  v_mul_u32_u24 v3, 124416, v3
  v_and_b32_e64 v4, 7, v2
  v_lshl_add_u32 v3, v4, 4, v3
  s_lshl_b32 s71, s70, 7
  buffer_load_dwordx4 v[12:15], v3, s[52:55], s71 offen
  s_add_u32 s71, s71, 6912
  buffer_load_dwordx4 v[16:19], v3, s[52:55], s71 offen
  s_add_u32 s71, s71, 6912
  buffer_load_dwordx4 v[20:23], v3, s[52:55], s71 offen
  s_add_u32 s71, s71, 6912
  buffer_load_dwordx4 v[24:27], v3, s[52:55], s71 offen
  s_add_u32 s71, s71, 6912
  buffer_load_dwordx4 v[28:31], v3, s[52:55], s71 offen
  s_add_u32 s71, s71, 6912
  buffer_load_dwordx4 v[32:35], v3, s[52:55], s71 offen
  s_add_u32 s71, s71, 6912
  buffer_load_dwordx4 v[36:39], v3, s[52:55], s71 offen
  s_add_u32 s71, s71, 6912
  buffer_load_dwordx4 v[40:43], v3, s[52:55], s71 offen
  s_add_u32 s71, s71, 6912
  buffer_load_dwordx4 v[44:47], v3, s[52:55], s71 offen
  s_add_u32 s71, s71, 6912
  buffer_load_dwordx4 v[48:51], v3, s[52:55], s71 offen
  s_add_u32 s71, s71, 6912
  buffer_load_dwordx4 v[52:55], v3, s[52:55], s71 offen
  s_add_u32 s71, s71, 6912
  buffer_load_dwordx4 v[56:59], v3, s[52:55], s71 offen
  s_add_u32 s71, s71, 6912
  buffer_load_dwordx4 v[60:63], v3, s[52:55], s71 offen
  s_add_u32 s71, s71, 6912
  buffer_load_dwordx4 v[64:67], v3, s[52:55], s71 offen
  s_add_u32 s71, s71, 6912
  buffer_load_dwordx4 v[68:71], v3, s[52:55], s71 offen
  s_add_u32 s71, s71, 6912
  buffer_load_dwordx4 v[72:75], v3, s[52:55], s71 offen
  s_add_u32 s71, s71, 6912
  buffer_load_dwordx4 v[76:79], v3, s[52:55], s71 offen
  s_add_u32 s71, s71, 6912
  buffer_load_dwordx4 v[80:83], v3, s[52:55], s71 offen
MODSKIP1_45:
  v_lshrrev_b32 v3, 3, v2
  v_mul_u32_u24 v6, 1152, v3
  v_and_b32_e64 v4, 7, v0
  v_lshl_add_u32 v6, v4, 4, v6
  s_sub_u32 s73, 63, s70
  s_mul_i32 s71, s73, 36864
  buffer_load_dwordx4 v[84:87], v6, s[44:47], s71 offen offset:0
  buffer_load_dwordx4 v[88:91], v6, s[44:47], s71 offen offset:128
  buffer_load_dwordx4 v[92:95], v6, s[44:47], s71 offen offset:256
  buffer_load_dwordx4 v[96:99], v6, s[44:47], s71 offen offset:384
  buffer_load_dwordx4 v[100:103], v6, s[44:47], s71 offen offset:512
  buffer_load_dwordx4 v[104:107], v6, s[44:47], s71 offen offset:640
  buffer_load_dwordx4 v[108:111], v6, s[44:47], s71 offen offset:768
  buffer_load_dwordx4 v[112:115], v6, s[44:47], s71 offen offset:896
  buffer_load_dwordx4 v[116:119], v6, s[44:47], s71 offen offset:1024
  s_cmp_ge_u32 s70, 54
  s_cbranch_scc1 MODSKIP2_46
  s_waitcnt vmcnt(27)
  v_lshlrev_b32 v8, 16, v8
  v_mul_f32 v3, 0xbfb8aa3b, v8
  v_exp_f32 v3, v3
  s_nop 0
  v_add_f32 v3, 1.0, v3
  v_rcp_f32 v3, v3
  s_nop 0
  v_mul_f32 v8, v8, v3
  v_cvt_pk_bf16_f32 v8, v8, v8
  v_lshlrev_b32 v8, 16, v8
  v_lshlrev_b32 v9, 16, v9
  v_mul_f32 v3, 0xbfb8aa3b, v9
  v_exp_f32 v3, v3
  s_nop 0
  v_add_f32 v3, 1.0, v3
  v_rcp_f32 v3, v3
  s_nop 0
  v_mul_f32 v9, v9, v3
  v_cvt_pk_bf16_f32 v9, v9, v9
  v_lshlrev_b32 v9, 16, v9
  v_lshlrev_b32 v10, 16, v10
  v_mul_f32 v3, 0xbfb8aa3b, v10
  v_exp_f32 v3, v3
  s_nop 0
  v_add_f32 v3, 1.0, v3
  v_rcp_f32 v3, v3
  s_nop 0
  v_mul_f32 v10, v10, v3
  v_cvt_pk_bf16_f32 v10, v10, v10
  v_lshlrev_b32 v10, 16, v10
  v_lshlrev_b32 v3, 2, v2
  ds_write_b32 v3, v8
  ds_write_b32 v3, v9 offset:1024
  ds_write_b32 v3, v10 offset:2048
  s_waitcnt lgkmcnt(0)
  s_barrier
  v_lshrrev_b32 v3, 3, v2
  v_mul_u32_u24 v3, 72, v3
  ds_read_b64 v[120:121], v3 offset:0
  ds_read_b64 v[122:123], v3 offset:8
  ds_read_b64 v[124:125], v3 offset:16
  ds_read_b64 v[126:127], v3 offset:24
  ds_read_b64 v[128:129], v3 offset:32
  ds_read_b64 v[130:131], v3 offset:40
  ds_read_b64 v[132:133], v3 offset:48
  ds_read_b64 v[134:135], v3 offset:56
  ds_read_b64 v[136:137], v3 offset:64
  v_mov_b32 v140, 0
  v_mov_b32 v141, 0
  v_mov_b32 v142, 0
  v_mov_b32 v143, 0
  v_mov_b32 v144, 0
  v_mov_b32 v145, 0
  v_mov_b32 v146, 0
  v_mov_b32 v147, 0
  s_waitcnt lgkmcnt(0)
  s_waitcnt vmcnt(26)
  v_lshlrev_b32 v4, 16, v12
  v_and_b32 v5, 0xffff0000, v12
  v_fmac_f32 v140, v120, v4
  v_fmac_f32 v141, v120, v5
  v_lshlrev_b32 v4, 16, v13
  v_and_b32 v5, 0xffff0000, v13
  v_fmac_f32 v142, v120, v4
  v_fmac_f32 v143, v120, v5
  v_lshlrev_b32 v4, 16, v14
  v_and_b32 v5, 0xffff0000, v14
  v_fmac_f32 v144, v120, v4
  v_fmac_f32 v145, v120, v5
  v_lshlrev_b32 v4, 16, v15
  v_and_b32 v5, 0xffff0000, v15
  v_fmac_f32 v146, v120, v4
  v_fmac_f32 v147, v120, v5
  s_waitcnt vmcnt(25)
  v_lshlrev_b32 v4, 16, v16
  v_and_b32 v5, 0xffff0000, v16
  v_fmac_f32 v140, v121, v4
  v_fmac_f32 v141, v121, v5
  v_lshlrev_b32 v4, 16, v17
  v_and_b32 v5, 0xffff0000, v17
  v_fmac_f32 v142, v121, v4
  v_fmac_f32 v143, v121, v5
  v_lshlrev_b32 v4, 16, v18
  v_and_b32 v5, 0xffff0000, v18
  v_fmac_f32 v144, v121, v4
  v_fmac_f32 v145, v121, v5
  v_lshlrev_b32 v4, 16, v19
  v_and_b32 v5, 0xffff0000, v19
  v_fmac_f32 v146, v121, v4
  v_fmac_f32 v147, v121, v5
  s_waitcnt vmcnt(24)
  v_lshlrev_b32 v4, 16, v20
  v_and_b32 v5, 0xffff0000, v20
  v_fmac_f32 v140, v122, v4
  v_fmac_f32 v141, v122, v5
  v_lshlrev_b32 v4, 16, v21
  v_and_b32 v5, 0xffff0000, v21
  v_fmac_f32 v142, v122, v4
  v_fmac_f32 v143, v122, v5
  v_lshlrev_b32 v4, 16, v22
  v_and_b32 v5, 0xffff0000, v22
  v_fmac_f32 v144, v122, v4
  v_fmac_f32 v145, v122, v5
  v_lshlrev_b32 v4, 16, v23
  v_and_b32 v5, 0xffff0000, v23
  v_fmac_f32 v146, v122, v4
  v_fmac_f32 v147, v122, v5
  s_waitcnt vmcnt(23)
  v_lshlrev_b32 v4, 16, v24
  v_and_b32 v5, 0xffff0000, v24
  v_fmac_f32 v140, v123, v4
  v_fmac_f32 v141, v123, v5
  v_lshlrev_b32 v4, 16, v25
  v_and_b32 v5, 0xffff0000, v25
  v_fmac_f32 v142, v123, v4
  v_fmac_f32 v143, v123, v5
  v_lshlrev_b32 v4, 16, v26
  v_and_b32 v5, 0xffff0000, v26
  v_fmac_f32 v144, v123, v4
  v_fmac_f32 v145, v123, v5
  v_lshlrev_b32 v4, 16, v27
  v_and_b32 v5, 0xffff0000, v27
  v_fmac_f32 v146, v123, v4
  v_fmac_f32 v147, v123, v5
  s_waitcnt vmcnt(22)
  v_lshlrev_b32 v4, 16, v28
  v_and_b32 v5, 0xffff0000, v28
  v_fmac_f32 v140, v124, v4
  v_fmac_f32 v141, v124, v5
  v_lshlrev_b32 v4, 16, v29
  v_and_b32 v5, 0xffff0000, v29
  v_fmac_f32 v142, v124, v4
  v_fmac_f32 v143, v124, v5
  v_lshlrev_b32 v4, 16, v30
  v_and_b32 v5, 0xffff0000, v30
  v_fmac_f32 v144, v124, v4
  v_fmac_f32 v145, v124, v5
  v_lshlrev_b32 v4, 16, v31
  v_and_b32 v5, 0xffff0000, v31
  v_fmac_f32 v146, v124, v4
  v_fmac_f32 v147, v124, v5
  s_waitcnt vmcnt(21)
  v_lshlrev_b32 v4, 16, v32
  v_and_b32 v5, 0xffff0000, v32
  v_fmac_f32 v140, v125, v4
  v_fmac_f32 v141, v125, v5
  v_lshlrev_b32 v4, 16, v33
  v_and_b32 v5, 0xffff0000, v33
  v_fmac_f32 v142, v125, v4
  v_fmac_f32 v143, v125, v5
  v_lshlrev_b32 v4, 16, v34
  v_and_b32 v5, 0xffff0000, v34
  v_fmac_f32 v144, v125, v4
  v_fmac_f32 v145, v125, v5
  v_lshlrev_b32 v4, 16, v35
  v_and_b32 v5, 0xffff0000, v35
  v_fmac_f32 v146, v125, v4
  v_fmac_f32 v147, v125, v5
  s_waitcnt vmcnt(20)
  v_lshlrev_b32 v4, 16, v36
  v_and_b32 v5, 0xffff0000, v36
  v_fmac_f32 v140, v126, v4
  v_fmac_f32 v141, v126, v5
  v_lshlrev_b32 v4, 16, v37
  v_and_b32 v5, 0xffff0000, v37
  v_fmac_f32 v142, v126, v4
  v_fmac_f32 v143, v126, v5
  v_lshlrev_b32 v4, 16, v38
  v_and_b32 v5, 0xffff0000, v38
  v_fmac_f32 v144, v126, v4
  v_fmac_f32 v145, v126, v5
  v_lshlrev_b32 v4, 16, v39
  v_and_b32 v5, 0xffff0000, v39
  v_fmac_f32 v146, v126, v4
  v_fmac_f32 v147, v126, v5
  s_waitcnt vmcnt(19)
  v_lshlrev_b32 v4, 16, v40
  v_and_b32 v5, 0xffff0000, v40
  v_fmac_f32 v140, v127, v4
  v_fmac_f32 v141, v127, v5
  v_lshlrev_b32 v4, 16, v41
  v_and_b32 v5, 0xffff0000, v41
  v_fmac_f32 v142, v127, v4
  v_fmac_f32 v143, v127, v5
  v_lshlrev_b32 v4, 16, v42
  v_and_b32 v5, 0xffff0000, v42
  v_fmac_f32 v144, v127, v4
  v_fmac_f32 v145, v127, v5
  v_lshlrev_b32 v4, 16, v43
  v_and_b32 v5, 0xffff0000, v43
  v_fmac_f32 v146, v127, v4
  v_fmac_f32 v147, v127, v5
  s_waitcnt vmcnt(18)
  v_lshlrev_b32 v4, 16, v44
  v_and_b32 v5, 0xffff0000, v44
  v_fmac_f32 v140, v128, v4
  v_fmac_f32 v141, v128, v5
  v_lshlrev_b32 v4, 16, v45
  v_and_b32 v5, 0xffff0000, v45
  v_fmac_f32 v142, v128, v4
  v_fmac_f32 v143, v128, v5
  v_lshlrev_b32 v4, 16, v46
  v_and_b32 v5, 0xffff0000, v46
  v_fmac_f32 v144, v128, v4
  v_fmac_f32 v145, v128, v5
  v_lshlrev_b32 v4, 16, v47
  v_and_b32 v5, 0xffff0000, v47
  v_fmac_f32 v146, v128, v4
  v_fmac_f32 v147, v128, v5
  s_waitcnt vmcnt(17)
  v_lshlrev_b32 v4, 16, v48
  v_and_b32 v5, 0xffff0000, v48
  v_fmac_f32 v140, v129, v4
  v_fmac_f32 v141, v129, v5
  v_lshlrev_b32 v4, 16, v49
  v_and_b32 v5, 0xffff0000, v49
  v_fmac_f32 v142, v129, v4
  v_fmac_f32 v143, v129, v5
  v_lshlrev_b32 v4, 16, v50
  v_and_b32 v5, 0xffff0000, v50
  v_fmac_f32 v144, v129, v4
  v_fmac_f32 v145, v129, v5
  v_lshlrev_b32 v4, 16, v51
  v_and_b32 v5, 0xffff0000, v51
  v_fmac_f32 v146, v129, v4
  v_fmac_f32 v147, v129, v5
  s_waitcnt vmcnt(16)
  v_lshlrev_b32 v4, 16, v52
  v_and_b32 v5, 0xffff0000, v52
  v_fmac_f32 v140, v130, v4
  v_fmac_f32 v141, v130, v5
  v_lshlrev_b32 v4, 16, v53
  v_and_b32 v5, 0xffff0000, v53
  v_fmac_f32 v142, v130, v4
  v_fmac_f32 v143, v130, v5
  v_lshlrev_b32 v4, 16, v54
  v_and_b32 v5, 0xffff0000, v54
  v_fmac_f32 v144, v130, v4
  v_fmac_f32 v145, v130, v5
  v_lshlrev_b32 v4, 16, v55
  v_and_b32 v5, 0xffff0000, v55
  v_fmac_f32 v146, v130, v4
  v_fmac_f32 v147, v130, v5
  s_waitcnt vmcnt(15)
  v_lshlrev_b32 v4, 16, v56
  v_and_b32 v5, 0xffff0000, v56
  v_fmac_f32 v140, v131, v4
  v_fmac_f32 v141, v131, v5
  v_lshlrev_b32 v4, 16, v57
  v_and_b32 v5, 0xffff0000, v57
  v_fmac_f32 v142, v131, v4
  v_fmac_f32 v143, v131, v5
  v_lshlrev_b32 v4, 16, v58
  v_and_b32 v5, 0xffff0000, v58
  v_fmac_f32 v144, v131, v4
  v_fmac_f32 v145, v131, v5
  v_lshlrev_b32 v4, 16, v59
  v_and_b32 v5, 0xffff0000, v59
  v_fmac_f32 v146, v131, v4
  v_fmac_f32 v147, v131, v5
  s_waitcnt vmcnt(14)
  v_lshlrev_b32 v4, 16, v60
  v_and_b32 v5, 0xffff0000, v60
  v_fmac_f32 v140, v132, v4
  v_fmac_f32 v141, v132, v5
  v_lshlrev_b32 v4, 16, v61
  v_and_b32 v5, 0xffff0000, v61
  v_fmac_f32 v142, v132, v4
  v_fmac_f32 v143, v132, v5
  v_lshlrev_b32 v4, 16, v62
  v_and_b32 v5, 0xffff0000, v62
  v_fmac_f32 v144, v132, v4
  v_fmac_f32 v145, v132, v5
  v_lshlrev_b32 v4, 16, v63
  v_and_b32 v5, 0xffff0000, v63
  v_fmac_f32 v146, v132, v4
  v_fmac_f32 v147, v132, v5
  s_waitcnt vmcnt(13)
  v_lshlrev_b32 v4, 16, v64
  v_and_b32 v5, 0xffff0000, v64
  v_fmac_f32 v140, v133, v4
  v_fmac_f32 v141, v133, v5
  v_lshlrev_b32 v4, 16, v65
  v_and_b32 v5, 0xffff0000, v65
  v_fmac_f32 v142, v133, v4
  v_fmac_f32 v143, v133, v5
  v_lshlrev_b32 v4, 16, v66
  v_and_b32 v5, 0xffff0000, v66
  v_fmac_f32 v144, v133, v4
  v_fmac_f32 v145, v133, v5
  v_lshlrev_b32 v4, 16, v67
  v_and_b32 v5, 0xffff0000, v67
  v_fmac_f32 v146, v133, v4
  v_fmac_f32 v147, v133, v5
  s_waitcnt vmcnt(12)
  v_lshlrev_b32 v4, 16, v68
  v_and_b32 v5, 0xffff0000, v68
  v_fmac_f32 v140, v134, v4
  v_fmac_f32 v141, v134, v5
  v_lshlrev_b32 v4, 16, v69
  v_and_b32 v5, 0xffff0000, v69
  v_fmac_f32 v142, v134, v4
  v_fmac_f32 v143, v134, v5
  v_lshlrev_b32 v4, 16, v70
  v_and_b32 v5, 0xffff0000, v70
  v_fmac_f32 v144, v134, v4
  v_fmac_f32 v145, v134, v5
  v_lshlrev_b32 v4, 16, v71
  v_and_b32 v5, 0xffff0000, v71
  v_fmac_f32 v146, v134, v4
  v_fmac_f32 v147, v134, v5
  s_waitcnt vmcnt(11)
  v_lshlrev_b32 v4, 16, v72
  v_and_b32 v5, 0xffff0000, v72
  v_fmac_f32 v140, v135, v4
  v_fmac_f32 v141, v135, v5
  v_lshlrev_b32 v4, 16, v73
  v_and_b32 v5, 0xffff0000, v73
  v_fmac_f32 v142, v135, v4
  v_fmac_f32 v143, v135, v5
  v_lshlrev_b32 v4, 16, v74
  v_and_b32 v5, 0xffff0000, v74
  v_fmac_f32 v144, v135, v4
  v_fmac_f32 v145, v135, v5
  v_lshlrev_b32 v4, 16, v75
  v_and_b32 v5, 0xffff0000, v75
  v_fmac_f32 v146, v135, v4
  v_fmac_f32 v147, v135, v5
  s_waitcnt vmcnt(10)
  v_lshlrev_b32 v4, 16, v76
  v_and_b32 v5, 0xffff0000, v76
  v_fmac_f32 v140, v136, v4
  v_fmac_f32 v141, v136, v5
  v_lshlrev_b32 v4, 16, v77
  v_and_b32 v5, 0xffff0000, v77
  v_fmac_f32 v142, v136, v4
  v_fmac_f32 v143, v136, v5
  v_lshlrev_b32 v4, 16, v78
  v_and_b32 v5, 0xffff0000, v78
  v_fmac_f32 v144, v136, v4
  v_fmac_f32 v145, v136, v5
  v_lshlrev_b32 v4, 16, v79
  v_and_b32 v5, 0xffff0000, v79
  v_fmac_f32 v146, v136, v4
  v_fmac_f32 v147, v136, v5
  s_waitcnt vmcnt(9)
  v_lshlrev_b32 v4, 16, v80
  v_and_b32 v5, 0xffff0000, v80
  v_fmac_f32 v140, v137, v4
  v_fmac_f32 v141, v137, v5
  v_lshlrev_b32 v4, 16, v81
  v_and_b32 v5, 0xffff0000, v81
  v_fmac_f32 v142, v137, v4
  v_fmac_f32 v143, v137, v5
  v_lshlrev_b32 v4, 16, v82
  v_and_b32 v5, 0xffff0000, v82
  v_fmac_f32 v144, v137, v4
  v_fmac_f32 v145, v137, v5
  v_lshlrev_b32 v4, 16, v83
  v_and_b32 v5, 0xffff0000, v83
  v_fmac_f32 v146, v137, v4
  v_fmac_f32 v147, v137, v5
  v_lshlrev_b32 v3, 5, v2
  ds_write_b128 v3, v[140:143] offset:4096
  ds_write_b128 v3, v[144:147] offset:4112
  s_waitcnt lgkmcnt(0)
  s_barrier
  s_cmp_lg_u32 s64, 0
  s_cbranch_scc1 MODW_47
  v_lshlrev_b32 v3, 2, v0
  ds_read_b32 v12, v3 offset:4096
  ds_read_b32 v13, v3 offset:4352
  ds_read_b32 v14, v3 offset:4608
  ds_read_b32 v15, v3 offset:4864
  ds_read_b32 v16, v3 offset:5120
  ds_read_b32 v17, v3 offset:5376
  ds_read_b32 v18, v3 offset:5632
  ds_read_b32 v19, v3 offset:5888
  ds_read_b32 v20, v3 offset:6144
  ds_read_b32 v21, v3 offset:6400
  ds_read_b32 v22, v3 offset:6656
  ds_read_b32 v23, v3 offset:6912
  ds_read_b32 v24, v3 offset:7168
  ds_read_b32 v25, v3 offset:7424
  ds_read_b32 v26, v3 offset:7680
  s_waitcnt lgkmcnt(0)
  ds_read_b32 v27, v3 offset:7936
  ds_read_b32 v28, v3 offset:8192
  ds_read_b32 v29, v3 offset:8448
  ds_read_b32 v30, v3 offset:8704
  ds_read_b32 v31, v3 offset:8960
  ds_read_b32 v32, v3 offset:9216
  ds_read_b32 v33, v3 offset:9472
  ds_read_b32 v34, v3 offset:9728
  ds_read_b32 v35, v3 offset:9984
  ds_read_b32 v36, v3 offset:10240
  ds_read_b32 v37, v3 offset:10496
  ds_read_b32 v38, v3 offset:10752
  ds_read_b32 v39, v3 offset:11008
  ds_read_b32 v40, v3 offset:11264
  ds_read_b32 v41, v3 offset:11520
  s_waitcnt lgkmcnt(0)
  ds_read_b32 v42, v3 offset:11776
  ds_read_b32 v43, v3 offset:12032
  s_waitcnt lgkmcnt(0)
  v_add_f32 v12, v12, v28
  v_add_f32 v13, v13, v29
  v_add_f32 v14, v14, v30
  v_add_f32 v15, v15, v31
  v_add_f32 v16, v16, v32
  v_add_f32 v17, v17, v33
  v_add_f32 v18, v18, v34
  v_add_f32 v19, v19, v35
  v_add_f32 v20, v20, v36
  v_add_f32 v21, v21, v37
  v_add_f32 v22, v22, v38
  v_add_f32 v23, v23, v39
  v_add_f32 v24, v24, v40
  v_add_f32 v25, v25, v41
  v_add_f32 v26, v26, v42
  v_add_f32 v27, v27, v43
  v_add_f32 v12, v12, v20
  v_add_f32 v13, v13, v21
  v_add_f32 v14, v14, v22
  v_add_f32 v15, v15, v23
  v_add_f32 v16, v16, v24
  v_add_f32 v17, v17, v25
  v_add_f32 v18, v18, v26
  v_add_f32 v19, v19, v27
  v_add_f32 v12, v12, v16
  v_add_f32 v13, v13, v17
  v_add_f32 v14, v14, v18
  v_add_f32 v15, v15, v19
  v_add_f32 v12, v12, v14
  v_add_f32 v13, v13, v15
  v_add_f32 v12, v12, v13
  v_cvt_pk_bf16_f32 v12, v12, v12
  v_lshlrev_b32 v3, 1, v0
  s_lshl_b32 s71, s70, 7
  s_add_u32 s71, s71, 65536
  buffer_store_short v12, v3, s[36:39], s71 offen sc1
  s_waitcnt vmcnt(0)
  v_mov_b32 v3, 1
  s_mov_b64 exec, 1
  s_cmp_lt_u32 s70, 18
  s_cselect_b32 s71, 64, 0
  buffer_atomic_add v3, v1, s[40:43], s71 offen offset:72
  s_mov_b64 exec, -1
MODW_47:
MODSKIP2_46:
  s_waitcnt vmcnt(0)
  v_lshlrev_b32 v12, 16, v84
  v_and_b32 v13, 0xffff0000, v84
  v_lshlrev_b32 v14, 16, v85
  v_and_b32 v15, 0xffff0000, v85
  v_lshlrev_b32 v16, 16, v86
  v_and_b32 v17, 0xffff0000, v86
  v_lshlrev_b32 v18, 16, v87
  v_and_b32 v19, 0xffff0000, v87
  v_lshlrev_b32 v20, 16, v88
  v_and_b32 v21, 0xffff0000, v88
  v_lshlrev_b32 v22, 16, v89
  v_and_b32 v23, 0xffff0000, v89
  v_lshlrev_b32 v24, 16, v90
  v_and_b32 v25, 0xffff0000, v90
  v_lshlrev_b32 v26, 16, v91
  v_and_b32 v27, 0xffff0000, v91
  v_lshlrev_b32 v28, 16, v92
  v_and_b32 v29, 0xffff0000, v92
  v_lshlrev_b32 v30, 16, v93
  v_and_b32 v31, 0xffff0000, v93
  v_lshlrev_b32 v32, 16, v94
  v_and_b32 v33, 0xffff0000, v94
  v_lshlrev_b32 v34, 16, v95
  v_and_b32 v35, 0xffff0000, v95
  v_lshlrev_b32 v36, 16, v96
  v_and_b32 v37, 0xffff0000, v96
  v_lshlrev_b32 v38, 16, v97
  v_and_b32 v39, 0xffff0000, v97
  v_lshlrev_b32 v40, 16, v98
  v_and_b32 v41, 0xffff0000, v98
  v_lshlrev_b32 v42, 16, v99
  v_and_b32 v43, 0xffff0000, v99
  v_lshlrev_b32 v44, 16, v100
  v_and_b32 v45, 0xffff0000, v100
  v_lshlrev_b32 v46, 16, v101
  v_and_b32 v47, 0xffff0000, v101
  v_lshlrev_b32 v48, 16, v102
  v_and_b32 v49, 0xffff0000, v102
  v_lshlrev_b32 v50, 16, v103
  v_and_b32 v51, 0xffff0000, v103
  v_lshlrev_b32 v52, 16, v104
  v_and_b32 v53, 0xffff0000, v104
  v_lshlrev_b32 v54, 16, v105
  v_and_b32 v55, 0xffff0000, v105
  v_lshlrev_b32 v56, 16, v106
  v_and_b32 v57, 0xffff0000, v106
  v_lshlrev_b32 v58, 16, v107
  v_and_b32 v59, 0xffff0000, v107
  v_lshlrev_b32 v60, 16, v108
  v_and_b32 v61, 0xffff0000, v108
  v_lshlrev_b32 v62, 16, v109
  v_and_b32 v63, 0xffff0000, v109
  v_lshlrev_b32 v64, 16, v110
  v_and_b32 v65, 0xffff0000, v110
  v_lshlrev_b32 v66, 16, v111
  v_and_b32 v67, 0xffff0000, v111
  v_lshlrev_b32 v68, 16, v112
  v_and_b32 v69, 0xffff0000, v112
  v_lshlrev_b32 v70, 16, v113
  v_and_b32 v71, 0xffff0000, v113
  v_lshlrev_b32 v72, 16, v114
  v_and_b32 v73, 0xffff0000, v114
  v_lshlrev_b32 v74, 16, v115
  v_and_b32 v75, 0xffff0000, v115
  v_lshlrev_b32 v76, 16, v116
  v_and_b32 v77, 0xffff0000, v116
  v_lshlrev_b32 v78, 16, v117
  v_and_b32 v79, 0xffff0000, v117
  v_lshlrev_b32 v80, 16, v118
  v_and_b32 v81, 0xffff0000, v118
  v_lshlrev_b32 v82, 16, v119
  v_and_b32 v83, 0xffff0000, v119
  v_add_f32 v84, v12, v13
  v_add_f32 v84, v84, v14
  v_add_f32 v84, v84, v15
  v_add_f32 v84, v84, v16
  v_add_f32 v84, v84, v17
  v_add_f32 v84, v84, v18
  v_add_f32 v84, v84, v19
  v_add_f32 v84, v84, v20
  v_add_f32 v84, v84, v21
  v_add_f32 v84, v84, v22
  v_add_f32 v84, v84, v23
  v_add_f32 v84, v84, v24
  v_add_f32 v84, v84, v25
  v_add_f32 v84, v84, v26
  v_add_f32 v84, v84, v27
  v_add_f32 v84, v84, v28
  v_add_f32 v84, v84, v29
  v_add_f32 v84, v84, v30
  v_add_f32 v84, v84, v31
  v_add_f32 v84, v84, v32
  v_add_f32 v84, v84, v33
  v_add_f32 v84, v84, v34
  v_add_f32 v84, v84, v35
  v_add_f32 v84, v84, v36
  v_add_f32 v84, v84, v37
  v_add_f32 v84, v84, v38
  v_add_f32 v84, v84, v39
  v_add_f32 v84, v84, v40
  v_add_f32 v84, v84, v41
  v_add_f32 v84, v84, v42
  v_add_f32 v84, v84, v43
  v_add_f32 v84, v84, v44
  v_add_f32 v84, v84, v45
  v_add_f32 v84, v84, v46
  v_add_f32 v84, v84, v47
  v_add_f32 v84, v84, v48
  v_add_f32 v84, v84, v49
  v_add_f32 v84, v84, v50
  v_add_f32 v84, v84, v51
  v_add_f32 v84, v84, v52
  v_add_f32 v84, v84, v53
  v_add_f32 v84, v84, v54
  v_add_f32 v84, v84, v55
  v_add_f32 v84, v84, v56
  v_add_f32 v84, v84, v57
  v_add_f32 v84, v84, v58
  v_add_f32 v84, v84, v59
  v_add_f32 v84, v84, v60
  v_add_f32 v84, v84, v61
  v_add_f32 v84, v84, v62
  v_add_f32 v84, v84, v63
  v_add_f32 v84, v84, v64
  v_add_f32 v84, v84, v65
  v_add_f32 v84, v84, v66
  v_add_f32 v84, v84, v67
  v_add_f32 v84, v84, v68
  v_add_f32 v84, v84, v69
  v_add_f32 v84, v84, v70
  v_add_f32 v84, v84, v71
  v_add_f32 v84, v84, v72
  v_add_f32 v84, v84, v73
  v_add_f32 v84, v84, v74
  v_add_f32 v84, v84, v75
  v_add_f32 v84, v84, v76
  v_add_f32 v84, v84, v77
  v_add_f32 v84, v84, v78
  v_add_f32 v84, v84, v79
  v_add_f32 v84, v84, v80
  v_add_f32 v84, v84, v81
  v_add_f32 v84, v84, v82
  v_add_f32 v84, v84, v83
  s_nop 1
  v_add_f32_dpp v88, v84, v84 quad_perm:[1,0,3,2] row_mask:0xf bank_mask:0xf
  s_nop 1
  v_add_f32_dpp v84, v88, v88 quad_perm:[2,3,0,1] row_mask:0xf bank_mask:0xf
  s_nop 1
  v_add_f32_dpp v88, v84, v84 row_half_mirror row_mask:0xf bank_mask:0xf
  v_mov_b32 v84, v88
  v_mul_f32 v86, 0x3ae38e39, v84
  v_mov_b32 v85, 0
  v_sub_f32 v87, v12, v86
  v_fmac_f32 v85, v87, v87
  v_sub_f32 v87, v13, v86
  v_fmac_f32 v85, v87, v87
  v_sub_f32 v87, v14, v86
  v_fmac_f32 v85, v87, v87
  v_sub_f32 v87, v15, v86
  v_fmac_f32 v85, v87, v87
  v_sub_f32 v87, v16, v86
  v_fmac_f32 v85, v87, v87
  v_sub_f32 v87, v17, v86
  v_fmac_f32 v85, v87, v87
  v_sub_f32 v87, v18, v86
  v_fmac_f32 v85, v87, v87
  v_sub_f32 v87, v19, v86
  v_fmac_f32 v85, v87, v87
  v_sub_f32 v87, v20, v86
  v_fmac_f32 v85, v87, v87
  v_sub_f32 v87, v21, v86
  v_fmac_f32 v85, v87, v87
  v_sub_f32 v87, v22, v86
  v_fmac_f32 v85, v87, v87
  v_sub_f32 v87, v23, v86
  v_fmac_f32 v85, v87, v87
  v_sub_f32 v87, v24, v86
  v_fmac_f32 v85, v87, v87
  v_sub_f32 v87, v25, v86
  v_fmac_f32 v85, v87, v87
  v_sub_f32 v87, v26, v86
  v_fmac_f32 v85, v87, v87
  v_sub_f32 v87, v27, v86
  v_fmac_f32 v85, v87, v87
  v_sub_f32 v87, v28, v86
  v_fmac_f32 v85, v87, v87
  v_sub_f32 v87, v29, v86
  v_fmac_f32 v85, v87, v87
  v_sub_f32 v87, v30, v86
  v_fmac_f32 v85, v87, v87
  v_sub_f32 v87, v31, v86
  v_fmac_f32 v85, v87, v87
  v_sub_f32 v87, v32, v86
  v_fmac_f32 v85, v87, v87
  v_sub_f32 v87, v33, v86
  v_fmac_f32 v85, v87, v87
  v_sub_f32 v87, v34, v86
  v_fmac_f32 v85, v87, v87
  v_sub_f32 v87, v35, v86
  v_fmac_f32 v85, v87, v87
  v_sub_f32 v87, v36, v86
  v_fmac_f32 v85, v87, v87
  v_sub_f32 v87, v37, v86
  v_fmac_f32 v85, v87, v87
  v_sub_f32 v87, v38, v86
  v_fmac_f32 v85, v87, v87
  v_sub_f32 v87, v39, v86
  v_fmac_f32 v85, v87, v87
  v_sub_f32 v87, v40, v86
  v_fmac_f32 v85, v87, v87
  v_sub_f32 v87, v41, v86
  v_fmac_f32 v85, v87, v87
  v_sub_f32 v87, v42, v86
  v_fmac_f32 v85, v87, v87
  v_sub_f32 v87, v43, v86
  v_fmac_f32 v85, v87, v87
  v_sub_f32 v87, v44, v86
  v_fmac_f32 v85, v87, v87
  v_sub_f32 v87, v45, v86
  v_fmac_f32 v85, v87, v87
  v_sub_f32 v87, v46, v86
  v_fmac_f32 v85, v87, v87
  v_sub_f32 v87, v47, v86
  v_fmac_f32 v85, v87, v87
  v_sub_f32 v87, v48, v86
  v_fmac_f32 v85, v87, v87
  v_sub_f32 v87, v49, v86
  v_fmac_f32 v85, v87, v87
  v_sub_f32 v87, v50, v86
  v_fmac_f32 v85, v87, v87
  v_sub_f32 v87, v51, v86
  v_fmac_f32 v85, v87, v87
  v_sub_f32 v87, v52, v86
  v_fmac_f32 v85, v87, v87
  v_sub_f32 v87, v53, v86
  v_fmac_f32 v85, v87, v87
  v_sub_f32 v87, v54, v86
  v_fmac_f32 v85, v87, v87
  v_sub_f32 v87, v55, v86
  v_fmac_f32 v85, v87, v87
  v_sub_f32 v87, v56, v86
  v_fmac_f32 v85, v87, v87
  v_sub_f32 v87, v57, v86
  v_fmac_f32 v85, v87, v87
  v_sub_f32 v87, v58, v86
  v_fmac_f32 v85, v87, v87
  v_sub_f32 v87, v59, v86
  v_fmac_f32 v85, v87, v87
  v_sub_f32 v87, v60, v86
  v_fmac_f32 v85, v87, v87
  v_sub_f32 v87, v61, v86
  v_fmac_f32 v85, v87, v87
  v_sub_f32 v87, v62, v86
  v_fmac_f32 v85, v87, v87
  v_sub_f32 v87, v63, v86
  v_fmac_f32 v85, v87, v87
  v_sub_f32 v87, v64, v86
  v_fmac_f32 v85, v87, v87
  v_sub_f32 v87, v65, v86
  v_fmac_f32 v85, v87, v87
  v_sub_f32 v87, v66, v86
  v_fmac_f32 v85, v87, v87
  v_sub_f32 v87, v67, v86
  v_fmac_f32 v85, v87, v87
  v_sub_f32 v87, v68, v86
  v_fmac_f32 v85, v87, v87
  v_sub_f32 v87, v69, v86
  v_fmac_f32 v85, v87, v87
  v_sub_f32 v87, v70, v86
  v_fmac_f32 v85, v87, v87
  v_sub_f32 v87, v71, v86
  v_fmac_f32 v85, v87, v87
  v_sub_f32 v87, v72, v86
  v_fmac_f32 v85, v87, v87
  v_sub_f32 v87, v73, v86
  v_fmac_f32 v85, v87, v87
  v_sub_f32 v87, v74, v86
  v_fmac_f32 v85, v87, v87
  v_sub_f32 v87, v75, v86
  v_fmac_f32 v85, v87, v87
  v_sub_f32 v87, v76, v86
  v_fmac_f32 v85, v87, v87
  v_sub_f32 v87, v77, v86
  v_fmac_f32 v85, v87, v87
  v_sub_f32 v87, v78, v86
  v_fmac_f32 v85, v87, v87
  v_sub_f32 v87, v79, v86
  v_fmac_f32 v85, v87, v87
  v_sub_f32 v87, v80, v86
  v_fmac_f32 v85, v87, v87
  v_sub_f32 v87, v81, v86
  v_fmac_f32 v85, v87, v87
  v_sub_f32 v87, v82, v86
  v_fmac_f32 v85, v87, v87
  v_sub_f32 v87, v83, v86
  v_fmac_f32 v85, v87, v87
  s_nop 1
  v_add_f32_dpp v88, v85, v85 quad_perm:[1,0,3,2] row_mask:0xf bank_mask:0xf
  s_nop 1
  v_add_f32_dpp v85, v88, v88 quad_perm:[2,3,0,1] row_mask:0xf bank_mask:0xf
  s_nop 1
  v_add_f32_dpp v88, v85, v85 row_half_mirror row_mask:0xf bank_mask:0xf
  v_mov_b32 v85, v88
  v_mul_f32 v85, 0x3ae38e39, v85
  v_cvt_pk_bf16_f32 v88, v86, v85
  v_lshlrev_b32 v86, 16, v88
  v_and_b32 v85, 0xffff0000, v88
  v_add_f32 v85, 0x3727c5ac, v85
  v_cvt_pk_bf16_f32 v85, v85, v85
  v_lshlrev_b32 v85, 16, v85
  v_sqrt_f32 v85, v85
  s_nop 0
  v_cvt_pk_bf16_f32 v85, v85, v85
  v_lshlrev_b32 v85, 16, v85
  v_rcp_f32 v85, v85
  s_nop 0
  v_sub_f32 v12, v12, v86
  v_sub_f32 v13, v13, v86
  v_cvt_pk_bf16_f32 v87, v12, v13
  v_lshlrev_b32 v12, 16, v87
  v_and_b32 v13, 0xffff0000, v87
  v_mul_f32 v12, v12, v85
  v_mul_f32 v13, v13, v85
  v_cvt_pk_bf16_f32 v87, v12, v13
  v_lshlrev_b32 v12, 16, v87
  v_and_b32 v13, 0xffff0000, v87
  v_sub_f32 v14, v14, v86
  v_sub_f32 v15, v15, v86
  v_cvt_pk_bf16_f32 v87, v14, v15
  v_lshlrev_b32 v14, 16, v87
  v_and_b32 v15, 0xffff0000, v87
  v_mul_f32 v14, v14, v85
  v_mul_f32 v15, v15, v85
  v_cvt_pk_bf16_f32 v87, v14, v15
  v_lshlrev_b32 v14, 16, v87
  v_and_b32 v15, 0xffff0000, v87
  v_sub_f32 v16, v16, v86
  v_sub_f32 v17, v17, v86
  v_cvt_pk_bf16_f32 v87, v16, v17
  v_lshlrev_b32 v16, 16, v87
  v_and_b32 v17, 0xffff0000, v87
  v_mul_f32 v16, v16, v85
  v_mul_f32 v17, v17, v85
  v_cvt_pk_bf16_f32 v87, v16, v17
  v_lshlrev_b32 v16, 16, v87
  v_and_b32 v17, 0xffff0000, v87
  v_sub_f32 v18, v18, v86
  v_sub_f32 v19, v19, v86
  v_cvt_pk_bf16_f32 v87, v18, v19
  v_lshlrev_b32 v18, 16, v87
  v_and_b32 v19, 0xffff0000, v87
  v_mul_f32 v18, v18, v85
  v_mul_f32 v19, v19, v85
  v_cvt_pk_bf16_f32 v87, v18, v19
  v_lshlrev_b32 v18, 16, v87
  v_and_b32 v19, 0xffff0000, v87
  v_sub_f32 v20, v20, v86
  v_sub_f32 v21, v21, v86
  v_cvt_pk_bf16_f32 v87, v20, v21
  v_lshlrev_b32 v20, 16, v87
  v_and_b32 v21, 0xffff0000, v87
  v_mul_f32 v20, v20, v85
  v_mul_f32 v21, v21, v85
  v_cvt_pk_bf16_f32 v87, v20, v21
  v_lshlrev_b32 v20, 16, v87
  v_and_b32 v21, 0xffff0000, v87
  v_sub_f32 v22, v22, v86
  v_sub_f32 v23, v23, v86
  v_cvt_pk_bf16_f32 v87, v22, v23
  v_lshlrev_b32 v22, 16, v87
  v_and_b32 v23, 0xffff0000, v87
  v_mul_f32 v22, v22, v85
  v_mul_f32 v23, v23, v85
  v_cvt_pk_bf16_f32 v87, v22, v23
  v_lshlrev_b32 v22, 16, v87
  v_and_b32 v23, 0xffff0000, v87
  v_sub_f32 v24, v24, v86
  v_sub_f32 v25, v25, v86
  v_cvt_pk_bf16_f32 v87, v24, v25
  v_lshlrev_b32 v24, 16, v87
  v_and_b32 v25, 0xffff0000, v87
  v_mul_f32 v24, v24, v85
  v_mul_f32 v25, v25, v85
  v_cvt_pk_bf16_f32 v87, v24, v25
  v_lshlrev_b32 v24, 16, v87
  v_and_b32 v25, 0xffff0000, v87
  v_sub_f32 v26, v26, v86
  v_sub_f32 v27, v27, v86
  v_cvt_pk_bf16_f32 v87, v26, v27
  v_lshlrev_b32 v26, 16, v87
  v_and_b32 v27, 0xffff0000, v87
  v_mul_f32 v26, v26, v85
  v_mul_f32 v27, v27, v85
  v_cvt_pk_bf16_f32 v87, v26, v27
  v_lshlrev_b32 v26, 16, v87
  v_and_b32 v27, 0xffff0000, v87
  v_sub_f32 v28, v28, v86
  v_sub_f32 v29, v29, v86
  v_cvt_pk_bf16_f32 v87, v28, v29
  v_lshlrev_b32 v28, 16, v87
  v_and_b32 v29, 0xffff0000, v87
  v_mul_f32 v28, v28, v85
  v_mul_f32 v29, v29, v85
  v_cvt_pk_bf16_f32 v87, v28, v29
  v_lshlrev_b32 v28, 16, v87
  v_and_b32 v29, 0xffff0000, v87
  v_sub_f32 v30, v30, v86
  v_sub_f32 v31, v31, v86
  v_cvt_pk_bf16_f32 v87, v30, v31
  v_lshlrev_b32 v30, 16, v87
  v_and_b32 v31, 0xffff0000, v87
  v_mul_f32 v30, v30, v85
  v_mul_f32 v31, v31, v85
  v_cvt_pk_bf16_f32 v87, v30, v31
  v_lshlrev_b32 v30, 16, v87
  v_and_b32 v31, 0xffff0000, v87
  v_sub_f32 v32, v32, v86
  v_sub_f32 v33, v33, v86
  v_cvt_pk_bf16_f32 v87, v32, v33
  v_lshlrev_b32 v32, 16, v87
  v_and_b32 v33, 0xffff0000, v87
  v_mul_f32 v32, v32, v85
  v_mul_f32 v33, v33, v85
  v_cvt_pk_bf16_f32 v87, v32, v33
  v_lshlrev_b32 v32, 16, v87
  v_and_b32 v33, 0xffff0000, v87
  v_sub_f32 v34, v34, v86
  v_sub_f32 v35, v35, v86
  v_cvt_pk_bf16_f32 v87, v34, v35
  v_lshlrev_b32 v34, 16, v87
  v_and_b32 v35, 0xffff0000, v87
  v_mul_f32 v34, v34, v85
  v_mul_f32 v35, v35, v85
  v_cvt_pk_bf16_f32 v87, v34, v35
  v_lshlrev_b32 v34, 16, v87
  v_and_b32 v35, 0xffff0000, v87
  v_sub_f32 v36, v36, v86
  v_sub_f32 v37, v37, v86
  v_cvt_pk_bf16_f32 v87, v36, v37
  v_lshlrev_b32 v36, 16, v87
  v_and_b32 v37, 0xffff0000, v87
  v_mul_f32 v36, v36, v85
  v_mul_f32 v37, v37, v85
  v_cvt_pk_bf16_f32 v87, v36, v37
  v_lshlrev_b32 v36, 16, v87
  v_and_b32 v37, 0xffff0000, v87
  v_sub_f32 v38, v38, v86
  v_sub_f32 v39, v39, v86
  v_cvt_pk_bf16_f32 v87, v38, v39
  v_lshlrev_b32 v38, 16, v87
  v_and_b32 v39, 0xffff0000, v87
  v_mul_f32 v38, v38, v85
  v_mul_f32 v39, v39, v85
  v_cvt_pk_bf16_f32 v87, v38, v39
  v_lshlrev_b32 v38, 16, v87
  v_and_b32 v39, 0xffff0000, v87
  v_sub_f32 v40, v40, v86
  v_sub_f32 v41, v41, v86
  v_cvt_pk_bf16_f32 v87, v40, v41
  v_lshlrev_b32 v40, 16, v87
  v_and_b32 v41, 0xffff0000, v87
  v_mul_f32 v40, v40, v85
  v_mul_f32 v41, v41, v85
  v_cvt_pk_bf16_f32 v87, v40, v41
  v_lshlrev_b32 v40, 16, v87
  v_and_b32 v41, 0xffff0000, v87
  v_sub_f32 v42, v42, v86
  v_sub_f32 v43, v43, v86
  v_cvt_pk_bf16_f32 v87, v42, v43
  v_lshlrev_b32 v42, 16, v87
  v_and_b32 v43, 0xffff0000, v87
  v_mul_f32 v42, v42, v85
  v_mul_f32 v43, v43, v85
  v_cvt_pk_bf16_f32 v87, v42, v43
  v_lshlrev_b32 v42, 16, v87
  v_and_b32 v43, 0xffff0000, v87
  v_sub_f32 v44, v44, v86
  v_sub_f32 v45, v45, v86
  v_cvt_pk_bf16_f32 v87, v44, v45
  v_lshlrev_b32 v44, 16, v87
  v_and_b32 v45, 0xffff0000, v87
  v_mul_f32 v44, v44, v85
  v_mul_f32 v45, v45, v85
  v_cvt_pk_bf16_f32 v87, v44, v45
  v_lshlrev_b32 v44, 16, v87
  v_and_b32 v45, 0xffff0000, v87
  v_sub_f32 v46, v46, v86
  v_sub_f32 v47, v47, v86
  v_cvt_pk_bf16_f32 v87, v46, v47
  v_lshlrev_b32 v46, 16, v87
  v_and_b32 v47, 0xffff0000, v87
  v_mul_f32 v46, v46, v85
  v_mul_f32 v47, v47, v85
  v_cvt_pk_bf16_f32 v87, v46, v47
  v_lshlrev_b32 v46, 16, v87
  v_and_b32 v47, 0xffff0000, v87
  v_sub_f32 v48, v48, v86
  v_sub_f32 v49, v49, v86
  v_cvt_pk_bf16_f32 v87, v48, v49
  v_lshlrev_b32 v48, 16, v87
  v_and_b32 v49, 0xffff0000, v87
  v_mul_f32 v48, v48, v85
  v_mul_f32 v49, v49, v85
  v_cvt_pk_bf16_f32 v87, v48, v49
  v_lshlrev_b32 v48, 16, v87
  v_and_b32 v49, 0xffff0000, v87
  v_sub_f32 v50, v50, v86
  v_sub_f32 v51, v51, v86
  v_cvt_pk_bf16_f32 v87, v50, v51
  v_lshlrev_b32 v50, 16, v87
  v_and_b32 v51, 0xffff0000, v87
  v_mul_f32 v50, v50, v85
  v_mul_f32 v51, v51, v85
  v_cvt_pk_bf16_f32 v87, v50, v51
  v_lshlrev_b32 v50, 16, v87
  v_and_b32 v51, 0xffff0000, v87
  v_sub_f32 v52, v52, v86
  v_sub_f32 v53, v53, v86
  v_cvt_pk_bf16_f32 v87, v52, v53
  v_lshlrev_b32 v52, 16, v87
  v_and_b32 v53, 0xffff0000, v87
  v_mul_f32 v52, v52, v85
  v_mul_f32 v53, v53, v85
  v_cvt_pk_bf16_f32 v87, v52, v53
  v_lshlrev_b32 v52, 16, v87
  v_and_b32 v53, 0xffff0000, v87
  v_sub_f32 v54, v54, v86
  v_sub_f32 v55, v55, v86
  v_cvt_pk_bf16_f32 v87, v54, v55
  v_lshlrev_b32 v54, 16, v87
  v_and_b32 v55, 0xffff0000, v87
  v_mul_f32 v54, v54, v85
  v_mul_f32 v55, v55, v85
  v_cvt_pk_bf16_f32 v87, v54, v55
  v_lshlrev_b32 v54, 16, v87
  v_and_b32 v55, 0xffff0000, v87
  v_sub_f32 v56, v56, v86
  v_sub_f32 v57, v57, v86
  v_cvt_pk_bf16_f32 v87, v56, v57
  v_lshlrev_b32 v56, 16, v87
  v_and_b32 v57, 0xffff0000, v87
  v_mul_f32 v56, v56, v85
  v_mul_f32 v57, v57, v85
  v_cvt_pk_bf16_f32 v87, v56, v57
  v_lshlrev_b32 v56, 16, v87
  v_and_b32 v57, 0xffff0000, v87
  v_sub_f32 v58, v58, v86
  v_sub_f32 v59, v59, v86
  v_cvt_pk_bf16_f32 v87, v58, v59
  v_lshlrev_b32 v58, 16, v87
  v_and_b32 v59, 0xffff0000, v87
  v_mul_f32 v58, v58, v85
  v_mul_f32 v59, v59, v85
  v_cvt_pk_bf16_f32 v87, v58, v59
  v_lshlrev_b32 v58, 16, v87
  v_and_b32 v59, 0xffff0000, v87
  v_sub_f32 v60, v60, v86
  v_sub_f32 v61, v61, v86
  v_cvt_pk_bf16_f32 v87, v60, v61
  v_lshlrev_b32 v60, 16, v87
  v_and_b32 v61, 0xffff0000, v87
  v_mul_f32 v60, v60, v85
  v_mul_f32 v61, v61, v85
  v_cvt_pk_bf16_f32 v87, v60, v61
  v_lshlrev_b32 v60, 16, v87
  v_and_b32 v61, 0xffff0000, v87
  v_sub_f32 v62, v62, v86
  v_sub_f32 v63, v63, v86
  v_cvt_pk_bf16_f32 v87, v62, v63
  v_lshlrev_b32 v62, 16, v87
  v_and_b32 v63, 0xffff0000, v87
  v_mul_f32 v62, v62, v85
  v_mul_f32 v63, v63, v85
  v_cvt_pk_bf16_f32 v87, v62, v63
  v_lshlrev_b32 v62, 16, v87
  v_and_b32 v63, 0xffff0000, v87
  v_sub_f32 v64, v64, v86
  v_sub_f32 v65, v65, v86
  v_cvt_pk_bf16_f32 v87, v64, v65
  v_lshlrev_b32 v64, 16, v87
  v_and_b32 v65, 0xffff0000, v87
  v_mul_f32 v64, v64, v85
  v_mul_f32 v65, v65, v85
  v_cvt_pk_bf16_f32 v87, v64, v65
  v_lshlrev_b32 v64, 16, v87
  v_and_b32 v65, 0xffff0000, v87
  v_sub_f32 v66, v66, v86
  v_sub_f32 v67, v67, v86
  v_cvt_pk_bf16_f32 v87, v66, v67
  v_lshlrev_b32 v66, 16, v87
  v_and_b32 v67, 0xffff0000, v87
  v_mul_f32 v66, v66, v85
  v_mul_f32 v67, v67, v85
  v_cvt_pk_bf16_f32 v87, v66, v67
  v_lshlrev_b32 v66, 16, v87
  v_and_b32 v67, 0xffff0000, v87
  v_sub_f32 v68, v68, v86
  v_sub_f32 v69, v69, v86
  v_cvt_pk_bf16_f32 v87, v68, v69
  v_lshlrev_b32 v68, 16, v87
  v_and_b32 v69, 0xffff0000, v87
  v_mul_f32 v68, v68, v85
  v_mul_f32 v69, v69, v85
  v_cvt_pk_bf16_f32 v87, v68, v69
  v_lshlrev_b32 v68, 16, v87
  v_and_b32 v69, 0xffff0000, v87
  v_sub_f32 v70, v70, v86
  v_sub_f32 v71, v71, v86
  v_cvt_pk_bf16_f32 v87, v70, v71
  v_lshlrev_b32 v70, 16, v87
  v_and_b32 v71, 0xffff0000, v87
  v_mul_f32 v70, v70, v85
  v_mul_f32 v71, v71, v85
  v_cvt_pk_bf16_f32 v87, v70, v71
  v_lshlrev_b32 v70, 16, v87
  v_and_b32 v71, 0xffff0000, v87
  v_sub_f32 v72, v72, v86
  v_sub_f32 v73, v73, v86
  v_cvt_pk_bf16_f32 v87, v72, v73
  v_lshlrev_b32 v72, 16, v87
  v_and_b32 v73, 0xffff0000, v87
  v_mul_f32 v72, v72, v85
  v_mul_f32 v73, v73, v85
  v_cvt_pk_bf16_f32 v87, v72, v73
  v_lshlrev_b32 v72, 16, v87
  v_and_b32 v73, 0xffff0000, v87
  v_sub_f32 v74, v74, v86
  v_sub_f32 v75, v75, v86
  v_cvt_pk_bf16_f32 v87, v74, v75
  v_lshlrev_b32 v74, 16, v87
  v_and_b32 v75, 0xffff0000, v87
  v_mul_f32 v74, v74, v85
  v_mul_f32 v75, v75, v85
  v_cvt_pk_bf16_f32 v87, v74, v75
  v_lshlrev_b32 v74, 16, v87
  v_and_b32 v75, 0xffff0000, v87
  v_sub_f32 v76, v76, v86
  v_sub_f32 v77, v77, v86
  v_cvt_pk_bf16_f32 v87, v76, v77
  v_lshlrev_b32 v76, 16, v87
  v_and_b32 v77, 0xffff0000, v87
  v_mul_f32 v76, v76, v85
  v_mul_f32 v77, v77, v85
  v_cvt_pk_bf16_f32 v87, v76, v77
  v_lshlrev_b32 v76, 16, v87
  v_and_b32 v77, 0xffff0000, v87
  v_sub_f32 v78, v78, v86
  v_sub_f32 v79, v79, v86
  v_cvt_pk_bf16_f32 v87, v78, v79
  v_lshlrev_b32 v78, 16, v87
  v_and_b32 v79, 0xffff0000, v87
  v_mul_f32 v78, v78, v85
  v_mul_f32 v79, v79, v85
  v_cvt_pk_bf16_f32 v87, v78, v79
  v_lshlrev_b32 v78, 16, v87
  v_and_b32 v79, 0xffff0000, v87
  v_sub_f32 v80, v80, v86
  v_sub_f32 v81, v81, v86
  v_cvt_pk_bf16_f32 v87, v80, v81
  v_lshlrev_b32 v80, 16, v87
  v_and_b32 v81, 0xffff0000, v87
  v_mul_f32 v80, v80, v85
  v_mul_f32 v81, v81, v85
  v_cvt_pk_bf16_f32 v87, v80, v81
  v_lshlrev_b32 v80, 16, v87
  v_and_b32 v81, 0xffff0000, v87
  v_sub_f32 v82, v82, v86
  v_sub_f32 v83, v83, v86
  v_cvt_pk_bf16_f32 v87, v82, v83
  v_lshlrev_b32 v82, 16, v87
  v_and_b32 v83, 0xffff0000, v87
  v_mul_f32 v82, v82, v85
  v_mul_f32 v83, v83, v85
  v_cvt_pk_bf16_f32 v87, v82, v83
  v_lshlrev_b32 v82, 16, v87
  v_and_b32 v83, 0xffff0000, v87
  s_mov_b32 s72, 32768
WC_48:
  buffer_load_dword v3, v1, s[40:43], 0 offen offset:136 sc1
  s_waitcnt vmcnt(0)
  v_cmp_gt_u32 vcc, 18, v3
  s_cbranch_vccz WCD_49
  s_sleep 2
  s_sub_u32 s72, s72, 1
  s_cmp_lg_u32 s72, 0
  s_cbranch_scc1 WC_48
  s_mov_b32 s68, 33
  s_branch L_ABORT
WCD_49:
  v_and_b32 v3, 7, v0
  v_lshlrev_b32_e64 v3, 4, v3
  s_mov_b32 s71, 65536
  buffer_load_dwordx4 v[120:123], v3, s[36:39], s71 offen offset:1152 sc1
  buffer_load_dwordx4 v[84:87], v3, s[36:39], s71 offen offset:0 sc1
  buffer_load_dwordx4 v[124:127], v3, s[36:39], s71 offen offset:1280 sc1
  buffer_load_dwordx4 v[88:91], v3, s[36:39], s71 offen offset:128 sc1
  buffer_load_dwordx4 v[128:131], v3, s[36:39], s71 offen offset:1408 sc1
  buffer_load_dwordx4 v[92:95], v3, s[36:39], s71 offen offset:256 sc1
  buffer_load_dwordx4 v[132:135], v3, s[36:39], s71 offen offset:1536 sc1
  buffer_load_dwordx4 v[96:99], v3, s[36:39], s71 offen offset:384 sc1
  buffer_load_dwordx4 v[136:139], v3, s[36:39], s71 offen offset:1664 sc1
  buffer_load_dwordx4 v[100:103], v3, s[36:39], s71 offen offset:512 sc1
  buffer_load_dwordx4 v[140:143], v3, s[36:39], s71 offen offset:1792 sc1
  buffer_load_dwordx4 v[104:107], v3, s[36:39], s71 offen offset:640 sc1
  buffer_load_dwordx4 v[144:147], v3, s[36:39], s71 offen offset:1920 sc1
  buffer_load_dwordx4 v[108:111], v3, s[36:39], s71 offen offset:768 sc1
  buffer_load_dwordx4 v[148:151], v3, s[36:39], s71 offen offset:2048 sc1
  buffer_load_dwordx4 v[112:115], v3, s[36:39], s71 offen offset:896 sc1
  buffer_load_dwordx4 v[152:155], v3, s[36:39], s71 offen offset:2176 sc1
  buffer_load_dwordx4 v[116:119], v3, s[36:39], s71 offen offset:1024 sc1
  v_and_b32 v3, 7, v0
  v_lshlrev_b32_e64 v6, 9, v3
  v_lshrrev_b32 v3, 3, v2
  v_lshl_add_u32 v6, v3, 4, v6
  s_mul_i32 s71, s73, 36864
  s_add_u32 s71, s71, 1048576
  s_waitcnt vmcnt(16)
  v_lshlrev_b32 v160, 16, v120
  v_and_b32 v161, 0xffff0000, v120
  v_add_f32 v160, 1.0, v160
  v_add_f32 v161, 1.0, v161
  v_cvt_pk_bf16_f32 v162, v160, v161
  v_lshlrev_b32 v160, 16, v162
  v_and_b32 v161, 0xffff0000, v162
  v_mul_f32 v160, v160, v12
  v_mul_f32 v161, v161, v13
  v_cvt_pk_bf16_f32 v162, v160, v161
  v_lshlrev_b32 v160, 16, v162
  v_and_b32 v161, 0xffff0000, v162
  v_lshlrev_b32 v162, 16, v84
  v_and_b32 v163, 0xffff0000, v84
  v_add_f32 v160, v160, v162
  v_add_f32 v161, v161, v163
  v_cvt_pk_bf16_f32 v84, v160, v161
  v_lshlrev_b32 v160, 16, v121
  v_and_b32 v161, 0xffff0000, v121
  v_add_f32 v160, 1.0, v160
  v_add_f32 v161, 1.0, v161
  v_cvt_pk_bf16_f32 v162, v160, v161
  v_lshlrev_b32 v160, 16, v162
  v_and_b32 v161, 0xffff0000, v162
  v_mul_f32 v160, v160, v14
  v_mul_f32 v161, v161, v15
  v_cvt_pk_bf16_f32 v162, v160, v161
  v_lshlrev_b32 v160, 16, v162
  v_and_b32 v161, 0xffff0000, v162
  v_lshlrev_b32 v162, 16, v85
  v_and_b32 v163, 0xffff0000, v85
  v_add_f32 v160, v160, v162
  v_add_f32 v161, v161, v163
  v_cvt_pk_bf16_f32 v85, v160, v161
  v_lshlrev_b32 v160, 16, v122
  v_and_b32 v161, 0xffff0000, v122
  v_add_f32 v160, 1.0, v160
  v_add_f32 v161, 1.0, v161
  v_cvt_pk_bf16_f32 v162, v160, v161
  v_lshlrev_b32 v160, 16, v162
  v_and_b32 v161, 0xffff0000, v162
  v_mul_f32 v160, v160, v16
  v_mul_f32 v161, v161, v17
  v_cvt_pk_bf16_f32 v162, v160, v161
  v_lshlrev_b32 v160, 16, v162
  v_and_b32 v161, 0xffff0000, v162
  v_lshlrev_b32 v162, 16, v86
  v_and_b32 v163, 0xffff0000, v86
  v_add_f32 v160, v160, v162
  v_add_f32 v161, v161, v163
  v_cvt_pk_bf16_f32 v86, v160, v161
  v_lshlrev_b32 v160, 16, v123
  v_and_b32 v161, 0xffff0000, v123
  v_add_f32 v160, 1.0, v160
  v_add_f32 v161, 1.0, v161
  v_cvt_pk_bf16_f32 v162, v160, v161
  v_lshlrev_b32 v160, 16, v162
  v_and_b32 v161, 0xffff0000, v162
  v_mul_f32 v160, v160, v18
  v_mul_f32 v161, v161, v19
  v_cvt_pk_bf16_f32 v162, v160, v161
  v_lshlrev_b32 v160, 16, v162
  v_and_b32 v161, 0xffff0000, v162
  v_lshlrev_b32 v162, 16, v87
  v_and_b32 v163, 0xffff0000, v87
  v_add_f32 v160, v160, v162
  v_add_f32_e64 v161, v161, v163
  v_cvt_pk_bf16_f32 v87, v160, v161
  buffer_store_dwordx4 v[84:87], v6, s[36:39], s71 offen sc1
  s_add_u32 s71, s71, 4096
  s_waitcnt vmcnt(15)
  v_lshlrev_b32 v160, 16, v124
  v_and_b32 v161, 0xffff0000, v124
  v_add_f32 v160, 1.0, v160
  v_add_f32 v161, 1.0, v161
  v_cvt_pk_bf16_f32 v162, v160, v161
  v_lshlrev_b32 v160, 16, v162
  v_and_b32 v161, 0xffff0000, v162
  v_mul_f32 v160, v160, v20
  v_mul_f32 v161, v161, v21
  v_cvt_pk_bf16_f32 v162, v160, v161
  v_lshlrev_b32 v160, 16, v162
  v_and_b32 v161, 0xffff0000, v162
  v_lshlrev_b32 v162, 16, v88
  v_and_b32 v163, 0xffff0000, v88
  v_add_f32 v160, v160, v162
  v_add_f32 v161, v161, v163
  v_cvt_pk_bf16_f32 v88, v160, v161
  v_lshlrev_b32 v160, 16, v125
  v_and_b32 v161, 0xffff0000, v125
  v_add_f32 v160, 1.0, v160
  v_add_f32 v161, 1.0, v161
  v_cvt_pk_bf16_f32 v162, v160, v161
  v_lshlrev_b32 v160, 16, v162
  v_and_b32 v161, 0xffff0000, v162
  v_mul_f32 v160, v160, v22
  v_mul_f32 v161, v161, v23
  v_cvt_pk_bf16_f32 v162, v160, v161
  v_lshlrev_b32 v160, 16, v162
  v_and_b32 v161, 0xffff0000, v162
  v_lshlrev_b32 v162, 16, v89
  v_and_b32 v163, 0xffff0000, v89
  v_add_f32 v160, v160, v162
  v_add_f32 v161, v161, v163
  v_cvt_pk_bf16_f32 v89, v160, v161
  v_lshlrev_b32 v160, 16, v126
  v_and_b32 v161, 0xffff0000, v126
  v_add_f32 v160, 1.0, v160
  v_add_f32 v161, 1.0, v161
  v_cvt_pk_bf16_f32 v162, v160, v161
  v_lshlrev_b32 v160, 16, v162
  v_and_b32 v161, 0xffff0000, v162
  v_mul_f32 v160, v160, v24
  v_mul_f32 v161, v161, v25
  v_cvt_pk_bf16_f32 v162, v160, v161
  v_lshlrev_b32 v160, 16, v162
  v_and_b32 v161, 0xffff0000, v162
  v_lshlrev_b32 v162, 16, v90
  v_and_b32 v163, 0xffff0000, v90
  v_add_f32 v160, v160, v162
  v_add_f32 v161, v161, v163
  v_cvt_pk_bf16_f32 v90, v160, v161
  v_lshlrev_b32 v160, 16, v127
  v_and_b32 v161, 0xffff0000, v127
  v_add_f32 v160, 1.0, v160
  v_add_f32 v161, 1.0, v161
  v_cvt_pk_bf16_f32 v162, v160, v161
  v_lshlrev_b32 v160, 16, v162
  v_and_b32 v161, 0xffff0000, v162
  v_mul_f32 v160, v160, v26
  v_mul_f32 v161, v161, v27
  v_cvt_pk_bf16_f32 v162, v160, v161
  v_lshlrev_b32 v160, 16, v162
  v_and_b32 v161, 0xffff0000, v162
  v_lshlrev_b32 v162, 16, v91
  v_and_b32 v163, 0xffff0000, v91
  v_add_f32 v160, v160, v162
  v_add_f32_e64 v161, v161, v163
  v_cvt_pk_bf16_f32 v91, v160, v161
  buffer_store_dwordx4 v[88:91], v6, s[36:39], s71 offen sc1
  s_add_u32 s71, s71, 4096
  s_waitcnt vmcnt(14)
  v_lshlrev_b32 v160, 16, v128
  v_and_b32 v161, 0xffff0000, v128
  v_add_f32 v160, 1.0, v160
  v_add_f32 v161, 1.0, v161
  v_cvt_pk_bf16_f32 v162, v160, v161
  v_lshlrev_b32 v160, 16, v162
  v_and_b32 v161, 0xffff0000, v162
  v_mul_f32 v160, v160, v28
  v_mul_f32 v161, v161, v29
  v_cvt_pk_bf16_f32 v162, v160, v161
  v_lshlrev_b32 v160, 16, v162
  v_and_b32 v161, 0xffff0000, v162
  v_lshlrev_b32 v162, 16, v92
  v_and_b32 v163, 0xffff0000, v92
  v_add_f32 v160, v160, v162
  v_add_f32 v161, v161, v163
  v_cvt_pk_bf16_f32 v92, v160, v161
  v_lshlrev_b32 v160, 16, v129
  v_and_b32 v161, 0xffff0000, v129
  v_add_f32 v160, 1.0, v160
  v_add_f32 v161, 1.0, v161
  v_cvt_pk_bf16_f32 v162, v160, v161
  v_lshlrev_b32 v160, 16, v162
  v_and_b32 v161, 0xffff0000, v162
  v_mul_f32 v160, v160, v30
  v_mul_f32 v161, v161, v31
  v_cvt_pk_bf16_f32 v162, v160, v161
  v_lshlrev_b32 v160, 16, v162
  v_and_b32 v161, 0xffff0000, v162
  v_lshlrev_b32 v162, 16, v93
  v_and_b32 v163, 0xffff0000, v93
  v_add_f32 v160, v160, v162
  v_add_f32 v161, v161, v163
  v_cvt_pk_bf16_f32 v93, v160, v161
  v_lshlrev_b32 v160, 16, v130
  v_and_b32 v161, 0xffff0000, v130
  v_add_f32 v160, 1.0, v160
  v_add_f32 v161, 1.0, v161
  v_cvt_pk_bf16_f32 v162, v160, v161
  v_lshlrev_b32 v160, 16, v162
  v_and_b32 v161, 0xffff0000, v162
  v_mul_f32 v160, v160, v32
  v_mul_f32 v161, v161, v33
  v_cvt_pk_bf16_f32 v162, v160, v161
  v_lshlrev_b32 v160, 16, v162
  v_and_b32 v161, 0xffff0000, v162
  v_lshlrev_b32 v162, 16, v94
  v_and_b32 v163, 0xffff0000, v94
  v_add_f32 v160, v160, v162
  v_add_f32 v161, v161, v163
  v_cvt_pk_bf16_f32 v94, v160, v161
  v_lshlrev_b32 v160, 16, v131
  v_and_b32 v161, 0xffff0000, v131
  v_add_f32 v160, 1.0, v160
  v_add_f32 v161, 1.0, v161
  v_cvt_pk_bf16_f32 v162, v160, v161
  v_lshlrev_b32 v160, 16, v162
  v_and_b32 v161, 0xffff0000, v162
  v_mul_f32 v160, v160, v34
  v_mul_f32 v161, v161, v35
  v_cvt_pk_bf16_f32 v162, v160, v161
  v_lshlrev_b32 v160, 16, v162
  v_and_b32 v161, 0xffff0000, v162
  v_lshlrev_b32 v162, 16, v95
  v_and_b32 v163, 0xffff0000, v95
  v_add_f32 v160, v160, v162
  v_add_f32_e64 v161, v161, v163
  v_cvt_pk_bf16_f32 v95, v160, v161
  buffer_store_dwordx4 v[92:95], v6, s[36:39], s71 offen sc1
  s_add_u32 s71, s71, 4096
  s_waitcnt vmcnt(13)
  v_lshlrev_b32 v160, 16, v132
  v_and_b32 v161, 0xffff0000, v132
  v_add_f32 v160, 1.0, v160
  v_add_f32 v161, 1.0, v161
  v_cvt_pk_bf16_f32 v162, v160, v161
  v_lshlrev_b32 v160, 16, v162
  v_and_b32 v161, 0xffff0000, v162
  v_mul_f32 v160, v160, v36
  v_mul_f32 v161, v161, v37
  v_cvt_pk_bf16_f32 v162, v160, v161
  v_lshlrev_b32 v160, 16, v162
  v_and_b32 v161, 0xffff0000, v162
  v_lshlrev_b32 v162, 16, v96
  v_and_b32 v163, 0xffff0000, v96
  v_add_f32 v160, v160, v162
  v_add_f32 v161, v161, v163
  v_cvt_pk_bf16_f32 v96, v160, v161
  v_lshlrev_b32 v160, 16, v133
  v_and_b32 v161, 0xffff0000, v133
  v_add_f32 v160, 1.0, v160
  v_add_f32 v161, 1.0, v161
  v_cvt_pk_bf16_f32 v162, v160, v161
  v_lshlrev_b32 v160, 16, v162
  v_and_b32 v161, 0xffff0000, v162
  v_mul_f32 v160, v160, v38
  v_mul_f32 v161, v161, v39
  v_cvt_pk_bf16_f32 v162, v160, v161
  v_lshlrev_b32 v160, 16, v162
  v_and_b32 v161, 0xffff0000, v162
  v_lshlrev_b32 v162, 16, v97
  v_and_b32 v163, 0xffff0000, v97
  v_add_f32 v160, v160, v162
  v_add_f32 v161, v161, v163
  v_cvt_pk_bf16_f32 v97, v160, v161
  v_lshlrev_b32 v160, 16, v134
  v_and_b32 v161, 0xffff0000, v134
  v_add_f32 v160, 1.0, v160
  v_add_f32 v161, 1.0, v161
  v_cvt_pk_bf16_f32 v162, v160, v161
  v_lshlrev_b32 v160, 16, v162
  v_and_b32 v161, 0xffff0000, v162
  v_mul_f32 v160, v160, v40
  v_mul_f32 v161, v161, v41
  v_cvt_pk_bf16_f32 v162, v160, v161
  v_lshlrev_b32 v160, 16, v162
  v_and_b32 v161, 0xffff0000, v162
  v_lshlrev_b32 v162, 16, v98
  v_and_b32 v163, 0xffff0000, v98
  v_add_f32 v160, v160, v162
  v_add_f32 v161, v161, v163
  v_cvt_pk_bf16_f32 v98, v160, v161
  v_lshlrev_b32 v160, 16, v135
  v_and_b32 v161, 0xffff0000, v135
  v_add_f32 v160, 1.0, v160
  v_add_f32 v161, 1.0, v161
  v_cvt_pk_bf16_f32 v162, v160, v161
  v_lshlrev_b32 v160, 16, v162
  v_and_b32 v161, 0xffff0000, v162
  v_mul_f32 v160, v160, v42
  v_mul_f32 v161, v161, v43
  v_cvt_pk_bf16_f32 v162, v160, v161
  v_lshlrev_b32 v160, 16, v162
  v_and_b32 v161, 0xffff0000, v162
  v_lshlrev_b32 v162, 16, v99
  v_and_b32 v163, 0xffff0000, v99
  v_add_f32 v160, v160, v162
  v_add_f32_e64 v161, v161, v163
  v_cvt_pk_bf16_f32 v99, v160, v161
  buffer_store_dwordx4 v[96:99], v6, s[36:39], s71 offen sc1
  s_add_u32 s71, s71, 4096
  s_waitcnt vmcnt(12)
  v_lshlrev_b32 v160, 16, v136
  v_and_b32 v161, 0xffff0000, v136
  v_add_f32 v160, 1.0, v160
  v_add_f32 v161, 1.0, v161
  v_cvt_pk_bf16_f32 v162, v160, v161
  v_lshlrev_b32 v160, 16, v162
  v_and_b32 v161, 0xffff0000, v162
  v_mul_f32 v160, v160, v44
  v_mul_f32 v161, v161, v45
  v_cvt_pk_bf16_f32 v162, v160, v161
  v_lshlrev_b32 v160, 16, v162
  v_and_b32 v161, 0xffff0000, v162
  v_lshlrev_b32 v162, 16, v100
  v_and_b32 v163, 0xffff0000, v100
  v_add_f32 v160, v160, v162
  v_add_f32 v161, v161, v163
  v_cvt_pk_bf16_f32 v100, v160, v161
  v_lshlrev_b32 v160, 16, v137
  v_and_b32 v161, 0xffff0000, v137
  v_add_f32 v160, 1.0, v160
  v_add_f32 v161, 1.0, v161
  v_cvt_pk_bf16_f32 v162, v160, v161
  v_lshlrev_b32 v160, 16, v162
  v_and_b32 v161, 0xffff0000, v162
  v_mul_f32 v160, v160, v46
  v_mul_f32 v161, v161, v47
  v_cvt_pk_bf16_f32 v162, v160, v161
  v_lshlrev_b32 v160, 16, v162
  v_and_b32 v161, 0xffff0000, v162
  v_lshlrev_b32 v162, 16, v101
  v_and_b32 v163, 0xffff0000, v101
  v_add_f32 v160, v160, v162
  v_add_f32 v161, v161, v163
  v_cvt_pk_bf16_f32 v101, v160, v161
  v_lshlrev_b32 v160, 16, v138
  v_and_b32 v161, 0xffff0000, v138
  v_add_f32 v160, 1.0, v160
  v_add_f32 v161, 1.0, v161
  v_cvt_pk_bf16_f32 v162, v160, v161
  v_lshlrev_b32 v160, 16, v162
  v_and_b32 v161, 0xffff0000, v162
  v_mul_f32 v160, v160, v48
  v_mul_f32 v161, v161, v49
  v_cvt_pk_bf16_f32 v162, v160, v161
  v_lshlrev_b32 v160, 16, v162
  v_and_b32 v161, 0xffff0000, v162
  v_lshlrev_b32 v162, 16, v102
  v_and_b32 v163, 0xffff0000, v102
  v_add_f32 v160, v160, v162
  v_add_f32 v161, v161, v163
  v_cvt_pk_bf16_f32 v102, v160, v161
  v_lshlrev_b32 v160, 16, v139
  v_and_b32 v161, 0xffff0000, v139
  v_add_f32 v160, 1.0, v160
  v_add_f32 v161, 1.0, v161
  v_cvt_pk_bf16_f32 v162, v160, v161
  v_lshlrev_b32 v160, 16, v162
  v_and_b32 v161, 0xffff0000, v162
  v_mul_f32 v160, v160, v50
  v_mul_f32 v161, v161, v51
  v_cvt_pk_bf16_f32 v162, v160, v161
  v_lshlrev_b32 v160, 16, v162
  v_and_b32 v161, 0xffff0000, v162
  v_lshlrev_b32 v162, 16, v103
  v_and_b32 v163, 0xffff0000, v103
  v_add_f32 v160, v160, v162
  v_add_f32_e64 v161, v161, v163
  v_cvt_pk_bf16_f32 v103, v160, v161
  buffer_store_dwordx4 v[100:103], v6, s[36:39], s71 offen sc1
  s_add_u32 s71, s71, 4096
  s_waitcnt vmcnt(11)
  v_lshlrev_b32 v160, 16, v140
  v_and_b32 v161, 0xffff0000, v140
  v_add_f32 v160, 1.0, v160
  v_add_f32 v161, 1.0, v161
  v_cvt_pk_bf16_f32 v162, v160, v161
  v_lshlrev_b32 v160, 16, v162
  v_and_b32 v161, 0xffff0000, v162
  v_mul_f32 v160, v160, v52
  v_mul_f32 v161, v161, v53
  v_cvt_pk_bf16_f32 v162, v160, v161
  v_lshlrev_b32 v160, 16, v162
  v_and_b32 v161, 0xffff0000, v162
  v_lshlrev_b32 v162, 16, v104
  v_and_b32 v163, 0xffff0000, v104
  v_add_f32 v160, v160, v162
  v_add_f32 v161, v161, v163
  v_cvt_pk_bf16_f32 v104, v160, v161
  v_lshlrev_b32 v160, 16, v141
  v_and_b32 v161, 0xffff0000, v141
  v_add_f32 v160, 1.0, v160
  v_add_f32 v161, 1.0, v161
  v_cvt_pk_bf16_f32 v162, v160, v161
  v_lshlrev_b32 v160, 16, v162
  v_and_b32 v161, 0xffff0000, v162
  v_mul_f32 v160, v160, v54
  v_mul_f32 v161, v161, v55
  v_cvt_pk_bf16_f32 v162, v160, v161
  v_lshlrev_b32 v160, 16, v162
  v_and_b32 v161, 0xffff0000, v162
  v_lshlrev_b32 v162, 16, v105
  v_and_b32 v163, 0xffff0000, v105
  v_add_f32 v160, v160, v162
  v_add_f32 v161, v161, v163
  v_cvt_pk_bf16_f32 v105, v160, v161
  v_lshlrev_b32 v160, 16, v142
  v_and_b32 v161, 0xffff0000, v142
  v_add_f32 v160, 1.0, v160
  v_add_f32 v161, 1.0, v161
  v_cvt_pk_bf16_f32 v162, v160, v161
  v_lshlrev_b32 v160, 16, v162
  v_and_b32 v161, 0xffff0000, v162
  v_mul_f32 v160, v160, v56
  v_mul_f32 v161, v161, v57
  v_cvt_pk_bf16_f32 v162, v160, v161
  v_lshlrev_b32 v160, 16, v162
  v_and_b32 v161, 0xffff0000, v162
  v_lshlrev_b32 v162, 16, v106
  v_and_b32 v163, 0xffff0000, v106
  v_add_f32 v160, v160, v162
  v_add_f32 v161, v161, v163
  v_cvt_pk_bf16_f32 v106, v160, v161
  v_lshlrev_b32 v160, 16, v143
  v_and_b32 v161, 0xffff0000, v143
  v_add_f32 v160, 1.0, v160
  v_add_f32 v161, 1.0, v161
  v_cvt_pk_bf16_f32 v162, v160, v161
  v_lshlrev_b32 v160, 16, v162
  v_and_b32 v161, 0xffff0000, v162
  v_mul_f32 v160, v160, v58
  v_mul_f32 v161, v161, v59
  v_cvt_pk_bf16_f32 v162, v160, v161
  v_lshlrev_b32 v160, 16, v162
  v_and_b32 v161, 0xffff0000, v162
  v_lshlrev_b32 v162, 16, v107
  v_and_b32 v163, 0xffff0000, v107
  v_add_f32 v160, v160, v162
  v_add_f32_e64 v161, v161, v163
  v_cvt_pk_bf16_f32 v107, v160, v161
  buffer_store_dwordx4 v[104:107], v6, s[36:39], s71 offen sc1
  s_add_u32 s71, s71, 4096
  s_waitcnt vmcnt(10)
  v_lshlrev_b32 v160, 16, v144
  v_and_b32 v161, 0xffff0000, v144
  v_add_f32 v160, 1.0, v160
  v_add_f32 v161, 1.0, v161
  v_cvt_pk_bf16_f32 v162, v160, v161
  v_lshlrev_b32 v160, 16, v162
  v_and_b32 v161, 0xffff0000, v162
  v_mul_f32 v160, v160, v60
  v_mul_f32 v161, v161, v61
  v_cvt_pk_bf16_f32 v162, v160, v161
  v_lshlrev_b32 v160, 16, v162
  v_and_b32 v161, 0xffff0000, v162
  v_lshlrev_b32 v162, 16, v108
  v_and_b32 v163, 0xffff0000, v108
  v_add_f32 v160, v160, v162
  v_add_f32 v161, v161, v163
  v_cvt_pk_bf16_f32 v108, v160, v161
  v_lshlrev_b32 v160, 16, v145
  v_and_b32 v161, 0xffff0000, v145
  v_add_f32 v160, 1.0, v160
  v_add_f32 v161, 1.0, v161
  v_cvt_pk_bf16_f32 v162, v160, v161
  v_lshlrev_b32 v160, 16, v162
  v_and_b32 v161, 0xffff0000, v162
  v_mul_f32 v160, v160, v62
  v_mul_f32 v161, v161, v63
  v_cvt_pk_bf16_f32 v162, v160, v161
  v_lshlrev_b32 v160, 16, v162
  v_and_b32 v161, 0xffff0000, v162
  v_lshlrev_b32 v162, 16, v109
  v_and_b32 v163, 0xffff0000, v109
  v_add_f32 v160, v160, v162
  v_add_f32 v161, v161, v163
  v_cvt_pk_bf16_f32 v109, v160, v161
  v_lshlrev_b32 v160, 16, v146
  v_and_b32 v161, 0xffff0000, v146
  v_add_f32 v160, 1.0, v160
  v_add_f32 v161, 1.0, v161
  v_cvt_pk_bf16_f32 v162, v160, v161
  v_lshlrev_b32 v160, 16, v162
  v_and_b32 v161, 0xffff0000, v162
  v_mul_f32 v160, v160, v64
  v_mul_f32 v161, v161, v65
  v_cvt_pk_bf16_f32 v162, v160, v161
  v_lshlrev_b32 v160, 16, v162
  v_and_b32 v161, 0xffff0000, v162
  v_lshlrev_b32 v162, 16, v110
  v_and_b32 v163, 0xffff0000, v110
  v_add_f32 v160, v160, v162
  v_add_f32 v161, v161, v163
  v_cvt_pk_bf16_f32 v110, v160, v161
  v_lshlrev_b32 v160, 16, v147
  v_and_b32 v161, 0xffff0000, v147
  v_add_f32 v160, 1.0, v160
  v_add_f32 v161, 1.0, v161
  v_cvt_pk_bf16_f32 v162, v160, v161
  v_lshlrev_b32 v160, 16, v162
  v_and_b32 v161, 0xffff0000, v162
  v_mul_f32 v160, v160, v66
  v_mul_f32 v161, v161, v67
  v_cvt_pk_bf16_f32 v162, v160, v161
  v_lshlrev_b32 v160, 16, v162
  v_and_b32 v161, 0xffff0000, v162
  v_lshlrev_b32 v162, 16, v111
  v_and_b32 v163, 0xffff0000, v111
  v_add_f32 v160, v160, v162
  v_add_f32_e64 v161, v161, v163
  v_cvt_pk_bf16_f32 v111, v160, v161
  buffer_store_dwordx4 v[108:111], v6, s[36:39], s71 offen sc1
  s_add_u32 s71, s71, 4096
  s_waitcnt vmcnt(9)
  v_lshlrev_b32 v160, 16, v148
  v_and_b32 v161, 0xffff0000, v148
  v_add_f32 v160, 1.0, v160
  v_add_f32 v161, 1.0, v161
  v_cvt_pk_bf16_f32 v162, v160, v161
  v_lshlrev_b32 v160, 16, v162
  v_and_b32 v161, 0xffff0000, v162
  v_mul_f32 v160, v160, v68
  v_mul_f32 v161, v161, v69
  v_cvt_pk_bf16_f32 v162, v160, v161
  v_lshlrev_b32 v160, 16, v162
  v_and_b32 v161, 0xffff0000, v162
  v_lshlrev_b32 v162, 16, v112
  v_and_b32 v163, 0xffff0000, v112
  v_add_f32 v160, v160, v162
  v_add_f32 v161, v161, v163
  v_cvt_pk_bf16_f32 v112, v160, v161
  v_lshlrev_b32 v160, 16, v149
  v_and_b32 v161, 0xffff0000, v149
  v_add_f32 v160, 1.0, v160
  v_add_f32 v161, 1.0, v161
  v_cvt_pk_bf16_f32 v162, v160, v161
  v_lshlrev_b32 v160, 16, v162
  v_and_b32 v161, 0xffff0000, v162
  v_mul_f32 v160, v160, v70
  v_mul_f32 v161, v161, v71
  v_cvt_pk_bf16_f32 v162, v160, v161
  v_lshlrev_b32 v160, 16, v162
  v_and_b32 v161, 0xffff0000, v162
  v_lshlrev_b32 v162, 16, v113
  v_and_b32 v163, 0xffff0000, v113
  v_add_f32 v160, v160, v162
  v_add_f32 v161, v161, v163
  v_cvt_pk_bf16_f32 v113, v160, v161
  v_lshlrev_b32 v160, 16, v150
  v_and_b32 v161, 0xffff0000, v150
  v_add_f32 v160, 1.0, v160
  v_add_f32 v161, 1.0, v161
  v_cvt_pk_bf16_f32 v162, v160, v161
  v_lshlrev_b32 v160, 16, v162
  v_and_b32 v161, 0xffff0000, v162
  v_mul_f32 v160, v160, v72
  v_mul_f32 v161, v161, v73
  v_cvt_pk_bf16_f32 v162, v160, v161
  v_lshlrev_b32 v160, 16, v162
  v_and_b32 v161, 0xffff0000, v162
  v_lshlrev_b32 v162, 16, v114
  v_and_b32 v163, 0xffff0000, v114
  v_add_f32 v160, v160, v162
  v_add_f32 v161, v161, v163
  v_cvt_pk_bf16_f32 v114, v160, v161
  v_lshlrev_b32 v160, 16, v151
  v_and_b32 v161, 0xffff0000, v151
  v_add_f32 v160, 1.0, v160
  v_add_f32 v161, 1.0, v161
  v_cvt_pk_bf16_f32 v162, v160, v161
  v_lshlrev_b32 v160, 16, v162
  v_and_b32 v161, 0xffff0000, v162
  v_mul_f32 v160, v160, v74
  v_mul_f32 v161, v161, v75
  v_cvt_pk_bf16_f32 v162, v160, v161
  v_lshlrev_b32 v160, 16, v162
  v_and_b32 v161, 0xffff0000, v162
  v_lshlrev_b32 v162, 16, v115
  v_and_b32 v163, 0xffff0000, v115
  v_add_f32 v160, v160, v162
  v_add_f32_e64 v161, v161, v163
  v_cvt_pk_bf16_f32 v115, v160, v161
  buffer_store_dwordx4 v[112:115], v6, s[36:39], s71 offen sc1
  s_add_u32 s71, s71, 4096
  s_waitcnt vmcnt(8)
  v_lshlrev_b32 v160, 16, v152
  v_and_b32 v161, 0xffff0000, v152
  v_add_f32 v160, 1.0, v160
  v_add_f32 v161, 1.0, v161
  v_cvt_pk_bf16_f32 v162, v160, v161
  v_lshlrev_b32 v160, 16, v162
  v_and_b32 v161, 0xffff0000, v162
  v_mul_f32 v160, v160, v76
  v_mul_f32 v161, v161, v77
  v_cvt_pk_bf16_f32 v162, v160, v161
  v_lshlrev_b32 v160, 16, v162
  v_and_b32 v161, 0xffff0000, v162
  v_lshlrev_b32 v162, 16, v116
  v_and_b32 v163, 0xffff0000, v116
  v_add_f32 v160, v160, v162
  v_add_f32 v161, v161, v163
  v_cvt_pk_bf16_f32 v116, v160, v161
  v_lshlrev_b32 v160, 16, v153
  v_and_b32 v161, 0xffff0000, v153
  v_add_f32 v160, 1.0, v160
  v_add_f32 v161, 1.0, v161
  v_cvt_pk_bf16_f32 v162, v160, v161
  v_lshlrev_b32 v160, 16, v162
  v_and_b32 v161, 0xffff0000, v162
  v_mul_f32 v160, v160, v78
  v_mul_f32 v161, v161, v79
  v_cvt_pk_bf16_f32 v162, v160, v161
  v_lshlrev_b32 v160, 16, v162
  v_and_b32 v161, 0xffff0000, v162
  v_lshlrev_b32 v162, 16, v117
  v_and_b32 v163, 0xffff0000, v117
  v_add_f32 v160, v160, v162
  v_add_f32 v161, v161, v163
  v_cvt_pk_bf16_f32 v117, v160, v161
  v_lshlrev_b32 v160, 16, v154
  v_and_b32 v161, 0xffff0000, v154
  v_add_f32 v160, 1.0, v160
  v_add_f32 v161, 1.0, v161
  v_cvt_pk_bf16_f32 v162, v160, v161
  v_lshlrev_b32 v160, 16, v162
  v_and_b32 v161, 0xffff0000, v162
  v_mul_f32 v160, v160, v80
  v_mul_f32 v161, v161, v81
  v_cvt_pk_bf16_f32 v162, v160, v161
  v_lshlrev_b32 v160, 16, v162
  v_and_b32 v161, 0xffff0000, v162
  v_lshlrev_b32 v162, 16, v118
  v_and_b32 v163, 0xffff0000, v118
  v_add_f32 v160, v160, v162
  v_add_f32 v161, v161, v163
  v_cvt_pk_bf16_f32 v118, v160, v161
  v_lshlrev_b32 v160, 16, v155
  v_and_b32 v161, 0xffff0000, v155
  v_add_f32 v160, 1.0, v160
  v_add_f32 v161, 1.0, v161
  v_cvt_pk_bf16_f32 v162, v160, v161
  v_lshlrev_b32 v160, 16, v162
  v_and_b32 v161, 0xffff0000, v162
  v_mul_f32 v160, v160, v82
  v_mul_f32 v161, v161, v83
  v_cvt_pk_bf16_f32 v162, v160, v161
  v_lshlrev_b32 v160, 16, v162
  v_and_b32 v161, 0xffff0000, v162
  v_lshlrev_b32 v162, 16, v119
  v_and_b32 v163, 0xffff0000, v119
  v_add_f32 v160, v160, v162
  v_add_f32_e64 v161, v161, v163
  v_cvt_pk_bf16_f32 v119, v160, v161
  buffer_store_dwordx4 v[116:119], v6, s[36:39], s71 offen sc1
  s_add_u32 s71, s71, 4096
  s_waitcnt vmcnt(0)
  s_barrier
  s_cmp_lg_u32 s64, 0
  s_cbranch_scc1 H1A_50
  v_mov_b32 v3, 1
  s_mov_b64 exec, 1
  s_cmp_ge_u32 s70, 54
  s_cselect_b32 s71, 4, 0
  buffer_atomic_add v3, v1, s[40:43], s71 offen offset:4
  s_mov_b64 exec, -1
H1A_50:
  v_lshlrev_b32 v4, 4, v0
  v_mov_b32 v8, -1
  v_mov_b32 v9, -1
  v_mov_b32 v10, -1
  v_mov_b32_e64 v11, -1
  s_mul_i32 s74, s64, 9216
  s_add_u32 s74, s74, s84
  buffer_store_dwordx4 v[8:11], v4, s[36:39], s74 offen offset:0
  buffer_store_dwordx4 v[8:11], v4, s[36:39], s74 offen offset:1024
  buffer_store_dwordx4 v[8:11], v4, s[36:39], s74 offen offset:2048
  s_add_u32 s74, s74, 3072
  buffer_store_dwordx4 v[8:11], v4, s[36:39], s74 offen offset:0
  buffer_store_dwordx4 v[8:11], v4, s[36:39], s74 offen offset:1024
  buffer_store_dwordx4 v[8:11], v4, s[36:39], s74 offen offset:2048
  s_add_u32 s74, s74, 3072
  buffer_store_dwordx4 v[8:11], v4, s[36:39], s74 offen offset:0
  buffer_store_dwordx4 v[8:11], v4, s[36:39], s74 offen offset:1024
  buffer_store_dwordx4 v[8:11], v4, s[36:39], s74 offen offset:2048
  s_add_u32 s74, s74, 1173504
  buffer_store_dwordx4 v[8:11], v4, s[36:39], s74 offen offset:0
  buffer_store_dwordx4 v[8:11], v4, s[36:39], s74 offen offset:1024
  buffer_store_dwordx4 v[8:11], v4, s[36:39], s74 offen offset:2048
  s_add_u32 s74, s74, 3072
  buffer_store_dwordx4 v[8:11], v4, s[36:39], s74 offen offset:0
  buffer_store_dwordx4 v[8:11], v4, s[36:39], s74 offen offset:1024
  buffer_store_dwordx4 v[8:11], v4, s[36:39], s74 offen offset:2048
  s_add_u32 s74, s74, 3072
  buffer_store_dwordx4 v[8:11], v4, s[36:39], s74 offen offset:0
  buffer_store_dwordx4 v[8:11], v4, s[36:39], s74 offen offset:1024
  buffer_store_dwordx4 v[8:11], v4, s[36:39], s74 offen offset:2048
  s_add_u32 s74, s74, 1173504
  s_lshl_b32 s74, s67, 5
  s_add_u32 s74, s74, s65
  s_lshl_b32 s74, s74, 2
  s_add_u32 s74, s74, s64
  s_lshl_b32 s74, s74, 10
  s_add_u32 s74, s74, 29360128
  buffer_store_dwordx4 v[8:11], v4, s[36:39], s74 offen sc1
  s_add_u32 s74, s74, 262144
  buffer_store_dwordx4 v[8:11], v4, s[36:39], s74 offen sc1
  s_add_u32 s74, s74, 262144
  buffer_store_dwordx4 v[8:11], v4, s[36:39], s74 offen sc1
  s_add_u32 s74, s74, 262144
  buffer_store_dwordx4 v[8:11], v4, s[36:39], s74 offen sc1
  s_add_u32 s74, s74, 262144
  buffer_store_dwordx4 v[8:11], v4, s[36:39], s74 offen sc1
  s_add_u32 s74, s74, 262144
  buffer_store_dwordx4 v[8:11], v4, s[36:39], s74 offen sc1
  s_add_u32 s74, s74, 262144
  buffer_store_dwordx4 v[8:11], v4, s[36:39], s74 offen sc1
  s_add_u32 s74, s74, 262144
  buffer_store_dwordx4 v[8:11], v4, s[36:39], s74 offen sc1
  s_add_u32 s74, s74, 262144
  s_waitcnt vmcnt(0)
  s_barrier
  v_mov_b32 v3, 0
  s_cmp_lg_u32 s64, 0
  s_cbranch_scc1 AI_51
  v_mov_b32_e64 v1, 1
  s_mov_b64 exec, 1
  buffer_atomic_add v1, v3, s[40:43], 0 offen offset:204
  s_mov_b64 exec, -1
AI_51:
  s_barrier
  s_mov_b32 s56, s14
  s_and_b32 s57, s15, 0xffff
  s_mov_b32 s58, 4718592
  s_mov_b32 s59, 0x20000
  v_mov_b32 v3, 0
  v_bfe_u32 v1, v0, 4, 2
  v_lshlrev_b32 v2, 0, v1
  v_mul_u32_u24 v4, 1152, v2
  v_bfe_u32 v1, v0, 0, 4
  v_lshl_add_u32 v4, v1, 4, v4
  s_lshl_b32 s77, s64, 13
  s_mul_i32 s78, s65, 147456
  s_mul_i32 s74, s64, 36864
  s_add_u32 s78, s78, s74
  v_bfe_u32 v1, v0, 5, 1
  v_lshlrev_b32_e64 v6, 12, v1
  v_bfe_u32 v1, v0, 4, 1
  v_lshl_add_u32 v6, v1, 10, v6
  v_bfe_u32 v1, v0, 2, 2
  v_lshl_add_u32 v6, v1, 8, v6
  v_bfe_u32 v1, v0, 0, 2
  v_lshl_add_u32 v6, v1, 3, v6
  s_lshl_b32 s74, s64, 5
  v_add_u32 v5, s74, v6
  v_add_u32_e64 v6, s74, v5
  s_add_u32 m0, s77, 0
  s_add_u32 s74, s78, 0
  buffer_load_dwordx4 v4, s[56:59], s74 offen lds
  s_add_u32 m0, s77, 1024
  s_add_u32 s74, s78, 4608
  buffer_load_dwordx4 v4, s[56:59], s74 offen lds
  s_add_u32 m0, s77, 2048
  s_add_u32 s74, s78, 9216
  buffer_load_dwordx4 v4, s[56:59], s74 offen lds
  s_add_u32 m0, s77, 3072
  s_add_u32 s74, s78, 13824
  buffer_load_dwordx4 v4, s[56:59], s74 offen lds
  s_add_u32 m0, s77, 4096
  s_add_u32 s74, s78, 18432
  buffer_load_dwordx4 v4, s[56:59], s74 offen lds
  s_add_u32 m0, s77, 5120
  s_add_u32 s74, s78, 23040
  buffer_load_dwordx4 v4, s[56:59], s74 offen lds
  s_add_u32 m0, s77, 6144
  s_add_u32 s74, s78, 27648
  buffer_load_dwordx4 v4, s[56:59], s74 offen lds
  s_add_u32 m0, s77, 7168
  s_add_u32 s74, s78, 32256
  buffer_load_dwordx4 v4, s[56:59], s74 offen lds
  s_add_u32 m0, s77, 32768
  s_add_u32 s74, s78, 256
  buffer_load_dwordx4 v4, s[56:59], s74 offen lds
  s_add_u32 m0, s77, 33792
  s_add_u32 s74, s78, 4864
  buffer_load_dwordx4 v4, s[56:59], s74 offen lds
  s_add_u32 m0, s77, 34816
  s_add_u32 s74, s78, 9472
  buffer_load_dwordx4 v4, s[56:59], s74 offen lds
  s_add_u32 m0, s77, 35840
  s_add_u32 s74, s78, 14080
  buffer_load_dwordx4 v4, s[56:59], s74 offen lds
  s_add_u32 m0, s77, 36864
  s_add_u32 s74, s78, 18688
  buffer_load_dwordx4 v4, s[56:59], s74 offen lds
  s_add_u32 m0, s77, 37888
  s_add_u32 s74, s78, 23296
  buffer_load_dwordx4 v4, s[56:59], s74 offen lds
  s_add_u32 m0, s77, 38912
  s_add_u32 s74, s78, 27904
  buffer_load_dwordx4 v4, s[56:59], s74 offen lds
  s_add_u32 m0, s77, 39936
  s_add_u32 s74, s78, 32512
  buffer_load_dwordx4 v4, s[56:59], s74 offen lds
  s_add_u32 m0, s77, 65536
  s_add_u32 s74, s78, 512
  buffer_load_dwordx4 v4, s[56:59], s74 offen lds
  s_add_u32 m0, s77, 66560
  s_add_u32 s74, s78, 5120
  buffer_load_dwordx4 v4, s[56:59], s74 offen lds
  s_add_u32 m0, s77, 67584
  s_add_u32 s74, s78, 9728
  buffer_load_dwordx4 v4, s[56:59], s74 offen lds
  s_add_u32 m0, s77, 68608
  s_add_u32 s74, s78, 14336
  buffer_load_dwordx4 v4, s[56:59], s74 offen lds
  s_add_u32 m0, s77, 69632
  s_add_u32 s74, s78, 18944
  buffer_load_dwordx4 v4, s[56:59], s74 offen lds
  s_add_u32 m0, s77, 70656
  s_add_u32 s74, s78, 23552
  buffer_load_dwordx4 v4, s[56:59], s74 offen lds
  s_add_u32 m0, s77, 71680
  s_add_u32 s74, s78, 28160
  buffer_load_dwordx4 v4, s[56:59], s74 offen lds
  s_add_u32 m0, s77, 72704
  s_add_u32 s74, s78, 32768
  buffer_load_dwordx4 v4, s[56:59], s74 offen lds
  s_add_u32 m0, s77, 98304
  s_add_u32 s74, s78, 768
  buffer_load_dwordx4 v4, s[56:59], s74 offen lds
  s_add_u32 m0, s77, 99328
  s_add_u32 s74, s78, 5376
  buffer_load_dwordx4 v4, s[56:59], s74 offen lds
  s_add_u32 m0, s77, 100352
  s_add_u32 s74, s78, 9984
  buffer_load_dwordx4 v4, s[56:59], s74 offen lds
  s_add_u32 m0, s77, 101376
  s_add_u32 s74, s78, 14592
  buffer_load_dwordx4 v4, s[56:59], s74 offen lds
  s_add_u32 m0, s77, 102400
  s_add_u32 s74, s78, 19200
  buffer_load_dwordx4 v4, s[56:59], s74 offen lds
  s_add_u32 m0, s77, 103424
  s_add_u32 s74, s78, 23808
  buffer_load_dwordx4 v4, s[56:59], s74 offen lds
  s_add_u32 m0, s77, 104448
  s_add_u32 s74, s78, 28416
  buffer_load_dwordx4 v4, s[56:59], s74 offen lds
  s_add_u32 m0, s77, 105472
  s_add_u32 s74, s78, 33024
  buffer_load_dwordx4 v4, s[56:59], s74 offen lds
  s_add_u32 m0, s77, 131072
  s_add_u32 s74, s78, 1024
  buffer_load_dwordx4 v4, s[56:59], s74 offen lds
  s_add_u32 m0, s77, 132096
  s_add_u32 s74, s78, 5632
  buffer_load_dwordx4 v4, s[56:59], s74 offen lds
  s_add_u32 m0, s77, 133120
  s_add_u32 s74, s78, 10240
  buffer_load_dwordx4 v4, s[56:59], s74 offen lds
  s_add_u32 m0, s77, 134144
  s_add_u32 s74, s78, 14848
  buffer_load_dwordx4 v4, s[56:59], s74 offen lds
  s_add_u32 m0, s77, 135168
  s_add_u32 s74, s78, 19456
  buffer_load_dwordx4 v4, s[56:59], s74 offen lds
  s_add_u32 m0, s77, 136192
  s_add_u32 s74, s78, 24064
  buffer_load_dwordx4 v4, s[56:59], s74 offen lds
  s_add_u32 m0, s77, 137216
  s_add_u32 s74, s78, 28672
  buffer_load_dwordx4 v4, s[56:59], s74 offen lds
  s_add_u32 m0, s77, 138240
  s_add_u32 s74, s78, 33280
  buffer_load_dwordx4 v4, s[56:59], s74 offen lds
  s_waitcnt vmcnt(32) lgkmcnt(0)
  s_barrier
  v_add_u32_e64 v2, 0, v6
  ds_read_b64_tr_b16 a[0:1], v2 offset:0
  ds_read_b64_tr_b16 a[2:3], v2 offset:2048
  ds_read_b64_tr_b16 a[16:17], v2 offset:32
  ds_read_b64_tr_b16 a[18:19], v2 offset:2080
  s_waitcnt lgkmcnt(8)
  ds_read_b64_tr_b16 a[4:5], v2 offset:8192
  ds_read_b64_tr_b16 a[6:7], v2 offset:10240
  ds_read_b64_tr_b16 a[20:21], v2 offset:8224
  ds_read_b64_tr_b16 a[22:23], v2 offset:10272
  s_waitcnt lgkmcnt(8)
  ds_read_b64_tr_b16 a[8:9], v2 offset:16384
  ds_read_b64_tr_b16 a[10:11], v2 offset:18432
  ds_read_b64_tr_b16 a[24:25], v2 offset:16416
  ds_read_b64_tr_b16 a[26:27], v2 offset:18464
  s_waitcnt lgkmcnt(8)
  ds_read_b64_tr_b16 a[12:13], v2 offset:24576
  ds_read_b64_tr_b16 a[14:15], v2 offset:26624
  ds_read_b64_tr_b16 a[28:29], v2 offset:24608
  ds_read_b64_tr_b16 a[30:31], v2 offset:26656
  s_waitcnt lgkmcnt(8)
  s_waitcnt vmcnt(24) lgkmcnt(0)
  s_barrier
  v_add_u32 v2, 32768, v6
  ds_read_b64_tr_b16 a[32:33], v2 offset:0
  ds_read_b64_tr_b16 a[34:35], v2 offset:2048
  ds_read_b64_tr_b16 a[48:49], v2 offset:32
  ds_read_b64_tr_b16 a[50:51], v2 offset:2080
  s_waitcnt lgkmcnt(8)
  ds_read_b64_tr_b16 a[36:37], v2 offset:8192
  ds_read_b64_tr_b16 a[38:39], v2 offset:10240
  ds_read_b64_tr_b16 a[52:53], v2 offset:8224
  ds_read_b64_tr_b16 a[54:55], v2 offset:10272
  s_waitcnt lgkmcnt(8)
  ds_read_b64_tr_b16 a[40:41], v2 offset:16384
  ds_read_b64_tr_b16 a[42:43], v2 offset:18432
  ds_read_b64_tr_b16 a[56:57], v2 offset:16416
  ds_read_b64_tr_b16 a[58:59], v2 offset:18464
  s_waitcnt lgkmcnt(8)
  ds_read_b64_tr_b16 a[44:45], v2 offset:24576
  ds_read_b64_tr_b16 a[46:47], v2 offset:26624
  ds_read_b64_tr_b16 a[60:61], v2 offset:24608
  ds_read_b64_tr_b16 a[62:63], v2 offset:26656
  s_waitcnt lgkmcnt(8)
  s_waitcnt vmcnt(16) lgkmcnt(0)
  s_barrier
  v_add_u32 v2, 65536, v6
  ds_read_b64_tr_b16 a[64:65], v2 offset:0
  ds_read_b64_tr_b16 a[66:67], v2 offset:2048
  ds_read_b64_tr_b16 a[80:81], v2 offset:32
  ds_read_b64_tr_b16 a[82:83], v2 offset:2080
  s_waitcnt lgkmcnt(8)
  ds_read_b64_tr_b16 a[68:69], v2 offset:8192
  ds_read_b64_tr_b16 a[70:71], v2 offset:10240
  ds_read_b64_tr_b16 a[84:85], v2 offset:8224
  ds_read_b64_tr_b16 a[86:87], v2 offset:10272
  s_waitcnt lgkmcnt(8)
  ds_read_b64_tr_b16 a[72:73], v2 offset:16384
  ds_read_b64_tr_b16 a[74:75], v2 offset:18432
  ds_read_b64_tr_b16 a[88:89], v2 offset:16416
  ds_read_b64_tr_b16 a[90:91], v2 offset:18464
  s_waitcnt lgkmcnt(8)
  ds_read_b64_tr_b16 a[76:77], v2 offset:24576
  ds_read_b64_tr_b16 a[78:79], v2 offset:26624
  ds_read_b64_tr_b16 a[92:93], v2 offset:24608
  ds_read_b64_tr_b16 a[94:95], v2 offset:26656
  s_waitcnt lgkmcnt(8)
  s_waitcnt vmcnt(8) lgkmcnt(0)
  s_barrier
  v_add_u32 v2, 98304, v6
  ds_read_b64_tr_b16 a[96:97], v2 offset:0
  ds_read_b64_tr_b16 a[98:99], v2 offset:2048
  ds_read_b64_tr_b16 a[112:113], v2 offset:32
  ds_read_b64_tr_b16 a[114:115], v2 offset:2080
  s_waitcnt lgkmcnt(8)
  ds_read_b64_tr_b16 a[100:101], v2 offset:8192
  ds_read_b64_tr_b16 a[102:103], v2 offset:10240
  ds_read_b64_tr_b16 a[116:117], v2 offset:8224
  ds_read_b64_tr_b16 a[118:119], v2 offset:10272
  s_waitcnt lgkmcnt(8)
  ds_read_b64_tr_b16 a[104:105], v2 offset:16384
  ds_read_b64_tr_b16 a[106:107], v2 offset:18432
  ds_read_b64_tr_b16 a[120:121], v2 offset:16416
  ds_read_b64_tr_b16 a[122:123], v2 offset:18464
  s_waitcnt lgkmcnt(8)
  ds_read_b64_tr_b16 a[108:109], v2 offset:24576
  ds_read_b64_tr_b16 a[110:111], v2 offset:26624
  ds_read_b64_tr_b16 a[124:125], v2 offset:24608
  ds_read_b64_tr_b16 a[126:127], v2 offset:26656
  s_waitcnt lgkmcnt(8)
  s_waitcnt vmcnt(0) lgkmcnt(0)
  s_barrier
  v_add_u32 v2, 131072, v5
  ds_read_b64_tr_b16 a[128:129], v2 offset:0
  ds_read_b64_tr_b16 a[130:131], v2 offset:2048
  s_waitcnt lgkmcnt(8)
  ds_read_b64_tr_b16 a[132:133], v2 offset:8192
  ds_read_b64_tr_b16 a[134:135], v2 offset:10240
  s_waitcnt lgkmcnt(8)
  ds_read_b64_tr_b16 a[136:137], v2 offset:16384
  ds_read_b64_tr_b16 a[138:139], v2 offset:18432
  s_waitcnt lgkmcnt(8)
  ds_read_b64_tr_b16 a[140:141], v2 offset:24576
  ds_read_b64_tr_b16 a[142:143], v2 offset:26624
  s_waitcnt lgkmcnt(8)
  s_waitcnt lgkmcnt(0)
  s_barrier
  v_and_b32 v1, 1, v0
  v_lshlrev_b32 v1, 4, v1
  v_mov_b32 v2, 0x3f80
  v_lshlrev_b32 v2, v1, v2
  v_bfe_u32 v1, v0, 2, 2
  v_cmp_eq_u32 vcc, 0, v1
  s_nop 1
  v_cndmask_b32 v28, 0, v2, vcc
  v_cmp_eq_u32 vcc, 1, v1
  s_nop 1
  v_cndmask_b32 v29, 0, v2, vcc
  v_cmp_eq_u32 vcc, 2, v1
  s_nop 1
  v_cndmask_b32 v30, 0, v2, vcc
  v_cmp_eq_u32 vcc, 3, v1
  s_nop 1
  v_cndmask_b32 v31, 0, v2, vcc
  v_bfe_u32 v1, v0, 4, 2
  v_lshlrev_b32 v2, 0, v1
  s_mov_b32 s74, 147456
  v_mul_lo_u32 v18, s74, v2
  v_mov_b32_e64 v19, v18
  v_bfe_u32 v1, v0, 0, 4
  v_lshl_add_u32 v18, v1, 4, v18
  v_bfe_u32 v1, v0, 0, 4
  v_lshl_add_u32 v19, v1, 1, v19
  s_lshl_b32 s74, s64, 8
  v_add_u32 v18, s74, v18
  s_lshl_b32 s74, s64, 5
  s_add_u32 s74, s74, 1024
  v_add_u32 v19, s74, v19
  v_bfe_u32 v1, v0, 4, 2
  v_lshlrev_b32_e64 v2, 0, v1
  v_mul_u32_u24 v20, 1152, v2
  v_bfe_u32 v1, v0, 0, 4
  v_lshl_add_u32 v20, v1, 4, v20
  s_lshl_b32 s74, s64, 8
  v_add_u32 v20, s74, v20
  v_bfe_u32 v1, v0, 3, 3
  v_lshlrev_b32_e64 v2, 0, v1
  v_mul_u32_u24 v21, 1152, v2
  v_bfe_u32 v1, v0, 0, 3
  v_lshl_add_u32 v21, v1, 4, v21
  s_mul_i32 s74, s64, 9216
  s_add_u32 s74, s74, 1024
  v_add_u32 v21, s74, v21
  v_bfe_u32 v1, v0, 4, 2
  v_lshlrev_b32 v22, 9, v1
  v_bfe_u32 v1, v0, 0, 4
  v_lshl_add_u32 v22, v1, 2, v22
  s_lshl_b32 s74, s64, 7
  s_add_u32 s74, s74, 12288
  v_add_u32 v22, s74, v22
  v_bfe_u32 v1, v0, 3, 1
  v_lshlrev_b32_e64 v23, 8, v1
  v_bfe_u32 v1, v0, 0, 3
  v_lshl_add_u32 v23, v1, 5, v23
  v_bfe_u32 v1, v0, 4, 2
  v_lshl_add_u32 v23, v1, 3, v23
  s_lshl_b32 s74, s64, 9
  s_add_u32 s74, s74, 14336
  v_add_u32 v23, s74, v23
  v_lshlrev_b32 v24, 5, v0
  v_lshlrev_b32 v25, 2, v0
  v_lshlrev_b32 v26, 4, v0
  v_lshlrev_b32 v27, 1, v0
  v_add_u32 v27, 1024, v27
  s_mov_b32 s75, 32768
WC_52:
  buffer_load_dword v1, v3, s[40:43], 0 offen offset:72 sc1
  s_waitcnt vmcnt(0)
  v_cmp_gt_u32 vcc, 36, v1
  s_cbranch_vccz WCD_53
  s_sleep 2
  s_sub_u32 s75, s75, 1
  s_cmp_lg_u32 s75, 0
  s_cbranch_scc1 WC_52
  s_mov_b32 s68, 54
  s_branch L_ABORT
WCD_53:
  s_mov_b32 s74, 67840
  buffer_load_dwordx4 v[216:219], v26, s[36:39], s74 offen offset:0 sc1
  buffer_load_ushort v220, v27, s[36:39], s74 offen offset:0 sc1
  buffer_load_dwordx4 v[224:227], v26, s[36:39], s74 offen offset:1152 sc1
  buffer_load_ushort v228, v27, s[36:39], s74 offen offset:1152 sc1
  buffer_load_dwordx4 v[232:235], v26, s[36:39], s74 offen offset:2304 sc1
  buffer_load_ushort v236, v27, s[36:39], s74 offen offset:2304 sc1
  s_waitcnt vmcnt(0)
  v_lshlrev_b32 v32, 16, v216
  v_and_b32 v33, 0xffff0000, v216
  v_lshlrev_b32 v34, 16, v217
  v_and_b32 v35, 0xffff0000, v217
  v_lshlrev_b32 v36, 16, v218
  v_and_b32 v37, 0xffff0000, v218
  v_lshlrev_b32 v38, 16, v219
  v_and_b32 v39, 0xffff0000, v219
  v_lshlrev_b32 v40, 16, v220
  v_lshlrev_b32 v52, 16, v224
  v_and_b32 v53, 0xffff0000, v224
  v_lshlrev_b32 v54, 16, v225
  v_and_b32 v55, 0xffff0000, v225
  v_lshlrev_b32 v56, 16, v226
  v_and_b32 v57, 0xffff0000, v226
  v_lshlrev_b32 v58, 16, v227
  v_and_b32 v59, 0xffff0000, v227
  v_lshlrev_b32 v60, 16, v228
  v_lshlrev_b32 v42, 16, v232
  v_and_b32 v43, 0xffff0000, v232
  v_lshlrev_b32 v44, 16, v233
  v_and_b32 v45, 0xffff0000, v233
  v_lshlrev_b32 v46, 16, v234
  v_and_b32 v47, 0xffff0000, v234
  v_lshlrev_b32 v48, 16, v235
  v_and_b32 v49, 0xffff0000, v235
  v_lshlrev_b32 v50, 16, v236
  v_add_f32 v42, 1.0, v42
  v_add_f32 v43, 1.0, v43
  v_add_f32 v44, 1.0, v44
  v_add_f32 v45, 1.0, v45
  v_add_f32 v46, 1.0, v46
  v_add_f32 v47, 1.0, v47
  v_add_f32 v48, 1.0, v48
  v_add_f32 v49, 1.0, v49
  v_add_f32 v50, 1.0, v50
  v_cvt_pk_bf16_f32 v216, v42, v43
  v_lshlrev_b32 v42, 16, v216
  v_and_b32 v43, 0xffff0000, v216
  v_cvt_pk_bf16_f32 v216, v44, v45
  v_lshlrev_b32 v44, 16, v216
  v_and_b32 v45, 0xffff0000, v216
  v_cvt_pk_bf16_f32 v216, v46, v47
  v_lshlrev_b32 v46, 16, v216
  v_and_b32 v47, 0xffff0000, v216
  v_cvt_pk_bf16_f32 v216, v48, v49
  v_lshlrev_b32 v48, 16, v216
  v_and_b32 v49, 0xffff0000, v216
  v_cvt_pk_bf16_f32 v50, v50, v50
  v_lshlrev_b32 v50, 16, v50
  v_lshlrev_b32 v7, 4, v0
  v_lshlrev_b32 v11, 2, v0
  v_mov_b32 v8, 0
  v_mov_b32 v9, 0
  v_bfe_u32 v1, v0, 3, 1
  v_lshlrev_b32 v12, 8, v1
  v_bfe_u32 v1, v0, 1, 1
  v_lshl_add_u32 v12, v1, 7, v12
  v_bfe_u32 v1, v0, 4, 2
  v_lshl_add_u32 v12, v1, 5, v12
  v_bfe_u32 v1, v0, 0, 1
  v_lshl_add_u32 v12, v1, 3, v12
  v_bfe_u32 v1, v0, 2, 1
  v_lshl_add_u32 v12, v1, 2, v12
  s_lshl_b32 s74, s64, 9
  v_add_u32 v12, s74, v12
  v_bfe_u32 v1, v0, 0, 4
  v_lshlrev_b32_e64 v13, 4, v1
  v_bfe_u32 v1, v0, 4, 2
  v_lshl_add_u32 v13, v1, 2, v13
  s_add_u32 s74, s74, 2048
  v_add_u32 v13, s74, v13
  v_bfe_u32 v1, v0, 0, 5
  v_lshlrev_b32 v14, 4, v1
  v_bfe_u32 v1, v0, 5, 1
  v_lshl_add_u32 v14, v1, 3, v14
  v_add_u32 v14, s74, v14
  v_bfe_u32 v1, v0, 5, 1
  v_lshlrev_b32 v15, 7, v1
  v_bfe_u32 v1, v0, 0, 3
  v_lshl_add_u32 v15, v1, 4, v15
  s_lshl_b32 s74, s64, 11
  s_add_u32 s74, s74, 4096
  v_add_u32 v16, s74, v7
  v_bfe_u32 v1, v0, 4, 2
  v_lshlrev_b32 v17, 9, v1
  v_bfe_u32 v1, v0, 0, 4
  v_lshl_add_u32 v17, v1, 4, v17
  v_and_b32 v61, 31, v0
  v_bfe_u32 v1, v0, 5, 1
  v_lshlrev_b32 v1, 2, v1
  v_sub_u32 v61, v61, v1
  s_lshl_b32 s79, s67, 5
  s_add_u32 s79, s79, s65
  s_lshl_b32 s81, s65, 7
  s_lshl_b32 s80, s79, 12
  s_mul_i32 s87, s79, 1152
  s_lshl_b32 s79, s79, 13
  s_lshl_b32 s74, s64, 10
  s_add_u32 s80, s80, s74
  s_add_u32 s80, s80, 23068672
  s_lshl_b32 s82, s65, 7
  s_add_u32 s82, s82, 8192
  s_mul_i32 s74, s67, 0x240000
  s_add_u32 s74, s74, 10485760
  s_mul_i32 s83, s65, 1152
  s_add_u32 s83, s83, s74
  s_mul_i32 s84, s65, 36864
  s_add_u32 s84, s84, s74
  s_mov_b32 s76, 0
  s_mov_b32 s75, 32768
WC_54:
  buffer_load_dword v1, v3, s[40:43], 0 offen offset:204 sc1
  s_waitcnt vmcnt(0)
  v_cmp_gt_u32 vcc, 160, v1
  s_cbranch_vccz WCD_55
  s_sleep 2
  s_sub_u32 s75, s75, 1
  s_cmp_lg_u32 s75, 0
  s_cbranch_scc1 WC_54
  s_mov_b32 s68, 49
  s_branch L_ABORT
WCD_55:
  s_mov_b32 s75, 32768
WC_56:
  buffer_load_dword v1, v3, s[40:43], 0 offen offset:12 sc1
  s_waitcnt vmcnt(0)
  v_cmp_gt_u32 vcc, 136, v1
  s_cbranch_vccz WCD_57
  s_sleep 2
  s_sub_u32 s75, s75, 1
  s_cmp_lg_u32 s75, 0
  s_cbranch_scc1 WC_56
  s_mov_b32 s68, 55
  s_branch L_ABORT
WCD_57:
  s_barrier
  v_cmp_le_i32 s[4:5], 0, v61
  v_cmp_le_i32 s[6:7], 1, v61
  v_cmp_le_i32 s[8:9], 2, v61
  v_cmp_le_i32 s[10:11], 3, v61
  v_cmp_le_i32 s[12:13], 8, v61
  v_cmp_le_i32 s[14:15], 9, v61
  v_cmp_le_i32 s[16:17], 10, v61
  v_cmp_le_i32 s[18:19], 11, v61
  v_cmp_le_i32 s[20:21], 16, v61
  v_cmp_le_i32 s[22:23], 17, v61
  v_cmp_le_i32 s[24:25], 18, v61
  v_cmp_le_i32 s[26:27], 19, v61
  v_cmp_le_i32 s[28:29], 24, v61
  v_cmp_le_i32 s[30:31], 25, v61
  v_cmp_le_i32 s[32:33], 26, v61
  v_cmp_le_i32 s[34:35], 27, v61
  s_mov_b32 s90, 0x10000
  v_add_u32 v61, 0x10000, v7
  s_add_u32 s88, s67, 1
  s_mov_b64 exec, 0xff
  v_cmp_gt_u32 vcc, s88, v8
  s_cbranch_vccz PWD_59
  s_mov_b32 s75, 32768
PW_58:
  buffer_load_dword v8, v7, s[36:39], s81 offen offset:0 sc1
  s_waitcnt vmcnt(0)
  v_cmp_gt_u32 vcc, s88, v8
  s_cbranch_vccz PWD_59
  s_sleep 4
  s_sub_u32 s75, s75, 1
  s_cmp_lg_u32 s75, 0
  s_cbranch_scc1 PW_58
  s_mov_b32 s68, 50
  s_branch L_ABORT
PWD_59:
  s_mov_b64 exec, -1
  s_lshl_b32 s89, s64, 11
  s_add_u32 s75, s90, s89
  s_add_u32 s89, s89, s79
  s_add_u32 m0, s75, 0
  s_add_u32 s74, s89, 50331648
  buffer_load_dwordx4 v7, s[36:39], s74 offen offset:0 sc1 lds
  buffer_load_dwordx4 v7, s[36:39], s74 offen offset:1024 sc1 lds
  s_add_u32 m0, s75, 8192
  s_add_u32 s74, s89, 33554432
  buffer_load_dwordx4 v7, s[36:39], s74 offen offset:0 sc1 lds
  buffer_load_dwordx4 v7, s[36:39], s74 offen offset:1024 sc1 lds
  s_add_u32 m0, s75, 16384
  s_add_u32 s74, s89, 67108864
  buffer_load_dwordx4 v7, s[36:39], s74 offen offset:0 sc1 lds
  buffer_load_dwordx4 v7, s[36:39], s74 offen offset:1024 sc1 lds
  s_add_u32 s79, s79, 524288
  s_xor_b32 s90, s90, 0x8000
  s_waitcnt vmcnt(0)
  s_barrier
  s_mov_b32 s91, 0
  ds_write_b32 v3, v3 offset:61440
  ds_read_b128 v[96:99], v61 offset:0
  ds_read_b128 v[64:67], v61 offset:8192
  ds_read_b128 v[100:103], v61 offset:1024
  ds_read_b128 v[68:71], v61 offset:9216
  ds_read_b128 v[104:107], v61 offset:2048
  ds_read_b128 v[72:75], v61 offset:10240
  ds_read_b128 v[108:111], v61 offset:3072
  ds_read_b128 v[76:79], v61 offset:11264
  ds_read_b128 v[112:115], v61 offset:4096
  ds_read_b128 v[80:83], v61 offset:12288
  ds_read_b128 v[116:119], v61 offset:5120
  ds_read_b128 v[84:87], v61 offset:13312
  ds_read_b128 v[120:123], v61 offset:6144
  ds_read_b128 v[88:91], v61 offset:14336
  s_waitcnt lgkmcnt(12)
  v_mfma_f32_32x32x16_bf16 v[136:151], v[96:99], v[64:67], 0
  ds_read_b128 v[124:127], v61 offset:7168
  ds_read_b128 v[92:95], v61 offset:15360
  s_waitcnt lgkmcnt(12)
  v_mfma_f32_32x32x16_bf16 v[136:151], v[100:103], v[68:71], v[136:151]
  s_lshl_b32 s74, s64, 11
  v_add_u32 v1, s74, v61
  ds_read_b128 v[128:131], v1 offset:16384
  ds_read_b128 v[132:135], v1 offset:17408
  s_waitcnt lgkmcnt(12)
  v_mfma_f32_32x32x16_bf16 v[136:151], v[104:107], v[72:75], v[136:151]
  s_waitcnt lgkmcnt(10)
  v_mfma_f32_32x32x16_bf16 v[136:151], v[108:111], v[76:79], v[136:151]
  s_waitcnt lgkmcnt(8)
  v_mfma_f32_32x32x16_bf16 v[136:151], v[112:115], v[80:83], v[136:151]
  s_waitcnt lgkmcnt(6)
  v_mfma_f32_32x32x16_bf16 v[136:151], v[116:119], v[84:87], v[136:151]
  s_waitcnt lgkmcnt(4)
  v_mfma_f32_32x32x16_bf16 v[136:151], v[120:123], v[88:91], v[136:151]
  s_waitcnt lgkmcnt(2)
  v_mfma_f32_32x32x16_bf16 v[136:151], v[124:127], v[92:95], v[136:151]
  v_xor_b32 v61, 0x8000, v61
  s_nop 9
  s_mov_b32 s74, 1035273459
  v_cvt_pk_bf16_f32 v216, v136, v137
  v_lshlrev_b32 v136, 16, v216
  v_and_b32 v137, 0xffff0000, v216
  v_mul_f32 v136, s74, v136
  v_mul_f32 v137, s74, v137
  v_cvt_pk_bf16_f32 v216, v136, v137
  v_lshlrev_b32 v136, 16, v216
  v_and_b32 v137, 0xffff0000, v216
  v_cvt_pk_bf16_f32 v216, v138, v139
  v_lshlrev_b32 v138, 16, v216
  v_and_b32 v139, 0xffff0000, v216
  v_mul_f32 v138, s74, v138
  v_mul_f32 v139, s74, v139
  v_cvt_pk_bf16_f32 v216, v138, v139
  v_lshlrev_b32 v138, 16, v216
  v_and_b32 v139, 0xffff0000, v216
  v_cvt_pk_bf16_f32 v216, v140, v141
  v_lshlrev_b32 v140, 16, v216
  v_and_b32 v141, 0xffff0000, v216
  v_mul_f32 v140, s74, v140
  v_mul_f32 v141, s74, v141
  v_cvt_pk_bf16_f32 v216, v140, v141
  v_lshlrev_b32 v140, 16, v216
  v_and_b32 v141, 0xffff0000, v216
  v_cvt_pk_bf16_f32 v216, v142, v143
  v_lshlrev_b32 v142, 16, v216
  v_and_b32 v143, 0xffff0000, v216
  v_mul_f32 v142, s74, v142
  v_mul_f32 v143, s74, v143
  v_cvt_pk_bf16_f32 v216, v142, v143
  v_lshlrev_b32 v142, 16, v216
  v_and_b32 v143, 0xffff0000, v216
  v_cvt_pk_bf16_f32 v216, v144, v145
  v_lshlrev_b32 v144, 16, v216
  v_and_b32 v145, 0xffff0000, v216
  v_mul_f32 v144, s74, v144
  v_mul_f32 v145, s74, v145
  v_cvt_pk_bf16_f32 v216, v144, v145
  v_lshlrev_b32 v144, 16, v216
  v_and_b32 v145, 0xffff0000, v216
  v_cvt_pk_bf16_f32 v216, v146, v147
  v_lshlrev_b32 v146, 16, v216
  v_and_b32 v147, 0xffff0000, v216
  v_mul_f32 v146, s74, v146
  v_mul_f32 v147, s74, v147
  v_cvt_pk_bf16_f32 v216, v146, v147
  v_lshlrev_b32 v146, 16, v216
  v_and_b32 v147, 0xffff0000, v216
  v_cvt_pk_bf16_f32 v216, v148, v149
  v_lshlrev_b32 v148, 16, v216
  v_and_b32 v149, 0xffff0000, v216
  v_mul_f32 v148, s74, v148
  v_mul_f32 v149, s74, v149
  v_cvt_pk_bf16_f32 v216, v148, v149
  v_lshlrev_b32 v148, 16, v216
  v_and_b32 v149, 0xffff0000, v216
  v_cvt_pk_bf16_f32 v216, v150, v151
  v_lshlrev_b32 v150, 16, v216
  v_and_b32 v151, 0xffff0000, v216
  v_mul_f32 v150, s74, v150
  v_mul_f32 v151, s74, v151
  v_cvt_pk_bf16_f32 v216, v150, v151
  v_lshlrev_b32_e64 v150, 16, v216
  v_and_b32 v151, 0xffff0000, v216
  v_mov_b32 v218, 0xce6e6b28
  v_cndmask_b32 v136, v218, v136, s[4:5]
  v_cndmask_b32 v137, v218, v137, s[6:7]
  v_cndmask_b32 v138, v218, v138, s[8:9]
  v_cndmask_b32 v139, v218, v139, s[10:11]
  v_cndmask_b32 v140, v218, v140, s[12:13]
  v_cndmask_b32 v141, v218, v141, s[14:15]
  v_cndmask_b32 v142, v218, v142, s[16:17]
  v_cndmask_b32 v143, v218, v143, s[18:19]
  v_cndmask_b32 v144, v218, v144, s[20:21]
  v_cndmask_b32 v145, v218, v145, s[22:23]
  v_cndmask_b32 v146, v218, v146, s[24:25]
  v_cndmask_b32 v147, v218, v147, s[26:27]
  v_cndmask_b32 v148, v218, v148, s[28:29]
  v_cndmask_b32 v149, v218, v149, s[30:31]
  v_cndmask_b32 v150, v218, v150, s[32:33]
  v_cndmask_b32 v151, v218, v151, s[34:35]
  v_max3_f32 v220, v136, v137, v138
  v_max3_f32 v220, v220, v139, v140
  v_max3_f32 v220, v220, v141, v142
  v_max3_f32 v220, v220, v143, v144
  v_max3_f32 v220, v220, v145, v146
  v_max3_f32 v220, v220, v147, v148
  v_max3_f32 v220, v220, v149, v150
  v_max_f32 v220, v220, v151
L_A_LOOP:
  s_lshl_b32 s88, s76, 1
  s_add_u32 s88, s88, s67
  s_add_u32 s88, s88, 1
  s_mov_b32 s75, 32768
  s_waitcnt vmcnt(2)
  s_cmp_lg_u32 s91, 0
  s_cbranch_scc1 L_A_EXC
L_A_EXP:
  s_waitcnt vmcnt(0)
L_A_EXC:
  s_cmp_lt_u32 s76, 24
  s_cbranch_scc1 L_A_EXF
  v_cmp_eq_u32 vcc, -1, v236
  s_cbranch_vccz L_A_EXOK
L_A_EXF:
  s_mov_b64 exec, 3
  v_cmp_le_u32 vcc, s88, v9
  s_mov_b64 exec, -1
  s_cbranch_vccz L_A_EXN
  s_cbranch_scc1 L_A_EXOK
  s_mov_b64 exec, 3
  buffer_load_dword v9, v11, s[36:39], s82 offen sc1
  s_mov_b64 exec, -1
  s_add_u32 s89, s80, 0
  buffer_load_dwordx4 v[236:239], v7, s[36:39], s89 offen sc1
  s_waitcnt vmcnt(0)
  s_branch L_A_EXOK
L_A_EXN:
  s_cmp_eq_u32 s91, 0
  s_cbranch_scc1 FH_60
  s_waitcnt vmcnt(0)
  v_mov_b32 v1, s91
  s_mov_b64 exec, 1
  buffer_store_dword v1, v3, s[36:39], s86 offen sc1
  s_mov_b64 exec, -1
  s_mov_b32 s91, 0
FH_60:
  s_sleep 4
  s_mov_b64 exec, 3
  buffer_load_dword v9, v11, s[36:39], s82 offen sc1
  s_mov_b64 exec, -1
  s_add_u32 s89, s80, 0
  buffer_load_dwordx4 v[236:239], v7, s[36:39], s89 offen sc1
  s_sub_u32 s75, s75, 1
  s_cmp_lg_u32 s75, 0
  s_cbranch_scc1 L_A_EXP
  s_mov_b32 s68, 0x33
  s_branch L_ABORT
L_A_EXOK:
  ds_write2_b32 v12, v236, v237 offset0:0 offset1:4
  ds_write2_b32 v13, v238, v239 offset0:0 offset1:64
  s_waitcnt lgkmcnt(0)
  s_barrier
  ds_read_b128 v[184:187], v15 offset:0
  ds_read_b128 v[188:191], v15 offset:256
  ds_read_b128 v[192:195], v15 offset:512
  ds_read_b128 v[196:199], v15 offset:768
  ds_read_b128 v[200:203], v15 offset:1024
  ds_read_b128 v[204:207], v15 offset:1280
  ds_read_b128 v[208:211], v15 offset:1536
  ds_read_b128 v[212:215], v15 offset:1792
  ds_read_b64 v[232:233], v14
  s_waitcnt lgkmcnt(8)
  v_mfma_f32_32x32x16_bf16 v[152:167], v[184:187], v[64:67], 0
  s_waitcnt lgkmcnt(7)
  v_mfma_f32_32x32x16_bf16 v[152:167], v[188:191], v[68:71], v[152:167]
  s_waitcnt lgkmcnt(6)
  v_mfma_f32_32x32x16_bf16 v[152:167], v[192:195], v[72:75], v[152:167]
  s_waitcnt lgkmcnt(5)
  v_mfma_f32_32x32x16_bf16 v[152:167], v[196:199], v[76:79], v[152:167]
  s_waitcnt lgkmcnt(4)
  v_mfma_f32_32x32x16_bf16 v[152:167], v[200:203], v[80:83], v[152:167]
  s_waitcnt lgkmcnt(3)
  v_mfma_f32_32x32x16_bf16 v[152:167], v[204:207], v[84:87], v[152:167]
  s_waitcnt lgkmcnt(2)
  v_mfma_f32_32x32x16_bf16 v[152:167], v[208:211], v[88:91], v[152:167]
  s_waitcnt lgkmcnt(1)
  v_mfma_f32_32x32x16_bf16 v[152:167], v[212:215], v[92:95], v[152:167]
  s_cmp_eq_u32 s76, 31
  s_cbranch_scc1 L_A_NODMA
  s_add_u32 s88, s88, 2
  s_mov_b64 exec, 0xff
  v_cmp_gt_u32 vcc, s88, v8
  s_cbranch_vccz PWD_62
  s_mov_b32 s75, 32768
PW_61:
  buffer_load_dword v8, v7, s[36:39], s81 offen offset:0 sc1
  s_waitcnt vmcnt(0)
  v_cmp_gt_u32 vcc, s88, v8
  s_cbranch_vccz PWD_62
  s_sleep 4
  s_sub_u32 s75, s75, 1
  s_cmp_lg_u32 s75, 0
  s_cbranch_scc1 PW_61
  s_mov_b32 s68, 50
  s_branch L_ABORT
PWD_62:
  s_mov_b64 exec, -1
  s_lshl_b32 s89, s64, 11
  s_add_u32 s75, s90, s89
  s_add_u32 s89, s89, s79
  s_add_u32 m0, s75, 0
  s_add_u32 s74, s89, 50331648
  buffer_load_dwordx4 v7, s[36:39], s74 offen offset:0 sc1 lds
  buffer_load_dwordx4 v7, s[36:39], s74 offen offset:1024 sc1 lds
  s_add_u32 m0, s75, 8192
  s_add_u32 s74, s89, 33554432
  buffer_load_dwordx4 v7, s[36:39], s74 offen offset:0 sc1 lds
  buffer_load_dwordx4 v7, s[36:39], s74 offen offset:1024 sc1 lds
  s_add_u32 m0, s75, 16384
  s_add_u32 s74, s89, 67108864
  buffer_load_dwordx4 v7, s[36:39], s74 offen offset:0 sc1 lds
  buffer_load_dwordx4 v7, s[36:39], s74 offen offset:1024 sc1 lds
  s_add_u32 s79, s79, 524288
  s_xor_b32 s90, s90, 0x8000
L_A_NODMA:
  buffer_load_dwordx4 v[224:227], v26, s[44:47], s87 offen offset:0
  buffer_load_ushort v228, v27, s[44:47], s87 offen offset:0
  s_mov_b32 s74, 1035273459
  s_nop 6
  v_cvt_pk_bf16_f32 v216, v152, v153
  v_lshlrev_b32 v152, 16, v216
  v_and_b32 v153, 0xffff0000, v216
  v_mul_f32 v152, s74, v152
  v_mul_f32 v153, s74, v153
  v_cvt_pk_bf16_f32 v216, v152, v153
  v_lshlrev_b32 v152, 16, v216
  v_and_b32 v153, 0xffff0000, v216
  v_cvt_pk_bf16_f32 v216, v154, v155
  v_lshlrev_b32 v154, 16, v216
  v_and_b32 v155, 0xffff0000, v216
  v_mul_f32 v154, s74, v154
  v_mul_f32 v155, s74, v155
  v_cvt_pk_bf16_f32 v216, v154, v155
  v_lshlrev_b32 v154, 16, v216
  v_and_b32 v155, 0xffff0000, v216
  v_max3_f32 v220, v220, v152, v153
  v_max3_f32 v220, v220, v154, v155
  v_mov_b32 v221, v220
  s_mov_b32 s74, 1069066811
  s_nop 0
  v_permlane32_swap_b32 v220, v221
  v_max_f32 v220, v220, v221
  v_mul_f32_e64 v220, s74, v220
  v_fma_f32 v136, v136, s74, -v220
  v_fma_f32 v137, v137, s74, -v220
  v_fma_f32 v138, v138, s74, -v220
  v_fma_f32 v139, v139, s74, -v220
  v_fma_f32 v140, v140, s74, -v220
  v_fma_f32 v141, v141, s74, -v220
  v_fma_f32 v142, v142, s74, -v220
  v_fma_f32 v143, v143, s74, -v220
  v_fma_f32 v144, v144, s74, -v220
  v_fma_f32 v145, v145, s74, -v220
  v_fma_f32 v146, v146, s74, -v220
  v_fma_f32 v147, v147, s74, -v220
  v_fma_f32 v148, v148, s74, -v220
  v_fma_f32 v149, v149, s74, -v220
  v_fma_f32 v150, v150, s74, -v220
  v_fma_f32 v151, v151, s74, -v220
  v_fma_f32 v152, v152, s74, -v220
  v_fma_f32 v153, v153, s74, -v220
  v_fma_f32 v154, v154, s74, -v220
  v_fma_f32 v155, v155, s74, -v220
  v_exp_f32 v136, v136
  v_exp_f32 v137, v137
  v_exp_f32 v138, v138
  v_exp_f32 v139, v139
  v_exp_f32 v140, v140
  v_exp_f32 v141, v141
  v_exp_f32 v142, v142
  v_exp_f32 v143, v143
  v_exp_f32 v144, v144
  v_exp_f32 v145, v145
  v_exp_f32 v146, v146
  v_exp_f32 v147, v147
  v_exp_f32 v148, v148
  v_exp_f32 v149, v149
  v_exp_f32 v150, v150
  v_exp_f32 v151, v151
  v_exp_f32 v152, v152
  v_exp_f32 v153, v153
  v_exp_f32 v154, v154
  v_exp_f32 v155, v155
  v_cvt_pk_bf16_f32 v184, v136, v137
  v_cvt_pk_bf16_f32 v185, v138, v139
  v_cvt_pk_bf16_f32 v186, v140, v141
  v_cvt_pk_bf16_f32 v187, v142, v143
  v_cvt_pk_bf16_f32 v188, v144, v145
  v_cvt_pk_bf16_f32 v189, v146, v147
  v_cvt_pk_bf16_f32 v190, v148, v149
  v_cvt_pk_bf16_f32 v191, v150, v151
  v_cvt_pk_bf16_f32 v192, v152, v153
  v_cvt_pk_bf16_f32 v193, v154, v155
  s_waitcnt lgkmcnt(0)
  v_add_f32 v222, v136, v137
  v_mfma_f32_32x32x16_bf16 v[168:183], v[128:131], v[184:187], 0
  v_add_f32 v222, v222, v138
  v_add_f32 v222, v222, v139
  v_mfma_f32_32x32x16_bf16 v[168:183], v[132:135], v[188:191], v[168:183]
  v_add_f32 v222, v222, v140
  v_add_f32 v222, v222, v141
  v_add_f32 v222, v222, v142
  v_add_f32 v222, v222, v143
  v_add_f32 v222, v222, v144
  v_add_f32 v222, v222, v145
  v_add_f32 v222, v222, v146
  v_add_f32 v222, v222, v147
  v_add_f32 v222, v222, v148
  v_add_f32 v222, v222, v149
  v_mfma_f32_32x32x8_bf16 v[168:183], v[232:233], v[192:193], v[168:183]
  v_add_f32 v222, v222, v150
  v_add_f32 v222, v222, v151
  v_add_f32 v222, v222, v152
  v_add_f32 v222, v222, v153
  v_add_f32 v222, v222, v154
  v_add_f32 v222, v222, v155
  v_mov_b32 v223, v222
  s_nop 1
  v_permlane32_swap_b32 v222, v223
  v_add_f32 v222, v222, v223
  v_rcp_f32 v222, v222
  s_nop 0
  v_pk_mul_f32 v[168:169], v[168:169], v[222:223] op_sel_hi:[1,0]
  v_pk_mul_f32 v[170:171], v[170:171], v[222:223] op_sel_hi:[1,0]
  v_pk_mul_f32 v[172:173], v[172:173], v[222:223] op_sel_hi:[1,0]
  v_pk_mul_f32 v[174:175], v[174:175], v[222:223] op_sel_hi:[1,0]
  v_pk_mul_f32 v[176:177], v[176:177], v[222:223] op_sel_hi:[1,0]
  v_pk_mul_f32 v[178:179], v[178:179], v[222:223] op_sel_hi:[1,0]
  v_pk_mul_f32 v[180:181], v[180:181], v[222:223] op_sel_hi:[1,0]
  v_pk_mul_f32 v[182:183], v[182:183], v[222:223] op_sel_hi:[1,0]
  v_cvt_pk_bf16_f32 v136, v168, v169
  v_cvt_pk_bf16_f32 v137, v170, v171
  v_cvt_pk_bf16_f32 v138, v172, v173
  v_cvt_pk_bf16_f32 v139, v174, v175
  v_cvt_pk_bf16_f32 v140, v176, v177
  v_cvt_pk_bf16_f32 v141, v178, v179
  v_cvt_pk_bf16_f32 v142, v180, v181
  v_cvt_pk_bf16_f32 v143, v182, v183
  ds_write_b128 v16, v[136:139]
  ds_write_b128 v16, v[140:143] offset:1024
  s_cmp_lg_u32 s76, 31
  s_cbranch_scc1 L_A_F8
  s_waitcnt vmcnt(2)
L_A_F8:
  s_cmp_eq_u32 s91, 0
  s_cbranch_scc1 FH_63
  s_waitcnt vmcnt(8)
  v_mov_b32 v1, s91
  s_mov_b64 exec, 1
  buffer_store_dword v1, v3, s[36:39], s86 offen sc1
  s_mov_b64 exec, -1
  s_mov_b32 s91, 0
FH_63:
  s_waitcnt lgkmcnt(0)
  s_barrier
  ds_read_b128 v[184:187], v17 offset:4096
  ds_read_b128 v[188:191], v17 offset:6144
  ds_read_b128 v[192:195], v17 offset:8192
  ds_read_b128 v[196:199], v17 offset:10240
  ds_read_b128 v[200:203], v17 offset:4352
  ds_read_b128 v[204:207], v17 offset:6400
  ds_read_b128 v[208:211], v17 offset:8448
  ds_read_b128 v[212:215], v17 offset:10496
  s_bfe_u32 s85, s76, 0x10001
  s_waitcnt lgkmcnt(7)
  v_mfma_f32_16x16x32_bf16 v[64:67], v[184:187], a[0:3], 0
  v_mfma_f32_16x16x32_bf16 v[68:71], v[184:187], a[16:19], 0
  v_mfma_f32_16x16x32_bf16 v[72:75], v[184:187], a[32:35], 0
  v_mfma_f32_16x16x32_bf16 v[76:79], v[184:187], a[48:51], 0
  v_mfma_f32_16x16x32_bf16 v[80:83], v[184:187], a[64:67], 0
  v_mfma_f32_16x16x32_bf16 v[84:87], v[184:187], a[80:83], 0
  v_mfma_f32_16x16x32_bf16 v[88:91], v[184:187], a[96:99], 0
  v_mfma_f32_16x16x32_bf16 v[92:95], v[184:187], a[112:115], 0
  v_mfma_f32_16x16x32_bf16 v[96:99], v[184:187], a[128:131], 0
  s_waitcnt lgkmcnt(6)
  v_mfma_f32_16x16x32_bf16 v[64:67], v[188:191], a[4:7], v[64:67]
  v_mfma_f32_16x16x32_bf16 v[68:71], v[188:191], a[20:23], v[68:71]
  v_mfma_f32_16x16x32_bf16 v[72:75], v[188:191], a[36:39], v[72:75]
  v_mfma_f32_16x16x32_bf16 v[76:79], v[188:191], a[52:55], v[76:79]
  v_mfma_f32_16x16x32_bf16 v[80:83], v[188:191], a[68:71], v[80:83]
  v_mfma_f32_16x16x32_bf16 v[84:87], v[188:191], a[84:87], v[84:87]
  v_mfma_f32_16x16x32_bf16 v[88:91], v[188:191], a[100:103], v[88:91]
  v_mfma_f32_16x16x32_bf16 v[92:95], v[188:191], a[116:119], v[92:95]
  v_mfma_f32_16x16x32_bf16 v[96:99], v[188:191], a[132:135], v[96:99]
  s_waitcnt lgkmcnt(5)
  v_mfma_f32_16x16x32_bf16 v[64:67], v[192:195], a[8:11], v[64:67]
  v_mfma_f32_16x16x32_bf16 v[68:71], v[192:195], a[24:27], v[68:71]
  v_mfma_f32_16x16x32_bf16 v[72:75], v[192:195], a[40:43], v[72:75]
  v_mfma_f32_16x16x32_bf16 v[76:79], v[192:195], a[56:59], v[76:79]
  v_mfma_f32_16x16x32_bf16 v[80:83], v[192:195], a[72:75], v[80:83]
  v_mfma_f32_16x16x32_bf16 v[84:87], v[192:195], a[88:91], v[84:87]
  v_mfma_f32_16x16x32_bf16 v[88:91], v[192:195], a[104:107], v[88:91]
  v_mfma_f32_16x16x32_bf16 v[92:95], v[192:195], a[120:123], v[92:95]
  v_mfma_f32_16x16x32_bf16 v[96:99], v[192:195], a[136:139], v[96:99]
  s_waitcnt lgkmcnt(4)
  v_mfma_f32_16x16x32_bf16 v[64:67], v[196:199], a[12:15], v[64:67]
  v_mfma_f32_16x16x32_bf16 v[68:71], v[196:199], a[28:31], v[68:71]
  v_mfma_f32_16x16x32_bf16 v[72:75], v[196:199], a[44:47], v[72:75]
  v_mfma_f32_16x16x32_bf16 v[76:79], v[196:199], a[60:63], v[76:79]
  v_mfma_f32_16x16x32_bf16 v[80:83], v[196:199], a[76:79], v[80:83]
  v_mfma_f32_16x16x32_bf16 v[84:87], v[196:199], a[92:95], v[84:87]
  v_mfma_f32_16x16x32_bf16 v[88:91], v[196:199], a[108:111], v[88:91]
  v_mfma_f32_16x16x32_bf16 v[92:95], v[196:199], a[124:127], v[92:95]
  v_mfma_f32_16x16x32_bf16 v[96:99], v[196:199], a[140:143], v[96:99]
  s_waitcnt lgkmcnt(3)
  v_mfma_f32_16x16x32_bf16 v[100:103], v[200:203], a[0:3], 0
  v_mfma_f32_16x16x32_bf16 v[104:107], v[200:203], a[16:19], 0
  v_mfma_f32_16x16x32_bf16 v[108:111], v[200:203], a[32:35], 0
  v_mfma_f32_16x16x32_bf16 v[112:115], v[200:203], a[48:51], 0
  v_cvt_pk_bf16_f32 v136, v64, v68
  v_mfma_f32_16x16x32_bf16 v[116:119], v[200:203], a[64:67], 0
  v_cvt_pk_bf16_f32 v137, v72, v76
  v_mfma_f32_16x16x32_bf16 v[120:123], v[200:203], a[80:83], 0
  v_cvt_pk_bf16_f32 v138, v80, v84
  v_cvt_pk_bf16_f32 v139, v88, v92
  v_mfma_f32_16x16x32_bf16 v[124:127], v[200:203], a[96:99], 0
  v_cvt_pk_bf16_f32 v140, v96, v96
  v_mfma_f32_16x16x32_bf16 v[128:131], v[200:203], a[112:115], 0
  v_and_or_b32 v136, v136, -2, s85
  v_mfma_f32_16x16x32_bf16 v[132:135], v[200:203], a[128:131], 0
  v_and_or_b32 v140, v140, -2, s85
  s_add_u32 s74, s83, 0
  s_waitcnt lgkmcnt(2)
  v_mfma_f32_16x16x32_bf16 v[100:103], v[204:207], a[4:7], v[100:103]
  buffer_store_dwordx4 v[136:139], v18, s[36:39], s74 offen
  v_mfma_f32_16x16x32_bf16 v[104:107], v[204:207], a[20:23], v[104:107]
  buffer_store_short v140, v19, s[36:39], s74 offen
  v_mfma_f32_16x16x32_bf16 v[108:111], v[204:207], a[36:39], v[108:111]
  v_cvt_pk_bf16_f32 v144, v65, v69
  v_cvt_pk_bf16_f32 v145, v73, v77
  v_mfma_f32_16x16x32_bf16 v[112:115], v[204:207], a[52:55], v[112:115]
  v_cvt_pk_bf16_f32 v146, v81, v85
  v_mfma_f32_16x16x32_bf16 v[116:119], v[204:207], a[68:71], v[116:119]
  v_cvt_pk_bf16_f32 v147, v89, v93
  v_mfma_f32_16x16x32_bf16 v[120:123], v[204:207], a[84:87], v[120:123]
  v_cvt_pk_bf16_f32 v148, v97, v97
  v_and_or_b32 v144, v144, -2, s85
  v_mfma_f32_16x16x32_bf16 v[124:127], v[204:207], a[100:103], v[124:127]
  v_and_or_b32 v148, v148, -2, s85
  v_mfma_f32_16x16x32_bf16 v[128:131], v[204:207], a[116:119], v[128:131]
  s_add_u32 s74, s83, 36864
  v_mfma_f32_16x16x32_bf16 v[132:135], v[204:207], a[132:135], v[132:135]
  buffer_store_dwordx4 v[144:147], v18, s[36:39], s74 offen
  buffer_store_short v148, v19, s[36:39], s74 offen
  s_waitcnt lgkmcnt(1)
  v_mfma_f32_16x16x32_bf16 v[100:103], v[208:211], a[8:11], v[100:103]
  v_cvt_pk_bf16_f32 v136, v66, v70
  v_mfma_f32_16x16x32_bf16 v[104:107], v[208:211], a[24:27], v[104:107]
  v_cvt_pk_bf16_f32 v137, v74, v78
  v_mfma_f32_16x16x32_bf16 v[108:111], v[208:211], a[40:43], v[108:111]
  v_cvt_pk_bf16_f32 v138, v82, v86
  v_cvt_pk_bf16_f32 v139, v90, v94
  v_mfma_f32_16x16x32_bf16 v[112:115], v[208:211], a[56:59], v[112:115]
  v_cvt_pk_bf16_f32 v140, v98, v98
  v_mfma_f32_16x16x32_bf16 v[116:119], v[208:211], a[72:75], v[116:119]
  v_and_or_b32 v136, v136, -2, s85
  v_mfma_f32_16x16x32_bf16 v[120:123], v[208:211], a[88:91], v[120:123]
  v_and_or_b32 v140, v140, -2, s85
  s_add_u32 s74, s83, 73728
  v_mfma_f32_16x16x32_bf16 v[124:127], v[208:211], a[104:107], v[124:127]
  buffer_store_dwordx4 v[136:139], v18, s[36:39], s74 offen
  v_mfma_f32_16x16x32_bf16 v[128:131], v[208:211], a[120:123], v[128:131]
  buffer_store_short v140, v19, s[36:39], s74 offen
  v_mfma_f32_16x16x32_bf16 v[132:135], v[208:211], a[136:139], v[132:135]
  v_cvt_pk_bf16_f32 v144, v67, v71
  v_cvt_pk_bf16_f32 v145, v75, v79
  s_waitcnt lgkmcnt(0)
  v_mfma_f32_16x16x32_bf16 v[100:103], v[212:215], a[12:15], v[100:103]
  v_cvt_pk_bf16_f32 v146, v83, v87
  v_mfma_f32_16x16x32_bf16 v[104:107], v[212:215], a[28:31], v[104:107]
  v_cvt_pk_bf16_f32 v147, v91, v95
  v_mfma_f32_16x16x32_bf16 v[108:111], v[212:215], a[44:47], v[108:111]
  v_cvt_pk_bf16_f32 v148, v99, v99
  v_and_or_b32 v144, v144, -2, s85
  v_mfma_f32_16x16x32_bf16 v[112:115], v[212:215], a[60:63], v[112:115]
  v_and_or_b32 v148, v148, -2, s85
  v_mfma_f32_16x16x32_bf16 v[116:119], v[212:215], a[76:79], v[116:119]
  s_add_u32 s74, s83, 110592
  v_mfma_f32_16x16x32_bf16 v[120:123], v[212:215], a[92:95], v[120:123]
  buffer_store_dwordx4 v[144:147], v18, s[36:39], s74 offen
  buffer_store_short v148, v19, s[36:39], s74 offen
  v_mfma_f32_16x16x32_bf16 v[124:127], v[212:215], a[108:111], v[124:127]
  v_mfma_f32_16x16x32_bf16 v[128:131], v[212:215], a[124:127], v[128:131]
  v_mfma_f32_16x16x32_bf16 v[132:135], v[212:215], a[140:143], v[132:135]
  s_nop 3
  v_cvt_pk_bf16_f32 v136, v100, v104
  v_cvt_pk_bf16_f32 v137, v108, v112
  v_cvt_pk_bf16_f32 v138, v116, v120
  v_cvt_pk_bf16_f32 v139, v124, v128
  v_cvt_pk_bf16_f32 v140, v132, v132
  v_and_or_b32 v136, v136, -2, s85
  v_and_or_b32 v140, v140, -2, s85
  s_add_u32 s74, s83, 589824
  buffer_store_dwordx4 v[136:139], v18, s[36:39], s74 offen
  buffer_store_short v140, v19, s[36:39], s74 offen
  v_cvt_pk_bf16_f32 v144, v101, v105
  v_cvt_pk_bf16_f32 v145, v109, v113
  v_cvt_pk_bf16_f32 v146, v117, v121
  v_cvt_pk_bf16_f32 v147, v125, v129
  v_cvt_pk_bf16_f32 v148, v133, v133
  v_and_or_b32 v144, v144, -2, s85
  v_and_or_b32 v148, v148, -2, s85
  s_add_u32 s74, s83, 626688
  buffer_store_dwordx4 v[144:147], v18, s[36:39], s74 offen
  buffer_store_short v148, v19, s[36:39], s74 offen
  v_cvt_pk_bf16_f32 v136, v102, v106
  v_cvt_pk_bf16_f32 v137, v110, v114
  v_cvt_pk_bf16_f32 v138, v118, v122
  v_cvt_pk_bf16_f32 v139, v126, v130
  v_cvt_pk_bf16_f32 v140, v134, v134
  v_and_or_b32 v136, v136, -2, s85
  v_and_or_b32 v140, v140, -2, s85
  s_add_u32 s74, s83, 663552
  buffer_store_dwordx4 v[136:139], v18, s[36:39], s74 offen
  buffer_store_short v140, v19, s[36:39], s74 offen
  v_cvt_pk_bf16_f32 v144, v103, v107
  v_cvt_pk_bf16_f32 v145, v111, v115
  v_cvt_pk_bf16_f32 v146, v119, v123
  v_cvt_pk_bf16_f32 v147, v127, v131
  v_cvt_pk_bf16_f32 v148, v135, v135
  v_and_or_b32 v144, v144, -2, s85
  v_and_or_b32 v148, v148, -2, s85
  s_add_u32 s74, s83, 700416
  buffer_store_dwordx4 v[144:147], v18, s[36:39], s74 offen
  buffer_store_short v148, v19, s[36:39], s74 offen
  s_waitcnt vmcnt(16)
  s_cmp_eq_u32 s91, 0
  s_cbranch_scc1 FH_64
  s_waitcnt vmcnt(16)
  v_mov_b32_e64 v1, s91
  s_mov_b64 exec, 1
  buffer_store_dword v1, v3, s[36:39], s86 offen sc1
  s_mov_b64 exec, -1
  s_mov_b32 s91, 0
FH_64:
  s_cmp_eq_u32 s76, 31
  s_cbranch_scc1 L_A_NOPRE
  s_barrier
  ds_read_b128 v[96:99], v61 offset:0
  ds_read_b128 v[64:67], v61 offset:8192
  ds_read_b128 v[100:103], v61 offset:1024
  ds_read_b128 v[68:71], v61 offset:9216
  ds_read_b128 v[104:107], v61 offset:2048
  ds_read_b128 v[72:75], v61 offset:10240
  ds_read_b128 v[108:111], v61 offset:3072
  ds_read_b128 v[76:79], v61 offset:11264
  ds_read_b128 v[112:115], v61 offset:4096
  ds_read_b128 v[80:83], v61 offset:12288
  ds_read_b128 v[116:119], v61 offset:5120
  ds_read_b128 v[84:87], v61 offset:13312
  ds_read_b128 v[120:123], v61 offset:6144
  ds_read_b128 v[88:91], v61 offset:14336
  s_waitcnt lgkmcnt(12)
  v_mfma_f32_32x32x16_bf16 v[136:151], v[96:99], v[64:67], 0
  ds_read_b128 v[124:127], v61 offset:7168
  ds_read_b128 v[92:95], v61 offset:15360
  s_waitcnt lgkmcnt(12)
  v_mfma_f32_32x32x16_bf16 v[136:151], v[100:103], v[68:71], v[136:151]
  s_lshl_b32 s74, s64, 11
  v_add_u32 v1, s74, v61
  ds_read_b128 v[128:131], v1 offset:16384
  ds_read_b128 v[132:135], v1 offset:17408
  s_waitcnt lgkmcnt(12)
  v_mfma_f32_32x32x16_bf16 v[136:151], v[104:107], v[72:75], v[136:151]
  s_waitcnt lgkmcnt(10)
  v_mfma_f32_32x32x16_bf16 v[136:151], v[108:111], v[76:79], v[136:151]
  s_waitcnt lgkmcnt(8)
  v_mfma_f32_32x32x16_bf16 v[136:151], v[112:115], v[80:83], v[136:151]
  s_waitcnt lgkmcnt(6)
  v_mfma_f32_32x32x16_bf16 v[136:151], v[116:119], v[84:87], v[136:151]
  s_waitcnt lgkmcnt(4)
  v_mfma_f32_32x32x16_bf16 v[136:151], v[120:123], v[88:91], v[136:151]
  s_waitcnt lgkmcnt(2)
  v_mfma_f32_32x32x16_bf16 v[136:151], v[124:127], v[92:95], v[136:151]
  v_xor_b32 v61, 0x8000, v61
  s_nop 9
  s_mov_b32 s74, 1035273459
  v_cvt_pk_bf16_f32 v216, v136, v137
  v_lshlrev_b32 v136, 16, v216
  v_and_b32 v137, 0xffff0000, v216
  v_mul_f32 v136, s74, v136
  v_mul_f32 v137, s74, v137
  v_cvt_pk_bf16_f32 v216, v136, v137
  v_lshlrev_b32 v136, 16, v216
  v_and_b32 v137, 0xffff0000, v216
  v_cvt_pk_bf16_f32 v216, v138, v139
  v_lshlrev_b32 v138, 16, v216
  v_and_b32 v139, 0xffff0000, v216
  v_mul_f32 v138, s74, v138
  v_mul_f32 v139, s74, v139
  v_cvt_pk_bf16_f32 v216, v138, v139
  v_lshlrev_b32 v138, 16, v216
  v_and_b32 v139, 0xffff0000, v216
  v_cvt_pk_bf16_f32 v216, v140, v141
  v_lshlrev_b32 v140, 16, v216
  v_and_b32 v141, 0xffff0000, v216
  v_mul_f32 v140, s74, v140
  v_mul_f32 v141, s74, v141
  v_cvt_pk_bf16_f32 v216, v140, v141
  v_lshlrev_b32 v140, 16, v216
  v_and_b32 v141, 0xffff0000, v216
  v_cvt_pk_bf16_f32 v216, v142, v143
  v_lshlrev_b32 v142, 16, v216
  v_and_b32 v143, 0xffff0000, v216
  v_mul_f32 v142, s74, v142
  v_mul_f32 v143, s74, v143
  v_cvt_pk_bf16_f32 v216, v142, v143
  v_lshlrev_b32 v142, 16, v216
  v_and_b32 v143, 0xffff0000, v216
  v_cvt_pk_bf16_f32 v216, v144, v145
  v_lshlrev_b32 v144, 16, v216
  v_and_b32 v145, 0xffff0000, v216
  v_mul_f32 v144, s74, v144
  v_mul_f32 v145, s74, v145
  v_cvt_pk_bf16_f32 v216, v144, v145
  v_lshlrev_b32 v144, 16, v216
  v_and_b32 v145, 0xffff0000, v216
  v_cvt_pk_bf16_f32 v216, v146, v147
  v_lshlrev_b32 v146, 16, v216
  v_and_b32 v147, 0xffff0000, v216
  v_mul_f32 v146, s74, v146
  v_mul_f32 v147, s74, v147
  v_cvt_pk_bf16_f32 v216, v146, v147
  v_lshlrev_b32 v146, 16, v216
  v_and_b32 v147, 0xffff0000, v216
  v_cvt_pk_bf16_f32 v216, v148, v149
  v_lshlrev_b32 v148, 16, v216
  v_and_b32 v149, 0xffff0000, v216
  v_mul_f32 v148, s74, v148
  v_mul_f32 v149, s74, v149
  v_cvt_pk_bf16_f32 v216, v148, v149
  v_lshlrev_b32 v148, 16, v216
  v_and_b32 v149, 0xffff0000, v216
  v_cvt_pk_bf16_f32 v216, v150, v151
  v_lshlrev_b32 v150, 16, v216
  v_and_b32 v151, 0xffff0000, v216
  v_mul_f32 v150, s74, v150
  v_mul_f32 v151, s74, v151
  v_cvt_pk_bf16_f32 v216, v150, v151
  v_lshlrev_b32_e64 v150, 16, v216
  v_and_b32 v151, 0xffff0000, v216
L_A_NOPRE:
  s_add_u32 s88, s76, 1
  s_add_u32 s74, s84, 0
  buffer_load_dwordx4 v[168:171], v20, s[36:39], s74 offen sc1
  s_add_u32 s74, s84, 4608
  buffer_load_dwordx4 v[172:175], v20, s[36:39], s74 offen sc1
  s_add_u32 s74, s84, 9216
  buffer_load_dwordx4 v[176:179], v20, s[36:39], s74 offen sc1
  s_add_u32 s74, s84, 13824
  buffer_load_dwordx4 v[180:183], v20, s[36:39], s74 offen sc1
  s_add_u32 s74, s84, 18432
  buffer_load_dwordx4 v[184:187], v20, s[36:39], s74 offen sc1
  s_add_u32 s74, s84, 23040
  buffer_load_dwordx4 v[188:191], v20, s[36:39], s74 offen sc1
  s_add_u32 s74, s84, 27648
  buffer_load_dwordx4 v[192:195], v20, s[36:39], s74 offen sc1
  s_add_u32 s74, s84, 32256
  buffer_load_dwordx4 v[196:199], v20, s[36:39], s74 offen sc1
  buffer_load_dwordx4 v[200:203], v21, s[36:39], s84 offen sc1
  s_mov_b32 s75, 32768
  v_mov_b32 v218, 0xce6e6b28
  v_cndmask_b32 v136, v218, v136, s[4:5]
  v_cndmask_b32 v137, v218, v137, s[6:7]
  v_cndmask_b32 v138, v218, v138, s[8:9]
  v_cndmask_b32 v139, v218, v139, s[10:11]
  v_cndmask_b32 v140, v218, v140, s[12:13]
  v_cndmask_b32 v141, v218, v141, s[14:15]
  v_cndmask_b32 v142, v218, v142, s[16:17]
  v_cndmask_b32 v143, v218, v143, s[18:19]
  v_cndmask_b32 v144, v218, v144, s[20:21]
  v_cndmask_b32 v145, v218, v145, s[22:23]
  v_cndmask_b32 v146, v218, v146, s[24:25]
  v_cndmask_b32 v147, v218, v147, s[26:27]
  v_cndmask_b32 v148, v218, v148, s[28:29]
  v_cndmask_b32 v149, v218, v149, s[30:31]
  v_cndmask_b32 v150, v218, v150, s[32:33]
  v_cndmask_b32 v151, v218, v151, s[34:35]
  v_max3_f32 v220, v136, v137, v138
  v_max3_f32 v220, v220, v139, v140
  v_max3_f32 v220, v220, v141, v142
  v_max3_f32 v220, v220, v143, v144
  v_max3_f32 v220, v220, v145, v146
  v_max3_f32 v220, v220, v147, v148
  v_max3_f32 v220, v220, v149, v150
  v_max_f32 v220, v220, v151
  s_branch RRC_66
RR_65:
  s_sub_u32 s75, s75, 1
  s_cmp_lg_u32 s75, 0
  s_cbranch_scc1 RRO_67
  s_mov_b32 s68, 52
  s_branch L_ABORT
RRO_67:
  s_add_u32 s74, s84, 0
  buffer_load_dwordx4 v[168:171], v20, s[36:39], s74 offen sc1
  s_add_u32 s74, s84, 4608
  buffer_load_dwordx4 v[172:175], v20, s[36:39], s74 offen sc1
  s_add_u32 s74, s84, 9216
  buffer_load_dwordx4 v[176:179], v20, s[36:39], s74 offen sc1
  s_add_u32 s74, s84, 13824
  buffer_load_dwordx4 v[180:183], v20, s[36:39], s74 offen sc1
  s_add_u32 s74, s84, 18432
  buffer_load_dwordx4 v[184:187], v20, s[36:39], s74 offen sc1
  s_add_u32 s74, s84, 23040
  buffer_load_dwordx4 v[188:191], v20, s[36:39], s74 offen sc1
  s_add_u32 s74, s84, 27648
  buffer_load_dwordx4 v[192:195], v20, s[36:39], s74 offen sc1
  s_add_u32 s74, s84, 32256
  buffer_load_dwordx4 v[196:199], v20, s[36:39], s74 offen sc1
  buffer_load_dwordx4 v[200:203], v21, s[36:39], s84 offen sc1
RRC_66:
  s_waitcnt vmcnt(8)
  v_mfma_f32_16x16x32_bf16 v[152:155], v[28:31], v[168:171], 0
  v_xor_b32 v160, s85, v168
  s_waitcnt vmcnt(7)
  v_mfma_f32_16x16x32_bf16 v[152:155], v[28:31], v[172:175], v[152:155]
  v_bitop3_b32 v160, v160, v172, s85 bitop3:0xf6
  s_waitcnt vmcnt(6)
  v_mfma_f32_16x16x32_bf16 v[152:155], v[28:31], v[176:179], v[152:155]
  v_bitop3_b32 v160, v160, v176, s85 bitop3:0xf6
  s_waitcnt vmcnt(5)
  v_mfma_f32_16x16x32_bf16 v[152:155], v[28:31], v[180:183], v[152:155]
  v_bitop3_b32 v160, v160, v180, s85 bitop3:0xf6
  s_waitcnt vmcnt(4)
  v_mfma_f32_16x16x32_bf16 v[152:155], v[28:31], v[184:187], v[152:155]
  v_bitop3_b32 v160, v160, v184, s85 bitop3:0xf6
  s_waitcnt vmcnt(3)
  v_mfma_f32_16x16x32_bf16 v[152:155], v[28:31], v[188:191], v[152:155]
  v_bitop3_b32 v160, v160, v188, s85 bitop3:0xf6
  s_waitcnt vmcnt(2)
  v_mfma_f32_16x16x32_bf16 v[152:155], v[28:31], v[192:195], v[152:155]
  v_bitop3_b32 v160, v160, v192, s85 bitop3:0xf6
  s_waitcnt vmcnt(1)
  v_mfma_f32_16x16x32_bf16 v[152:155], v[28:31], v[196:199], v[152:155]
  v_bitop3_b32 v160, v160, v196, s85 bitop3:0xf6
  s_waitcnt vmcnt(0)
  v_mfma_f32_16x16x32_bf16 v[156:159], v[28:31], v[200:203], 0
  v_bitop3_b32 v160, v160, v200, s85 bitop3:0xf6
  v_and_b32 v160, 1, v160
  v_cmp_ne_u32 vcc, 0, v160
  s_cbranch_vccnz RR_65
  s_nop 0
  ds_write2_b32 v22, v152, v153 offset0:0 offset1:16
  s_nop 1
  ds_write_b64 v23, v[156:157]
  s_waitcnt lgkmcnt(0)
  s_barrier
  s_mov_b64 exec, 3
  buffer_load_dword v9, v11, s[36:39], s82 offen sc1
  s_mov_b64 exec, -1
  s_add_u32 s89, s80, 262144
  buffer_load_dwordx4 v[236:239], v7, s[36:39], s89 offen sc1
  s_and_b32 s74, s76, 3
  s_cmp_lg_u32 s74, s64
  s_cbranch_scc1 L_A_NOLN
  v_lshlrev_b32 v168, 16, v224
  v_and_b32 v169, 0xffff0000, v224
  v_lshlrev_b32 v170, 16, v225
  v_and_b32 v171, 0xffff0000, v225
  v_lshlrev_b32 v172, 16, v226
  v_and_b32 v173, 0xffff0000, v226
  v_lshlrev_b32 v174, 16, v227
  v_and_b32 v175, 0xffff0000, v227
  v_lshlrev_b32_e64 v176, 16, v228
  ds_read_b128 v[184:187], v24 offset:12288
  ds_read_b128 v[188:191], v24 offset:12304
  ds_read_b32 v152, v25 offset:14336
  ds_read_b32 v153, v25 offset:14592
  ds_read_b32 v154, v25 offset:14848
  ds_read_b32 v155, v25 offset:15104
  ds_read_b32 v156, v25 offset:15360
  ds_read_b32 v157, v25 offset:15616
  ds_read_b32 v158, v25 offset:15872
  ds_read_b32 v159, v25 offset:16128
  s_waitcnt lgkmcnt(0)
  v_add_f32 v152, v152, v156
  v_add_f32 v153, v153, v157
  v_add_f32 v154, v154, v158
  v_add_f32 v155, v155, v159
  v_add_f32 v152, v152, v154
  v_add_f32 v153, v153, v155
  v_add_f32 v192, v152, v153
  s_cmp_eq_u32 s91, 0
  s_cbranch_scc1 FH_68
  s_waitcnt vmcnt(0)
  v_mov_b32 v1, s91
  s_mov_b64 exec, 1
  buffer_store_dword v1, v3, s[36:39], s86 offen sc1
  s_mov_b64 exec, -1
  s_mov_b32 s91, 0
FH_68:
  v_cvt_pk_bf16_f32 v196, v184, v185
  v_lshlrev_b32 v184, 16, v196
  v_and_b32 v185, 0xffff0000, v196
  v_cvt_pk_bf16_f32 v196, v186, v187
  v_lshlrev_b32 v186, 16, v196
  v_and_b32 v187, 0xffff0000, v196
  v_cvt_pk_bf16_f32 v196, v188, v189
  v_lshlrev_b32 v188, 16, v196
  v_and_b32 v189, 0xffff0000, v196
  v_cvt_pk_bf16_f32 v196, v190, v191
  v_lshlrev_b32 v190, 16, v196
  v_and_b32 v191, 0xffff0000, v196
  v_cvt_pk_bf16_f32 v192, v192, v192
  v_lshlrev_b32 v192, 16, v192
  v_pk_mul_f32 v[184:185], v[184:185], v[32:33]
  v_pk_mul_f32 v[186:187], v[186:187], v[34:35]
  v_pk_mul_f32 v[188:189], v[188:189], v[36:37]
  v_pk_mul_f32 v[190:191], v[190:191], v[38:39]
  v_mul_f32 v192, v192, v40
  v_cvt_pk_bf16_f32 v196, v184, v185
  v_lshlrev_b32 v184, 16, v196
  v_and_b32 v185, 0xffff0000, v196
  v_cvt_pk_bf16_f32 v196, v186, v187
  v_lshlrev_b32 v186, 16, v196
  v_and_b32 v187, 0xffff0000, v196
  v_cvt_pk_bf16_f32 v196, v188, v189
  v_lshlrev_b32 v188, 16, v196
  v_and_b32 v189, 0xffff0000, v196
  v_cvt_pk_bf16_f32 v196, v190, v191
  v_lshlrev_b32 v190, 16, v196
  v_and_b32 v191, 0xffff0000, v196
  v_cvt_pk_bf16_f32 v192, v192, v192
  v_lshlrev_b32 v192, 16, v192
  v_pk_add_f32 v[184:185], v[184:185], v[168:169]
  v_pk_add_f32 v[186:187], v[186:187], v[170:171]
  v_pk_add_f32 v[188:189], v[188:189], v[172:173]
  v_pk_add_f32 v[190:191], v[190:191], v[174:175]
  v_add_f32_e64 v192, v192, v176
  s_add_u32 s74, s87, 7340032
  v_cvt_pk_bf16_f32 v240, v184, v185
  v_cvt_pk_bf16_f32 v241, v186, v187
  v_cvt_pk_bf16_f32 v242, v188, v189
  v_cvt_pk_bf16_f32 v243, v190, v191
  v_cvt_pk_bf16_f32 v244, v192, v192
  buffer_store_dwordx4 v[240:243], v26, s[36:39], s74 offen sc1
  buffer_store_short v244, v27, s[36:39], s74 offen sc1
  v_lshlrev_b32 v184, 16, v240
  v_and_b32 v185, 0xffff0000, v240
  v_lshlrev_b32 v186, 16, v241
  v_and_b32 v187, 0xffff0000, v241
  v_lshlrev_b32 v188, 16, v242
  v_and_b32 v189, 0xffff0000, v242
  v_lshlrev_b32 v190, 16, v243
  v_and_b32 v191, 0xffff0000, v243
  v_lshlrev_b32 v192, 16, v244
  s_nop 0
  v_readfirstlane_b32 s97, v184
  s_nop 1
  v_subrev_f32 v202, s97, v184
  v_mov_b32 v196, v202
  v_mul_f32 v197, v202, v202
  v_subrev_f32 v202, s97, v185
  v_add_f32 v196, v196, v202
  v_fmac_f32 v197, v202, v202
  v_subrev_f32 v202, s97, v186
  v_add_f32 v196, v196, v202
  v_fmac_f32 v197, v202, v202
  v_subrev_f32 v202, s97, v187
  v_add_f32 v196, v196, v202
  v_fmac_f32 v197, v202, v202
  v_subrev_f32 v202, s97, v188
  v_add_f32 v196, v196, v202
  v_fmac_f32 v197, v202, v202
  v_subrev_f32 v202, s97, v189
  v_add_f32 v196, v196, v202
  v_fmac_f32 v197, v202, v202
  v_subrev_f32 v202, s97, v190
  v_add_f32 v196, v196, v202
  v_fmac_f32 v197, v202, v202
  v_subrev_f32 v202, s97, v191
  v_add_f32 v196, v196, v202
  v_fmac_f32 v197, v202, v202
  v_subrev_f32 v202, s97, v192
  v_add_f32 v196, v196, v202
  v_fmac_f32 v197, v202, v202
  s_nop 0
  v_add_f32_dpp v196, v196, v196 quad_perm:[1,0,3,2] row_mask:0xf bank_mask:0xf
  v_add_f32_dpp v197, v197, v197 quad_perm:[1,0,3,2] row_mask:0xf bank_mask:0xf
  s_nop 0
  v_add_f32_dpp v196, v196, v196 quad_perm:[2,3,0,1] row_mask:0xf bank_mask:0xf
  v_add_f32_dpp v197, v197, v197 quad_perm:[2,3,0,1] row_mask:0xf bank_mask:0xf
  s_nop 0
  v_add_f32_dpp v196, v196, v196 row_half_mirror row_mask:0xf bank_mask:0xf
  v_add_f32_dpp v197, v197, v197 row_half_mirror row_mask:0xf bank_mask:0xf
  s_nop 0
  v_add_f32_dpp v196, v196, v196 row_mirror row_mask:0xf bank_mask:0xf
  v_add_f32_dpp v197, v197, v197 row_mirror row_mask:0xf bank_mask:0xf
  s_nop 0
  v_mov_b64 v[202:203], v[196:197]
  s_nop 1
  v_permlane16_swap_b32 v196, v202
  v_permlane16_swap_b32 v197, v203
  v_pk_add_f32 v[196:197], v[196:197], v[202:203]
  v_mov_b64 v[202:203], v[196:197]
  s_nop 1
  v_permlane32_swap_b32 v196, v202
  v_permlane32_swap_b32 v197, v203
  v_pk_add_f32 v[196:197], v[196:197], v[202:203]
  s_mov_b64 exec, 3
  buffer_load_dword v9, v11, s[36:39], s82 offen sc1
  s_mov_b64 exec, -1
  s_add_u32 s89, s80, 262144
  buffer_load_dwordx4 v[236:239], v7, s[36:39], s89 offen sc1
  v_mul_f32 v196, 0x3ae38e39, v196
  v_mul_f32 v197, 0x3ae38e39, v197
  v_fma_f32 v197, -v196, v196, v197
  v_max_f32 v197, 0, v197
  v_add_f32 v198, s97, v196
  v_cvt_pk_bf16_f32 v202, v198, v197
  v_lshlrev_b32_e64 v198, 16, v202
  v_and_b32 v197, 0xffff0000, v202
  v_add_f32 v197, 0x3727c5ac, v197
  v_cvt_pk_bf16_f32 v197, v197, v197
  v_lshlrev_b32 v197, 16, v197
  v_sqrt_f32 v197, v197
  v_pk_add_f32 v[184:185], v[184:185], v[198:199] op_sel_hi:[1,0] neg_lo:[0,1] neg_hi:[0,1]
  v_pk_add_f32 v[186:187], v[186:187], v[198:199] op_sel_hi:[1,0] neg_lo:[0,1] neg_hi:[0,1]
  v_pk_add_f32 v[188:189], v[188:189], v[198:199] op_sel_hi:[1,0] neg_lo:[0,1] neg_hi:[0,1]
  v_pk_add_f32 v[190:191], v[190:191], v[198:199] op_sel_hi:[1,0] neg_lo:[0,1] neg_hi:[0,1]
  v_sub_f32 v192, v192, v198
  v_cvt_pk_bf16_f32 v197, v197, v197
  v_lshlrev_b32 v197, 16, v197
  v_rcp_f32 v200, v197
  v_cvt_pk_bf16_f32 v202, v184, v185
  v_lshlrev_b32 v184, 16, v202
  v_and_b32 v185, 0xffff0000, v202
  v_cvt_pk_bf16_f32 v202, v186, v187
  v_lshlrev_b32 v186, 16, v202
  v_and_b32 v187, 0xffff0000, v202
  v_cvt_pk_bf16_f32 v202, v188, v189
  v_lshlrev_b32 v188, 16, v202
  v_and_b32 v189, 0xffff0000, v202
  v_cvt_pk_bf16_f32 v202, v190, v191
  v_lshlrev_b32 v190, 16, v202
  v_and_b32 v191, 0xffff0000, v202
  v_cvt_pk_bf16_f32 v192, v192, v192
  v_lshlrev_b32 v192, 16, v192
  v_pk_mul_f32 v[184:185], v[184:185], v[200:201] op_sel_hi:[1,0]
  v_pk_mul_f32 v[186:187], v[186:187], v[200:201] op_sel_hi:[1,0]
  v_pk_mul_f32 v[188:189], v[188:189], v[200:201] op_sel_hi:[1,0]
  v_pk_mul_f32 v[190:191], v[190:191], v[200:201] op_sel_hi:[1,0]
  v_mul_f32 v192, v192, v200
  v_cvt_pk_bf16_f32 v202, v184, v185
  v_lshlrev_b32 v184, 16, v202
  v_and_b32 v185, 0xffff0000, v202
  v_cvt_pk_bf16_f32 v202, v186, v187
  v_lshlrev_b32 v186, 16, v202
  v_and_b32 v187, 0xffff0000, v202
  v_cvt_pk_bf16_f32 v202, v188, v189
  v_lshlrev_b32 v188, 16, v202
  v_and_b32 v189, 0xffff0000, v202
  v_cvt_pk_bf16_f32 v202, v190, v191
  v_lshlrev_b32 v190, 16, v202
  v_and_b32 v191, 0xffff0000, v202
  v_cvt_pk_bf16_f32 v192, v192, v192
  v_lshlrev_b32 v192, 16, v192
  v_pk_mul_f32 v[184:185], v[184:185], v[42:43]
  v_pk_mul_f32 v[186:187], v[186:187], v[44:45]
  v_pk_mul_f32 v[188:189], v[188:189], v[46:47]
  v_pk_mul_f32 v[190:191], v[190:191], v[48:49]
  v_mul_f32 v192, v192, v50
  v_cvt_pk_bf16_f32 v196, v184, v185
  v_lshlrev_b32 v184, 16, v196
  v_and_b32 v185, 0xffff0000, v196
  v_cvt_pk_bf16_f32 v196, v186, v187
  v_lshlrev_b32 v186, 16, v196
  v_and_b32 v187, 0xffff0000, v196
  v_cvt_pk_bf16_f32 v196, v188, v189
  v_lshlrev_b32 v188, 16, v196
  v_and_b32 v189, 0xffff0000, v196
  v_cvt_pk_bf16_f32 v196, v190, v191
  v_lshlrev_b32 v190, 16, v196
  v_and_b32 v191, 0xffff0000, v196
  v_cvt_pk_bf16_f32 v192, v192, v192
  v_lshlrev_b32 v192, 16, v192
  v_pk_add_f32 v[184:185], v[184:185], v[52:53]
  v_pk_add_f32 v[186:187], v[186:187], v[54:55]
  v_pk_add_f32 v[188:189], v[188:189], v[56:57]
  v_pk_add_f32 v[190:191], v[190:191], v[58:59]
  v_add_f32_e64 v192, v192, v60
  s_add_u32 s74, s87, 4194304
  v_cvt_pk_bf16_f32 v248, v184, v185
  v_cvt_pk_bf16_f32 v249, v186, v187
  v_cvt_pk_bf16_f32 v250, v188, v189
  v_cvt_pk_bf16_f32 v251, v190, v191
  v_cvt_pk_bf16_f32 v252, v192, v192
  buffer_store_dwordx4 v[248:251], v26, s[36:39], s74 offen sc1
  buffer_store_short v252, v27, s[36:39], s74 offen sc1
  s_mov_b32 s91, s88
L_A_NOLN:
  s_bitcmp1_b32 s76, 0
  s_mov_b32 s74, 0x120000
  s_cselect_b32 s74, 4293787648, s74
  s_add_u32 s83, s83, s74
  s_add_u32 s84, s84, s74
  s_add_u32 s80, s80, 262144
  s_add_u32 s87, s87, 73728
  s_add_u32 s76, s76, 1
  s_cmp_lt_u32 s76, 32
  s_cbranch_scc1 L_A_LOOP
  s_cmp_eq_u32 s91, 0
  s_cbranch_scc1 FH_69
  s_waitcnt vmcnt(0)
  v_mov_b32 v1, s91
  s_mov_b64 exec, 1
  buffer_store_dword v1, v3, s[36:39], s86 offen sc1
  s_mov_b64 exec, -1
  s_mov_b32 s91, 0
FH_69:
  s_endpgm
L_ROLE_F:
  s_mov_b32 s44, s20
  s_and_b32 s45, s21, 0xffff
  s_mov_b32 s46, 5308416
  s_mov_b32 s47, 0x20000
  s_mov_b32 s48, s22
  s_and_b32 s49, s23, 0xffff
  s_mov_b32 s50, 5308416
  s_mov_b32 s51, 0x20000
  s_mov_b32 s52, s24
  s_and_b32 s53, s25, 0xffff
  s_mov_b32 s54, 5308416
  s_mov_b32 s55, 0x20000
  s_mov_b32 s56, s30
  s_and_b32 s57, s31, 0xffff
  s_mov_b32 s58, 2359296
  s_mov_b32 s59, 0x20000
  v_mov_b32 v3, 0
  v_lshlrev_b32 v4, 4, v0
  s_mul_i32 s70, s67, 0x240000
  s_mul_i32 s78, s65, 36864
  s_add_u32 s78, s78, s70
  s_add_u32 s78, s78, 15728640
  v_mov_b32 v8, -1
  v_mov_b32 v9, -1
  v_mov_b32 v10, -1
  v_mov_b32_e64 v11, -1
  s_mul_i32 s70, s64, 9216
  s_add_u32 s70, s70, s78
  buffer_store_dwordx4 v[8:11], v4, s[36:39], s70 offen offset:0
  buffer_store_dwordx4 v[8:11], v4, s[36:39], s70 offen offset:1024
  buffer_store_dwordx4 v[8:11], v4, s[36:39], s70 offen offset:2048
  s_add_u32 s70, s70, 3072
  buffer_store_dwordx4 v[8:11], v4, s[36:39], s70 offen offset:0
  buffer_store_dwordx4 v[8:11], v4, s[36:39], s70 offen offset:1024
  buffer_store_dwordx4 v[8:11], v4, s[36:39], s70 offen offset:2048
  s_add_u32 s70, s70, 3072
  buffer_store_dwordx4 v[8:11], v4, s[36:39], s70 offen offset:0
  buffer_store_dwordx4 v[8:11], v4, s[36:39], s70 offen offset:1024
  buffer_store_dwordx4 v[8:11], v4, s[36:39], s70 offen offset:2048
  s_add_u32 s70, s70, 1173504
  buffer_store_dwordx4 v[8:11], v4, s[36:39], s70 offen offset:0
  buffer_store_dwordx4 v[8:11], v4, s[36:39], s70 offen offset:1024
  buffer_store_dwordx4 v[8:11], v4, s[36:39], s70 offen offset:2048
  s_add_u32 s70, s70, 3072
  buffer_store_dwordx4 v[8:11], v4, s[36:39], s70 offen offset:0
  buffer_store_dwordx4 v[8:11], v4, s[36:39], s70 offen offset:1024
  buffer_store_dwordx4 v[8:11], v4, s[36:39], s70 offen offset:2048
  s_add_u32 s70, s70, 3072
  buffer_store_dwordx4 v[8:11], v4, s[36:39], s70 offen offset:0
  buffer_store_dwordx4 v[8:11], v4, s[36:39], s70 offen offset:1024
  buffer_store_dwordx4 v[8:11], v4, s[36:39], s70 offen offset:2048
  s_add_u32 s70, s70, 1173504
  s_mov_b32 s71, 32768
WC_70:
  buffer_load_dword v1, v3, s[40:43], 0 offen offset:72 sc1
  s_waitcnt vmcnt(0)
  v_cmp_gt_u32 vcc, 36, v1
  s_cbranch_vccz WCD_71
  s_sleep 16
  s_sub_u32 s71, s71, 1
  s_cmp_lg_u32 s71, 0
  s_cbranch_scc1 WC_70
  s_mov_b32 s68, 66
  s_branch L_ABORT
WCD_71:
  s_waitcnt vmcnt(0)
  s_barrier
  s_cmp_lg_u32 s64, 0
  s_cbranch_scc1 AI_72
  v_mov_b32 v1, 1
  s_mov_b64 exec, 1
  buffer_atomic_add v1, v3, s[40:43], 0 offen offset:204
  s_mov_b64 exec, -1
AI_72:
  v_bfe_u32 v1, v0, 2, 4
  v_lshlrev_b32 v2, 0, v1
  v_mul_u32_u24 v30, 9216, v2
  v_mul_u32_u24 v31, 1152, v2
  v_mov_b32_e64 v32, v31
  v_bfe_u32 v1, v0, 0, 2
  v_lshl_add_u32 v30, v1, 4, v30
  v_bfe_u32 v1, v0, 0, 2
  v_lshl_add_u32 v31, v1, 4, v31
  v_bfe_u32 v1, v0, 0, 1
  v_lshl_add_u32 v32, v1, 4, v32
  v_bfe_u32 v1, v0, 1, 1
  v_mul_u32_u24 v1, 36864, v1
  v_add_u32 v32, v32, v1
  v_bfe_u32 v1, v0, 1, 5
  v_lshlrev_b32 v2, 0, v1
  v_mul_u32_u24 v33, 9216, v2
  v_bfe_u32 v1, v0, 0, 1
  v_lshl_add_u32 v33, v1, 4, v33
  s_mul_i32 s74, s65, 288
  s_mul_i32 s70, s64, 294912
  s_add_u32 s76, s74, s70
  s_add_u32 s76, s76, 256
  s_lshl_b32 s70, s64, 6
  s_add_u32 s74, s74, s70
  s_mul_i32 s75, s65, 165888
  s_mul_i32 s70, s64, 288
  s_add_u32 s75, s75, s70
  s_lshl_b32 s73, s64, 11
  s_add_u32 s73, s73, 119808
  v_lshlrev_b32 v4, 4, v0
  v_lshlrev_b32 v5, 2, v0
  v_add_u32 v38, s73, v4
  v_bfe_u32 v1, v0, 0, 1
  v_lshlrev_b32_e64 v37, 10, v1
  v_bfe_u32 v1, v0, 4, 2
  v_lshl_add_u32 v37, v1, 8, v37
  v_bfe_u32 v1, v0, 2, 2
  v_lshl_add_u32 v37, v1, 5, v37
  v_bfe_u32 v1, v0, 1, 1
  v_lshl_add_u32 v37, v1, 3, v37
  v_add_u32 v37, s73, v37
  s_add_u32 m0, s73, 0
  s_add_u32 s70, s76, 0
  buffer_load_dwordx4 v33, s[44:47], s70 offen  lds
  s_add_u32 m0, s73, 1024
  s_add_u32 s70, s76, 0
  buffer_load_dwordx4 v33, s[48:51], s70 offen  lds
  s_add_u32 m0, s73, 8192
  s_add_u32 s70, s76, 1179648
  buffer_load_dwordx4 v33, s[44:47], s70 offen  lds
  s_add_u32 m0, s73, 9216
  s_add_u32 s70, s76, 1179648
  buffer_load_dwordx4 v33, s[48:51], s70 offen  lds
  s_add_u32 m0, s73, 16384
  s_add_u32 s70, s76, 2359296
  buffer_load_dwordx4 v33, s[44:47], s70 offen  lds
  s_add_u32 m0, s73, 17408
  s_add_u32 s70, s76, 2359296
  buffer_load_dwordx4 v33, s[48:51], s70 offen  lds
  s_add_u32 m0, s73, 24576
  s_add_u32 s70, s76, 3538944
  buffer_load_dwordx4 v33, s[44:47], s70 offen  lds
  s_add_u32 m0, s73, 25600
  s_add_u32 s70, s76, 3538944
  buffer_load_dwordx4 v33, s[48:51], s70 offen  lds
  s_add_u32 m0, s73, 32768
  s_add_u32 s70, s76, 4718592
  buffer_load_dwordx4 v33, s[44:47], s70 offen  lds
  s_add_u32 m0, s73, 33792
  s_add_u32 s70, s76, 4718592
  buffer_load_dwordx4 v33, s[48:51], s70 offen  lds
  s_waitcnt vmcnt(8)
  ds_read_b64_tr_b16 v[60:61], v37 offset:0
  ds_read_b64_tr_b16 v[62:63], v37 offset:128
  ds_read_b64_tr_b16 v[64:65], v37 offset:16
  ds_read_b64_tr_b16 v[66:67], v37 offset:144
  s_waitcnt lgkmcnt(0)
  ds_write_b128 v38, v[60:63] offset:0
  ds_write_b128 v38, v[64:67] offset:1024
  s_waitcnt lgkmcnt(0)
  s_waitcnt vmcnt(6)
  ds_read_b64_tr_b16 v[60:61], v37 offset:8192
  ds_read_b64_tr_b16 v[62:63], v37 offset:8320
  ds_read_b64_tr_b16 v[64:65], v37 offset:8208
  ds_read_b64_tr_b16 v[66:67], v37 offset:8336
  s_waitcnt lgkmcnt(0)
  ds_write_b128 v38, v[60:63] offset:8192
  ds_write_b128 v38, v[64:67] offset:9216
  s_waitcnt lgkmcnt(0)
  s_waitcnt vmcnt(4)
  ds_read_b64_tr_b16 v[60:61], v37 offset:16384
  ds_read_b64_tr_b16 v[62:63], v37 offset:16512
  ds_read_b64_tr_b16 v[64:65], v37 offset:16400
  ds_read_b64_tr_b16 v[66:67], v37 offset:16528
  s_waitcnt lgkmcnt(0)
  ds_write_b128 v38, v[60:63] offset:16384
  ds_write_b128 v38, v[64:67] offset:17408
  s_waitcnt lgkmcnt(0)
  s_waitcnt vmcnt(2)
  ds_read_b64_tr_b16 v[60:61], v37 offset:24576
  ds_read_b64_tr_b16 v[62:63], v37 offset:24704
  ds_read_b64_tr_b16 v[64:65], v37 offset:24592
  ds_read_b64_tr_b16 v[66:67], v37 offset:24720
  s_waitcnt lgkmcnt(0)
  ds_write_b128 v38, v[60:63] offset:24576
  ds_write_b128 v38, v[64:67] offset:25600
  s_waitcnt lgkmcnt(0)
  s_waitcnt vmcnt(0)
  ds_read_b64_tr_b16 v[60:61], v37 offset:32768
  ds_read_b64_tr_b16 v[62:63], v37 offset:32896
  ds_read_b64_tr_b16 v[64:65], v37 offset:32784
  ds_read_b64_tr_b16 v[66:67], v37 offset:32912
  s_waitcnt lgkmcnt(0)
  ds_write_b128 v38, v[60:63] offset:32768
  ds_write_b128 v38, v[64:67] offset:33792
  s_waitcnt lgkmcnt(0)
  s_waitcnt lgkmcnt(0)
  s_mul_i32 s70, s64, 18432
  s_add_u32 s70, s70, 46080
  v_add_u32 v8, s70, v4
  s_lshl_b32 s73, s64, 12
  s_mul_i32 s74, s65, 288
  s_mul_i32 s70, s64, 147456
  s_add_u32 s74, s74, s70
  s_mul_i32 s75, s65, 165888
  s_lshl_b32 s76, s64, 8
  s_add_u32 s76, s76, s75
  s_mul_i32 s70, s64, 18432
  s_add_u32 s75, s75, s70
  v_bfe_u32 v1, v0, 4, 2
  v_lshlrev_b32_e64 v2, 0, v1
  v_mul_u32_u24 v30, 9216, v2
  v_mul_u32_u24 v31, 1152, v2
  v_bfe_u32 v1, v0, 0, 4
  v_lshl_add_u32 v30, v1, 4, v30
  v_bfe_u32 v1, v0, 0, 4
  v_lshl_add_u32 v31, v1, 4, v31
  v_bfe_u32 v1, v0, 4, 2
  v_lshlrev_b32_e64 v34, 11, v1
  v_bfe_u32 v1, v0, 2, 2
  v_lshl_add_u32 v34, v1, 8, v34
  v_bfe_u32 v1, v0, 0, 2
  v_lshl_add_u32 v34, v1, 3, v34
  v_bfe_u32 v1, v0, 4, 2
  v_lshlrev_b32_e64 v35, 10, v1
  v_bfe_u32 v1, v0, 2, 2
  v_lshl_add_u32 v35, v1, 8, v35
  v_bfe_u32 v1, v0, 0, 2
  v_lshl_add_u32 v35, v1, 3, v35
  v_bfe_u32 v1, v0, 4, 1
  v_lshlrev_b32_e64 v36, 8, v1
  v_bfe_u32 v1, v0, 5, 1
  v_lshl_add_u32 v36, v1, 10, v36
  v_bfe_u32 v1, v0, 2, 1
  v_lshl_add_u32 v36, v1, 9, v36
  v_bfe_u32 v1, v0, 3, 1
  v_lshl_add_u32 v36, v1, 11, v36
  v_bfe_u32 v1, v0, 0, 2
  v_lshl_add_u32 v36, v1, 3, v36
  s_lshl_b32 s70, s64, 5
  v_add_u32 v32, s70, v35
  v_add_u32 v33, s70, v36
  v_add_u32 v35, s70, v32
  v_add_u32 v36, s70, v33
  s_lshl_b32 s70, s64, 6
  v_add_u32 v34, s70, v34
  s_add_u32 m0, s73, 0
  s_add_u32 s70, s75, 73728
  buffer_load_dwordx4 v31, s[52:55], s70 offen lds
  s_add_u32 m0, s73, 1024
  s_add_u32 s70, s75, 78336
  buffer_load_dwordx4 v31, s[52:55], s70 offen lds
  s_add_u32 m0, s73, 2048
  s_add_u32 s70, s75, 82944
  buffer_load_dwordx4 v31, s[52:55], s70 offen lds
  s_add_u32 m0, s73, 3072
  s_add_u32 s70, s75, 87552
  buffer_load_dwordx4 v31, s[52:55], s70 offen lds
  s_add_u32 m0, s73, 16384
  s_add_u32 s70, s75, 73984
  buffer_load_dwordx4 v31, s[52:55], s70 offen lds
  s_add_u32 m0, s73, 17408
  s_add_u32 s70, s75, 78592
  buffer_load_dwordx4 v31, s[52:55], s70 offen lds
  s_add_u32 m0, s73, 18432
  s_add_u32 s70, s75, 83200
  buffer_load_dwordx4 v31, s[52:55], s70 offen lds
  s_add_u32 m0, s73, 19456
  s_add_u32 s70, s75, 87808
  buffer_load_dwordx4 v31, s[52:55], s70 offen lds
  s_add_u32 m0, s73, 32768
  s_add_u32 s70, s75, 74240
  buffer_load_dwordx4 v31, s[52:55], s70 offen lds
  s_add_u32 m0, s73, 33792
  s_add_u32 s70, s75, 78848
  buffer_load_dwordx4 v31, s[52:55], s70 offen lds
  s_add_u32 m0, s73, 34816
  s_add_u32 s70, s75, 83456
  buffer_load_dwordx4 v31, s[52:55], s70 offen lds
  s_add_u32 m0, s73, 35840
  s_add_u32 s70, s75, 88064
  buffer_load_dwordx4 v31, s[52:55], s70 offen lds
  s_add_u32 m0, s73, 49152
  s_add_u32 s70, s75, 74496
  buffer_load_dwordx4 v31, s[52:55], s70 offen lds
  s_add_u32 m0, s73, 50176
  s_add_u32 s70, s75, 79104
  buffer_load_dwordx4 v31, s[52:55], s70 offen lds
  s_add_u32 m0, s73, 51200
  s_add_u32 s70, s75, 83712
  buffer_load_dwordx4 v31, s[52:55], s70 offen lds
  s_add_u32 m0, s73, 52224
  s_add_u32 s70, s75, 88320
  buffer_load_dwordx4 v31, s[52:55], s70 offen lds
  s_add_u32 m0, s73, 65536
  s_add_u32 s70, s75, 74752
  buffer_load_dwordx4 v31, s[52:55], s70 offen lds
  s_add_u32 m0, s73, 66560
  s_add_u32 s70, s75, 79360
  buffer_load_dwordx4 v31, s[52:55], s70 offen lds
  s_add_u32 m0, s73, 67584
  s_add_u32 s70, s75, 83968
  buffer_load_dwordx4 v31, s[52:55], s70 offen lds
  s_add_u32 m0, s73, 68608
  s_add_u32 s70, s75, 88576
  buffer_load_dwordx4 v31, s[52:55], s70 offen lds
  s_add_u32 m0, s73, 81920
  s_add_u32 s70, s74, 0
  buffer_load_dwordx4 v30, s[44:47], s70 offen lds
  s_add_u32 m0, s73, 82944
  s_add_u32 s70, s74, 36864
  buffer_load_dwordx4 v30, s[44:47], s70 offen lds
  s_add_u32 m0, s73, 83968
  s_add_u32 s70, s74, 73728
  buffer_load_dwordx4 v30, s[44:47], s70 offen lds
  s_add_u32 m0, s73, 84992
  s_add_u32 s70, s74, 110592
  buffer_load_dwordx4 v30, s[44:47], s70 offen lds
  s_add_u32 m0, s73, 98304
  s_add_u32 s70, s74, 0
  buffer_load_dwordx4 v30, s[48:51], s70 offen lds
  s_add_u32 m0, s73, 99328
  s_add_u32 s70, s74, 36864
  buffer_load_dwordx4 v30, s[48:51], s70 offen lds
  s_add_u32 m0, s73, 100352
  s_add_u32 s70, s74, 73728
  buffer_load_dwordx4 v30, s[48:51], s70 offen lds
  s_add_u32 m0, s73, 101376
  s_add_u32 s70, s74, 110592
  buffer_load_dwordx4 v30, s[48:51], s70 offen lds
  s_waitcnt vmcnt(24) lgkmcnt(0)
  s_barrier
  v_add_u32_e64 v2, 0, v35
  ds_read_b64_tr_b16 v[60:61], v2 offset:0
  ds_read_b64_tr_b16 v[62:63], v2 offset:4096
  ds_read_b64_tr_b16 v[64:65], v2 offset:32
  ds_read_b64_tr_b16 v[66:67], v2 offset:4128
  ds_read_b64_tr_b16 v[96:97], v2 offset:8192
  ds_read_b64_tr_b16 v[98:99], v2 offset:12288
  ds_read_b64_tr_b16 v[100:101], v2 offset:8224
  ds_read_b64_tr_b16 v[102:103], v2 offset:12320
  s_waitcnt vmcnt(20) lgkmcnt(0)
  s_barrier
  s_add_u32 m0, s73, 0
  s_add_u32 s70, s74, 589824
  buffer_load_dwordx4 v30, s[44:47], s70 offen lds
  s_add_u32 m0, s73, 1024
  s_add_u32 s70, s74, 626688
  buffer_load_dwordx4 v30, s[44:47], s70 offen lds
  s_add_u32 m0, s73, 2048
  s_add_u32 s70, s74, 663552
  buffer_load_dwordx4 v30, s[44:47], s70 offen lds
  s_add_u32 m0, s73, 3072
  s_add_u32 s70, s74, 700416
  buffer_load_dwordx4 v30, s[44:47], s70 offen lds
  v_add_u32 v2, 16384, v35
  ds_read_b64_tr_b16 v[68:69], v2 offset:0
  ds_read_b64_tr_b16 v[70:71], v2 offset:4096
  ds_read_b64_tr_b16 v[72:73], v2 offset:32
  ds_read_b64_tr_b16 v[74:75], v2 offset:4128
  ds_read_b64_tr_b16 v[104:105], v2 offset:8192
  ds_read_b64_tr_b16 v[106:107], v2 offset:12288
  ds_read_b64_tr_b16 v[108:109], v2 offset:8224
  ds_read_b64_tr_b16 v[110:111], v2 offset:12320
  s_waitcnt vmcnt(20) lgkmcnt(0)
  s_barrier
  s_add_u32 m0, s73, 16384
  s_add_u32 s70, s74, 589824
  buffer_load_dwordx4 v30, s[48:51], s70 offen lds
  s_add_u32 m0, s73, 17408
  s_add_u32 s70, s74, 626688
  buffer_load_dwordx4 v30, s[48:51], s70 offen lds
  s_add_u32 m0, s73, 18432
  s_add_u32 s70, s74, 663552
  buffer_load_dwordx4 v30, s[48:51], s70 offen lds
  s_add_u32 m0, s73, 19456
  s_add_u32 s70, s74, 700416
  buffer_load_dwordx4 v30, s[48:51], s70 offen lds
  v_add_u32 v2, 32768, v35
  ds_read_b64_tr_b16 v[76:77], v2 offset:0
  ds_read_b64_tr_b16 v[78:79], v2 offset:4096
  ds_read_b64_tr_b16 v[80:81], v2 offset:32
  ds_read_b64_tr_b16 v[82:83], v2 offset:4128
  ds_read_b64_tr_b16 v[112:113], v2 offset:8192
  ds_read_b64_tr_b16 v[114:115], v2 offset:12288
  ds_read_b64_tr_b16 v[116:117], v2 offset:8224
  ds_read_b64_tr_b16 v[118:119], v2 offset:12320
  s_waitcnt vmcnt(20) lgkmcnt(0)
  s_barrier
  s_add_u32 m0, s73, 32768
  s_add_u32 s70, s74, 1179648
  buffer_load_dwordx4 v30, s[44:47], s70 offen lds
  s_add_u32 m0, s73, 33792
  s_add_u32 s70, s74, 1216512
  buffer_load_dwordx4 v30, s[44:47], s70 offen lds
  s_add_u32 m0, s73, 34816
  s_add_u32 s70, s74, 1253376
  buffer_load_dwordx4 v30, s[44:47], s70 offen lds
  s_add_u32 m0, s73, 35840
  s_add_u32 s70, s74, 1290240
  buffer_load_dwordx4 v30, s[44:47], s70 offen lds
  v_add_u32 v2, 49152, v35
  ds_read_b64_tr_b16 v[84:85], v2 offset:0
  ds_read_b64_tr_b16 v[86:87], v2 offset:4096
  ds_read_b64_tr_b16 v[88:89], v2 offset:32
  ds_read_b64_tr_b16 v[90:91], v2 offset:4128
  ds_read_b64_tr_b16 v[120:121], v2 offset:8192
  ds_read_b64_tr_b16 v[122:123], v2 offset:12288
  ds_read_b64_tr_b16 v[124:125], v2 offset:8224
  ds_read_b64_tr_b16 v[126:127], v2 offset:12320
  s_waitcnt vmcnt(20) lgkmcnt(0)
  s_barrier
  s_add_u32 m0, s73, 49152
  s_add_u32 s70, s74, 1179648
  buffer_load_dwordx4 v30, s[48:51], s70 offen lds
  s_add_u32 m0, s73, 50176
  s_add_u32 s70, s74, 1216512
  buffer_load_dwordx4 v30, s[48:51], s70 offen lds
  s_add_u32 m0, s73, 51200
  s_add_u32 s70, s74, 1253376
  buffer_load_dwordx4 v30, s[48:51], s70 offen lds
  s_add_u32 m0, s73, 52224
  s_add_u32 s70, s74, 1290240
  buffer_load_dwordx4 v30, s[48:51], s70 offen lds
  v_add_u32 v2, 65536, v32
  ds_read_b64_tr_b16 v[92:93], v2 offset:0
  ds_read_b64_tr_b16 v[94:95], v2 offset:4096
  ds_read_b64_tr_b16 v[128:129], v2 offset:8192
  ds_read_b64_tr_b16 v[130:131], v2 offset:12288
  s_waitcnt vmcnt(20) lgkmcnt(0)
  s_barrier
  s_add_u32 m0, s73, 65536
  s_add_u32 s70, s74, 1769472
  buffer_load_dwordx4 v30, s[44:47], s70 offen lds
  s_add_u32 m0, s73, 66560
  s_add_u32 s70, s74, 1806336
  buffer_load_dwordx4 v30, s[44:47], s70 offen lds
  s_add_u32 m0, s73, 67584
  s_add_u32 s70, s74, 1843200
  buffer_load_dwordx4 v30, s[44:47], s70 offen lds
  s_add_u32 m0, s73, 68608
  s_add_u32 s70, s74, 1880064
  buffer_load_dwordx4 v30, s[44:47], s70 offen lds
  v_add_u32 v2, 81920, v34
  ds_read_b64_tr_b16 a[0:1], v2 offset:0
  ds_read_b64_tr_b16 a[2:3], v2 offset:1024
  ds_read_b64_tr_b16 a[72:73], v2 offset:32
  ds_read_b64_tr_b16 a[74:75], v2 offset:1056
  ds_read_b64_tr_b16 a[4:5], v2 offset:8192
  ds_read_b64_tr_b16 a[6:7], v2 offset:9216
  ds_read_b64_tr_b16 a[76:77], v2 offset:8224
  ds_read_b64_tr_b16 a[78:79], v2 offset:9248
  s_waitcnt vmcnt(20) lgkmcnt(0)
  s_barrier
  s_add_u32 m0, s73, 81920
  s_add_u32 s70, s74, 1769472
  buffer_load_dwordx4 v30, s[48:51], s70 offen lds
  s_add_u32 m0, s73, 82944
  s_add_u32 s70, s74, 1806336
  buffer_load_dwordx4 v30, s[48:51], s70 offen lds
  s_add_u32 m0, s73, 83968
  s_add_u32 s70, s74, 1843200
  buffer_load_dwordx4 v30, s[48:51], s70 offen lds
  s_add_u32 m0, s73, 84992
  s_add_u32 s70, s74, 1880064
  buffer_load_dwordx4 v30, s[48:51], s70 offen lds
  v_add_u32 v2, 98304, v34
  ds_read_b64_tr_b16 a[144:145], v2 offset:0
  ds_read_b64_tr_b16 a[146:147], v2 offset:1024
  ds_read_b64_tr_b16 a[216:217], v2 offset:32
  ds_read_b64_tr_b16 a[218:219], v2 offset:1056
  ds_read_b64_tr_b16 a[148:149], v2 offset:8192
  ds_read_b64_tr_b16 a[150:151], v2 offset:9216
  ds_read_b64_tr_b16 a[220:221], v2 offset:8224
  ds_read_b64_tr_b16 a[222:223], v2 offset:9248
  s_waitcnt vmcnt(20) lgkmcnt(0)
  s_barrier
  s_add_u32 m0, s73, 98304
  s_add_u32 s70, s74, 2359296
  buffer_load_dwordx4 v30, s[44:47], s70 offen lds
  s_add_u32 m0, s73, 99328
  s_add_u32 s70, s74, 2396160
  buffer_load_dwordx4 v30, s[44:47], s70 offen lds
  s_add_u32 m0, s73, 100352
  s_add_u32 s70, s74, 2433024
  buffer_load_dwordx4 v30, s[44:47], s70 offen lds
  s_add_u32 m0, s73, 101376
  s_add_u32 s70, s74, 2469888
  buffer_load_dwordx4 v30, s[44:47], s70 offen lds
  v_add_u32 v2, 0, v34
  ds_read_b64_tr_b16 a[8:9], v2 offset:0
  ds_read_b64_tr_b16 a[10:11], v2 offset:1024
  ds_read_b64_tr_b16 a[80:81], v2 offset:32
  ds_read_b64_tr_b16 a[82:83], v2 offset:1056
  ds_read_b64_tr_b16 a[12:13], v2 offset:8192
  ds_read_b64_tr_b16 a[14:15], v2 offset:9216
  ds_read_b64_tr_b16 a[84:85], v2 offset:8224
  ds_read_b64_tr_b16 a[86:87], v2 offset:9248
  s_waitcnt vmcnt(20) lgkmcnt(0)
  s_barrier
  s_add_u32 m0, s73, 0
  s_add_u32 s70, s74, 2359296
  buffer_load_dwordx4 v30, s[48:51], s70 offen lds
  s_add_u32 m0, s73, 1024
  s_add_u32 s70, s74, 2396160
  buffer_load_dwordx4 v30, s[48:51], s70 offen lds
  s_add_u32 m0, s73, 2048
  s_add_u32 s70, s74, 2433024
  buffer_load_dwordx4 v30, s[48:51], s70 offen lds
  s_add_u32 m0, s73, 3072
  s_add_u32 s70, s74, 2469888
  buffer_load_dwordx4 v30, s[48:51], s70 offen lds
  v_add_u32 v2, 16384, v34
  ds_read_b64_tr_b16 a[152:153], v2 offset:0
  ds_read_b64_tr_b16 a[154:155], v2 offset:1024
  ds_read_b64_tr_b16 a[224:225], v2 offset:32
  ds_read_b64_tr_b16 a[226:227], v2 offset:1056
  ds_read_b64_tr_b16 a[156:157], v2 offset:8192
  ds_read_b64_tr_b16 a[158:159], v2 offset:9216
  ds_read_b64_tr_b16 a[228:229], v2 offset:8224
  ds_read_b64_tr_b16 a[230:231], v2 offset:9248
  s_waitcnt vmcnt(20) lgkmcnt(0)
  s_barrier
  s_add_u32 m0, s73, 16384
  s_add_u32 s70, s74, 2949120
  buffer_load_dwordx4 v30, s[44:47], s70 offen lds
  s_add_u32 m0, s73, 17408
  s_add_u32 s70, s74, 2985984
  buffer_load_dwordx4 v30, s[44:47], s70 offen lds
  s_add_u32 m0, s73, 18432
  s_add_u32 s70, s74, 3022848
  buffer_load_dwordx4 v30, s[44:47], s70 offen lds
  s_add_u32 m0, s73, 19456
  s_add_u32 s70, s74, 3059712
  buffer_load_dwordx4 v30, s[44:47], s70 offen lds
  v_add_u32 v2, 32768, v34
  ds_read_b64_tr_b16 a[16:17], v2 offset:0
  ds_read_b64_tr_b16 a[18:19], v2 offset:1024
  ds_read_b64_tr_b16 a[88:89], v2 offset:32
  ds_read_b64_tr_b16 a[90:91], v2 offset:1056
  ds_read_b64_tr_b16 a[20:21], v2 offset:8192
  ds_read_b64_tr_b16 a[22:23], v2 offset:9216
  ds_read_b64_tr_b16 a[92:93], v2 offset:8224
  ds_read_b64_tr_b16 a[94:95], v2 offset:9248
  s_waitcnt vmcnt(20) lgkmcnt(0)
  s_barrier
  s_add_u32 m0, s73, 32768
  s_add_u32 s70, s74, 2949120
  buffer_load_dwordx4 v30, s[48:51], s70 offen lds
  s_add_u32 m0, s73, 33792
  s_add_u32 s70, s74, 2985984
  buffer_load_dwordx4 v30, s[48:51], s70 offen lds
  s_add_u32 m0, s73, 34816
  s_add_u32 s70, s74, 3022848
  buffer_load_dwordx4 v30, s[48:51], s70 offen lds
  s_add_u32 m0, s73, 35840
  s_add_u32 s70, s74, 3059712
  buffer_load_dwordx4 v30, s[48:51], s70 offen lds
  v_add_u32 v2, 49152, v34
  ds_read_b64_tr_b16 a[160:161], v2 offset:0
  ds_read_b64_tr_b16 a[162:163], v2 offset:1024
  ds_read_b64_tr_b16 a[232:233], v2 offset:32
  ds_read_b64_tr_b16 a[234:235], v2 offset:1056
  ds_read_b64_tr_b16 a[164:165], v2 offset:8192
  ds_read_b64_tr_b16 a[166:167], v2 offset:9216
  ds_read_b64_tr_b16 a[236:237], v2 offset:8224
  ds_read_b64_tr_b16 a[238:239], v2 offset:9248
  s_waitcnt vmcnt(20) lgkmcnt(0)
  s_barrier
  s_add_u32 m0, s73, 49152
  s_add_u32 s70, s74, 3538944
  buffer_load_dwordx4 v30, s[44:47], s70 offen lds
  s_add_u32 m0, s73, 50176
  s_add_u32 s70, s74, 3575808
  buffer_load_dwordx4 v30, s[44:47], s70 offen lds
  s_add_u32 m0, s73, 51200
  s_add_u32 s70, s74, 3612672
  buffer_load_dwordx4 v30, s[44:47], s70 offen lds
  s_add_u32 m0, s73, 52224
  s_add_u32 s70, s74, 3649536
  buffer_load_dwordx4 v30, s[44:47], s70 offen lds
  v_add_u32 v2, 65536, v34
  ds_read_b64_tr_b16 a[24:25], v2 offset:0
  ds_read_b64_tr_b16 a[26:27], v2 offset:1024
  ds_read_b64_tr_b16 a[96:97], v2 offset:32
  ds_read_b64_tr_b16 a[98:99], v2 offset:1056
  ds_read_b64_tr_b16 a[28:29], v2 offset:8192
  ds_read_b64_tr_b16 a[30:31], v2 offset:9216
  ds_read_b64_tr_b16 a[100:101], v2 offset:8224
  ds_read_b64_tr_b16 a[102:103], v2 offset:9248
  s_waitcnt vmcnt(20) lgkmcnt(0)
  s_barrier
  s_add_u32 m0, s73, 65536
  s_add_u32 s70, s74, 3538944
  buffer_load_dwordx4 v30, s[48:51], s70 offen lds
  s_add_u32 m0, s73, 66560
  s_add_u32 s70, s74, 3575808
  buffer_load_dwordx4 v30, s[48:51], s70 offen lds
  s_add_u32 m0, s73, 67584
  s_add_u32 s70, s74, 3612672
  buffer_load_dwordx4 v30, s[48:51], s70 offen lds
  s_add_u32 m0, s73, 68608
  s_add_u32 s70, s74, 3649536
  buffer_load_dwordx4 v30, s[48:51], s70 offen lds
  v_add_u32 v2, 81920, v34
  ds_read_b64_tr_b16 a[168:169], v2 offset:0
  ds_read_b64_tr_b16 a[170:171], v2 offset:1024
  ds_read_b64_tr_b16 a[240:241], v2 offset:32
  ds_read_b64_tr_b16 a[242:243], v2 offset:1056
  ds_read_b64_tr_b16 a[172:173], v2 offset:8192
  ds_read_b64_tr_b16 a[174:175], v2 offset:9216
  ds_read_b64_tr_b16 a[244:245], v2 offset:8224
  ds_read_b64_tr_b16 a[246:247], v2 offset:9248
  s_waitcnt vmcnt(20) lgkmcnt(0)
  s_barrier
  s_add_u32 m0, s73, 81920
  s_add_u32 s70, s74, 4128768
  buffer_load_dwordx4 v30, s[44:47], s70 offen lds
  s_add_u32 m0, s73, 82944
  s_add_u32 s70, s74, 4165632
  buffer_load_dwordx4 v30, s[44:47], s70 offen lds
  s_add_u32 m0, s73, 83968
  s_add_u32 s70, s74, 4202496
  buffer_load_dwordx4 v30, s[44:47], s70 offen lds
  s_add_u32 m0, s73, 84992
  s_add_u32 s70, s74, 4239360
  buffer_load_dwordx4 v30, s[44:47], s70 offen lds
  v_add_u32 v2, 98304, v34
  ds_read_b64_tr_b16 a[32:33], v2 offset:0
  ds_read_b64_tr_b16 a[34:35], v2 offset:1024
  ds_read_b64_tr_b16 a[104:105], v2 offset:32
  ds_read_b64_tr_b16 a[106:107], v2 offset:1056
  ds_read_b64_tr_b16 a[36:37], v2 offset:8192
  ds_read_b64_tr_b16 a[38:39], v2 offset:9216
  ds_read_b64_tr_b16 a[108:109], v2 offset:8224
  ds_read_b64_tr_b16 a[110:111], v2 offset:9248
  s_waitcnt vmcnt(20) lgkmcnt(0)
  s_barrier
  s_add_u32 m0, s73, 98304
  s_add_u32 s70, s74, 4128768
  buffer_load_dwordx4 v30, s[48:51], s70 offen lds
  s_add_u32 m0, s73, 99328
  s_add_u32 s70, s74, 4165632
  buffer_load_dwordx4 v30, s[48:51], s70 offen lds
  s_add_u32 m0, s73, 100352
  s_add_u32 s70, s74, 4202496
  buffer_load_dwordx4 v30, s[48:51], s70 offen lds
  s_add_u32 m0, s73, 101376
  s_add_u32 s70, s74, 4239360
  buffer_load_dwordx4 v30, s[48:51], s70 offen lds
  v_add_u32 v2, 0, v34
  ds_read_b64_tr_b16 a[176:177], v2 offset:0
  ds_read_b64_tr_b16 a[178:179], v2 offset:1024
  ds_read_b64_tr_b16 a[248:249], v2 offset:32
  ds_read_b64_tr_b16 a[250:251], v2 offset:1056
  ds_read_b64_tr_b16 a[180:181], v2 offset:8192
  ds_read_b64_tr_b16 a[182:183], v2 offset:9216
  ds_read_b64_tr_b16 a[252:253], v2 offset:8224
  ds_read_b64_tr_b16 a[254:255], v2 offset:9248
  s_waitcnt vmcnt(20) lgkmcnt(0)
  s_barrier
  s_add_u32 m0, s73, 0
  s_add_u32 s70, s74, 4718592
  buffer_load_dwordx4 v30, s[44:47], s70 offen lds
  s_add_u32 m0, s73, 1024
  s_add_u32 s70, s74, 4755456
  buffer_load_dwordx4 v30, s[44:47], s70 offen lds
  s_add_u32 m0, s73, 2048
  s_add_u32 s70, s74, 4792320
  buffer_load_dwordx4 v30, s[44:47], s70 offen lds
  s_add_u32 m0, s73, 3072
  s_add_u32 s70, s74, 4829184
  buffer_load_dwordx4 v30, s[44:47], s70 offen lds
  v_add_u32 v2, 16384, v34
  ds_read_b64_tr_b16 a[40:41], v2 offset:0
  ds_read_b64_tr_b16 a[42:43], v2 offset:1024
  ds_read_b64_tr_b16 a[112:113], v2 offset:32
  ds_read_b64_tr_b16 a[114:115], v2 offset:1056
  ds_read_b64_tr_b16 a[44:45], v2 offset:8192
  ds_read_b64_tr_b16 a[46:47], v2 offset:9216
  ds_read_b64_tr_b16 a[116:117], v2 offset:8224
  ds_read_b64_tr_b16 a[118:119], v2 offset:9248
  s_waitcnt vmcnt(20) lgkmcnt(0)
  s_barrier
  s_add_u32 m0, s73, 16384
  s_add_u32 s70, s74, 4718592
  buffer_load_dwordx4 v30, s[48:51], s70 offen lds
  s_add_u32 m0, s73, 17408
  s_add_u32 s70, s74, 4755456
  buffer_load_dwordx4 v30, s[48:51], s70 offen lds
  s_add_u32 m0, s73, 18432
  s_add_u32 s70, s74, 4792320
  buffer_load_dwordx4 v30, s[48:51], s70 offen lds
  s_add_u32 m0, s73, 19456
  s_add_u32 s70, s74, 4829184
  buffer_load_dwordx4 v30, s[48:51], s70 offen lds
  v_add_u32 v2, 32768, v34
  ds_read_b64_tr_b16 a[184:185], v2 offset:0
  ds_read_b64_tr_b16 a[186:187], v2 offset:1024
  ds_read_b64_tr_b16 v[134:135], v2 offset:32
  ds_read_b64_tr_b16 v[136:137], v2 offset:1056
  ds_read_b64_tr_b16 a[188:189], v2 offset:8192
  ds_read_b64_tr_b16 a[190:191], v2 offset:9216
  ds_read_b64_tr_b16 v[138:139], v2 offset:8224
  ds_read_b64_tr_b16 v[140:141], v2 offset:9248
  s_waitcnt vmcnt(20) lgkmcnt(0)
  s_barrier
  s_add_u32 m0, s73, 32768
  s_add_u32 s70, s76, 147456
  buffer_load_dwordx4 v31, s[52:55], s70 offen lds
  s_add_u32 m0, s73, 33792
  s_add_u32 s70, s76, 152064
  buffer_load_dwordx4 v31, s[52:55], s70 offen lds
  s_add_u32 m0, s73, 34816
  s_add_u32 s70, s76, 156672
  buffer_load_dwordx4 v31, s[52:55], s70 offen lds
  s_add_u32 m0, s73, 35840
  s_add_u32 s70, s76, 161280
  buffer_load_dwordx4 v31, s[52:55], s70 offen lds
  v_add_u32 v2, 49152, v34
  ds_read_b64_tr_b16 a[48:49], v2 offset:0
  ds_read_b64_tr_b16 a[50:51], v2 offset:1024
  ds_read_b64_tr_b16 a[120:121], v2 offset:32
  ds_read_b64_tr_b16 a[122:123], v2 offset:1056
  ds_read_b64_tr_b16 a[52:53], v2 offset:8192
  ds_read_b64_tr_b16 a[54:55], v2 offset:9216
  ds_read_b64_tr_b16 a[124:125], v2 offset:8224
  ds_read_b64_tr_b16 a[126:127], v2 offset:9248
  s_waitcnt vmcnt(20) lgkmcnt(0)
  s_barrier
  s_add_u32 m0, s73, 49152
  s_add_u32 s70, s76, 148480
  buffer_load_dwordx4 v31, s[52:55], s70 offen lds
  s_add_u32 m0, s73, 50176
  s_add_u32 s70, s76, 153088
  buffer_load_dwordx4 v31, s[52:55], s70 offen lds
  s_add_u32 m0, s73, 51200
  s_add_u32 s70, s76, 157696
  buffer_load_dwordx4 v31, s[52:55], s70 offen lds
  s_add_u32 m0, s73, 52224
  s_add_u32 s70, s76, 162304
  buffer_load_dwordx4 v31, s[52:55], s70 offen lds
  v_add_u32 v2, 65536, v34
  ds_read_b64_tr_b16 a[192:193], v2 offset:0
  ds_read_b64_tr_b16 a[194:195], v2 offset:1024
  ds_read_b64_tr_b16 v[142:143], v2 offset:32
  ds_read_b64_tr_b16 v[144:145], v2 offset:1056
  ds_read_b64_tr_b16 a[196:197], v2 offset:8192
  ds_read_b64_tr_b16 a[198:199], v2 offset:9216
  ds_read_b64_tr_b16 v[146:147], v2 offset:8224
  ds_read_b64_tr_b16 v[148:149], v2 offset:9248
  s_waitcnt vmcnt(20) lgkmcnt(0)
  s_barrier
  s_add_u32 m0, s73, 65536
  s_add_u32 s70, s75, 0
  buffer_load_dwordx4 v31, s[52:55], s70 offen lds
  s_add_u32 m0, s73, 66560
  s_add_u32 s70, s75, 4608
  buffer_load_dwordx4 v31, s[52:55], s70 offen lds
  s_add_u32 m0, s73, 67584
  s_add_u32 s70, s75, 9216
  buffer_load_dwordx4 v31, s[52:55], s70 offen lds
  s_add_u32 m0, s73, 68608
  s_add_u32 s70, s75, 13824
  buffer_load_dwordx4 v31, s[52:55], s70 offen lds
  v_add_u32 v2, 81920, v34
  ds_read_b64_tr_b16 a[56:57], v2 offset:0
  ds_read_b64_tr_b16 a[58:59], v2 offset:1024
  ds_read_b64_tr_b16 a[128:129], v2 offset:32
  ds_read_b64_tr_b16 a[130:131], v2 offset:1056
  ds_read_b64_tr_b16 a[60:61], v2 offset:8192
  ds_read_b64_tr_b16 a[62:63], v2 offset:9216
  ds_read_b64_tr_b16 a[132:133], v2 offset:8224
  ds_read_b64_tr_b16 a[134:135], v2 offset:9248
  s_waitcnt vmcnt(20) lgkmcnt(0)
  s_barrier
  s_add_u32 m0, s73, 81920
  s_add_u32 s70, s75, 256
  buffer_load_dwordx4 v31, s[52:55], s70 offen lds
  s_add_u32 m0, s73, 82944
  s_add_u32 s70, s75, 4864
  buffer_load_dwordx4 v31, s[52:55], s70 offen lds
  s_add_u32 m0, s73, 83968
  s_add_u32 s70, s75, 9472
  buffer_load_dwordx4 v31, s[52:55], s70 offen lds
  s_add_u32 m0, s73, 84992
  s_add_u32 s70, s75, 14080
  buffer_load_dwordx4 v31, s[52:55], s70 offen lds
  v_add_u32 v2, 98304, v34
  ds_read_b64_tr_b16 a[200:201], v2 offset:0
  ds_read_b64_tr_b16 a[202:203], v2 offset:1024
  ds_read_b64_tr_b16 v[150:151], v2 offset:32
  ds_read_b64_tr_b16 v[152:153], v2 offset:1056
  ds_read_b64_tr_b16 a[204:205], v2 offset:8192
  ds_read_b64_tr_b16 a[206:207], v2 offset:9216
  ds_read_b64_tr_b16 v[154:155], v2 offset:8224
  ds_read_b64_tr_b16 v[156:157], v2 offset:9248
  s_waitcnt vmcnt(20) lgkmcnt(0)
  s_barrier
  s_add_u32 m0, s73, 98304
  s_add_u32 s70, s75, 512
  buffer_load_dwordx4 v31, s[52:55], s70 offen lds
  s_add_u32 m0, s73, 99328
  s_add_u32 s70, s75, 5120
  buffer_load_dwordx4 v31, s[52:55], s70 offen lds
  s_add_u32 m0, s73, 100352
  s_add_u32 s70, s75, 9728
  buffer_load_dwordx4 v31, s[52:55], s70 offen lds
  s_add_u32 m0, s73, 101376
  s_add_u32 s70, s75, 14336
  buffer_load_dwordx4 v31, s[52:55], s70 offen lds
  v_add_u32_e64 v2, 0, v34
  ds_read_b64_tr_b16 a[64:65], v2 offset:0
  ds_read_b64_tr_b16 a[66:67], v2 offset:1024
  ds_read_b64_tr_b16 a[136:137], v2 offset:32
  ds_read_b64_tr_b16 a[138:139], v2 offset:1056
  ds_read_b64_tr_b16 a[68:69], v2 offset:8192
  ds_read_b64_tr_b16 a[70:71], v2 offset:9216
  ds_read_b64_tr_b16 a[140:141], v2 offset:8224
  ds_read_b64_tr_b16 a[142:143], v2 offset:9248
  s_waitcnt vmcnt(20) lgkmcnt(0)
  s_barrier
  s_add_u32 m0, s73, 0
  s_add_u32 s70, s75, 768
  buffer_load_dwordx4 v31, s[52:55], s70 offen lds
  s_add_u32 m0, s73, 1024
  s_add_u32 s70, s75, 5376
  buffer_load_dwordx4 v31, s[52:55], s70 offen lds
  s_add_u32 m0, s73, 2048
  s_add_u32 s70, s75, 9984
  buffer_load_dwordx4 v31, s[52:55], s70 offen lds
  s_add_u32 m0, s73, 3072
  s_add_u32 s70, s75, 14592
  buffer_load_dwordx4 v31, s[52:55], s70 offen lds
  v_add_u32 v2, 16384, v34
  ds_read_b64_tr_b16 a[208:209], v2 offset:0
  ds_read_b64_tr_b16 a[210:211], v2 offset:1024
  ds_read_b64_tr_b16 v[158:159], v2 offset:32
  ds_read_b64_tr_b16 v[160:161], v2 offset:1056
  ds_read_b64_tr_b16 a[212:213], v2 offset:8192
  ds_read_b64_tr_b16 a[214:215], v2 offset:9216
  ds_read_b64_tr_b16 v[162:163], v2 offset:8224
  ds_read_b64_tr_b16 v[164:165], v2 offset:9248
  s_waitcnt vmcnt(20) lgkmcnt(0)
  s_barrier
  s_add_u32 m0, s73, 16384
  s_add_u32 s70, s75, 1024
  buffer_load_dwordx4 v31, s[52:55], s70 offen lds
  s_add_u32 m0, s73, 17408
  s_add_u32 s70, s75, 5632
  buffer_load_dwordx4 v31, s[52:55], s70 offen lds
  s_add_u32 m0, s73, 18432
  s_add_u32 s70, s75, 10240
  buffer_load_dwordx4 v31, s[52:55], s70 offen lds
  s_add_u32 m0, s73, 19456
  s_add_u32 s70, s75, 14848
  buffer_load_dwordx4 v31, s[52:55], s70 offen lds
  v_add_u32 v2, 32768, v36
  ds_read_b64_tr_b16 v[238:239], v2 offset:0
  ds_read_b64_tr_b16 v[240:241], v2 offset:32
  ds_read_b64_tr_b16 v[242:243], v2 offset:4096
  ds_read_b64_tr_b16 v[244:245], v2 offset:4128
  ds_read_b64_tr_b16 v[246:247], v2 offset:8192
  ds_read_b64_tr_b16 v[248:249], v2 offset:8224
  ds_read_b64_tr_b16 v[250:251], v2 offset:12288
  ds_read_b64_tr_b16 v[252:253], v2 offset:12320
  s_waitcnt vmcnt(20) lgkmcnt(0)
  s_barrier
  v_add_u32 v2, 49152, v33
  ds_read_b64_tr_b16 v[254:255], v2 offset:0
  s_waitcnt vmcnt(16) lgkmcnt(0)
  s_barrier
  v_add_u32 v2, 65536, v35
  ds_read_b64_tr_b16 v[166:167], v2 offset:0
  ds_read_b64_tr_b16 v[168:169], v2 offset:4096
  ds_read_b64_tr_b16 v[170:171], v2 offset:32
  ds_read_b64_tr_b16 v[172:173], v2 offset:4128
  ds_read_b64_tr_b16 v[202:203], v2 offset:8192
  ds_read_b64_tr_b16 v[204:205], v2 offset:12288
  ds_read_b64_tr_b16 v[206:207], v2 offset:8224
  ds_read_b64_tr_b16 v[208:209], v2 offset:12320
  s_waitcnt vmcnt(12) lgkmcnt(0)
  s_barrier
  v_add_u32 v2, 81920, v35
  ds_read_b64_tr_b16 v[174:175], v2 offset:0
  ds_read_b64_tr_b16 v[176:177], v2 offset:4096
  ds_read_b64_tr_b16 v[178:179], v2 offset:32
  ds_read_b64_tr_b16 v[180:181], v2 offset:4128
  ds_read_b64_tr_b16 v[210:211], v2 offset:8192
  ds_read_b64_tr_b16 v[212:213], v2 offset:12288
  ds_read_b64_tr_b16 v[214:215], v2 offset:8224
  ds_read_b64_tr_b16 v[216:217], v2 offset:12320
  s_waitcnt vmcnt(8) lgkmcnt(0)
  s_barrier
  v_add_u32 v2, 98304, v35
  ds_read_b64_tr_b16 v[182:183], v2 offset:0
  ds_read_b64_tr_b16 v[184:185], v2 offset:4096
  ds_read_b64_tr_b16 v[186:187], v2 offset:32
  ds_read_b64_tr_b16 v[188:189], v2 offset:4128
  ds_read_b64_tr_b16 v[218:219], v2 offset:8192
  ds_read_b64_tr_b16 v[220:221], v2 offset:12288
  ds_read_b64_tr_b16 v[222:223], v2 offset:8224
  ds_read_b64_tr_b16 v[224:225], v2 offset:12320
  s_waitcnt vmcnt(4) lgkmcnt(0)
  s_barrier
  v_add_u32 v2, 0, v35
  ds_read_b64_tr_b16 v[190:191], v2 offset:0
  ds_read_b64_tr_b16 v[192:193], v2 offset:4096
  ds_read_b64_tr_b16 v[194:195], v2 offset:32
  ds_read_b64_tr_b16 v[196:197], v2 offset:4128
  ds_read_b64_tr_b16 v[226:227], v2 offset:8192
  ds_read_b64_tr_b16 v[228:229], v2 offset:12288
  ds_read_b64_tr_b16 v[230:231], v2 offset:8224
  ds_read_b64_tr_b16 v[232:233], v2 offset:12320
  s_waitcnt vmcnt(0) lgkmcnt(0)
  s_barrier
  v_add_u32 v2, 16384, v32
  ds_read_b64_tr_b16 v[198:199], v2 offset:0
  ds_read_b64_tr_b16 v[200:201], v2 offset:4096
  ds_read_b64_tr_b16 v[234:235], v2 offset:8192
  ds_read_b64_tr_b16 v[236:237], v2 offset:12288
  s_waitcnt lgkmcnt(0)
  s_barrier
  ds_write_b128 v8, v[60:63] offset:0
  ds_write_b128 v8, v[64:67] offset:1024
  ds_write_b128 v8, v[68:71] offset:2048
  ds_write_b128 v8, v[72:75] offset:3072
  ds_write_b128 v8, v[76:79] offset:4096
  ds_write_b128 v8, v[80:83] offset:5120
  ds_write_b128 v8, v[84:87] offset:6144
  ds_write_b128 v8, v[88:91] offset:7168
  ds_write_b128 v8, v[92:95] offset:8192
  s_waitcnt lgkmcnt(0)
  ds_write_b128 v8, v[96:99] offset:9216
  ds_write_b128 v8, v[100:103] offset:10240
  ds_write_b128 v8, v[104:107] offset:11264
  ds_write_b128 v8, v[108:111] offset:12288
  ds_write_b128 v8, v[112:115] offset:13312
  ds_write_b128 v8, v[116:119] offset:14336
  ds_write_b128 v8, v[120:123] offset:15360
  ds_write_b128 v8, v[124:127] offset:16384
  ds_write_b128 v8, v[128:131] offset:17408
  s_waitcnt lgkmcnt(0)
  v_and_b32 v1, 1, v0
  v_lshlrev_b32 v1, 4, v1
  v_mov_b32 v2, 0x3f80
  v_lshlrev_b32 v2, v1, v2
  v_bfe_u32 v1, v0, 2, 2
  v_cmp_eq_u32 vcc, 0, v1
  s_nop 1
  v_cndmask_b32 v56, 0, v2, vcc
  v_cmp_eq_u32 vcc, 1, v1
  s_nop 1
  v_cndmask_b32 v57, 0, v2, vcc
  v_cmp_eq_u32 vcc, 2, v1
  s_nop 1
  v_cndmask_b32 v58, 0, v2, vcc
  v_cmp_eq_u32 vcc, 3, v1
  s_nop 1
  v_cndmask_b32 v59, 0, v2, vcc
  v_bfe_u32 v1, v0, 4, 2
  v_lshlrev_b32 v2, 0, v1
  s_mov_b32 s70, 147456
  v_mul_lo_u32 v19, s70, v2
  v_mov_b32_e64 v20, v19
  v_bfe_u32 v1, v0, 0, 4
  v_lshl_add_u32 v19, v1, 4, v19
  v_bfe_u32 v1, v0, 0, 4
  v_lshl_add_u32 v20, v1, 1, v20
  s_lshl_b32 s70, s64, 8
  v_add_u32 v19, s70, v19
  s_lshl_b32 s70, s64, 5
  s_add_u32 s70, s70, 1024
  v_add_u32 v20, s70, v20
  v_bfe_u32 v1, v0, 4, 2
  v_lshlrev_b32_e64 v2, 0, v1
  v_mul_u32_u24 v21, 1152, v2
  v_bfe_u32 v1, v0, 0, 4
  v_lshl_add_u32 v21, v1, 4, v21
  s_lshl_b32 s70, s64, 8
  v_add_u32 v21, s70, v21
  v_bfe_u32 v1, v0, 3, 3
  v_lshlrev_b32_e64 v2, 0, v1
  v_mul_u32_u24 v22, 1152, v2
  v_bfe_u32 v1, v0, 0, 3
  v_lshl_add_u32 v22, v1, 4, v22
  s_mul_i32 s70, s64, 9216
  s_add_u32 s70, s70, 1024
  v_add_u32 v22, s70, v22
  v_bfe_u32 v1, v0, 4, 2
  v_lshlrev_b32 v23, 9, v1
  v_bfe_u32 v1, v0, 0, 4
  v_lshl_add_u32 v23, v1, 2, v23
  s_lshl_b32 s70, s64, 7
  s_add_u32 s70, s70, 36864
  v_add_u32 v23, s70, v23
  v_bfe_u32 v1, v0, 3, 1
  v_lshlrev_b32_e64 v24, 8, v1
  v_bfe_u32 v1, v0, 0, 3
  v_lshl_add_u32 v24, v1, 5, v24
  v_bfe_u32 v1, v0, 4, 2
  v_lshl_add_u32 v24, v1, 3, v24
  s_lshl_b32 s70, s64, 9
  s_add_u32 s70, s70, 38912
  v_add_u32 v24, s70, v24
  v_lshlrev_b32 v25, 5, v0
  v_lshlrev_b32 v26, 2, v0
  v_lshlrev_b32 v27, 4, v0
  v_lshlrev_b32 v28, 1, v0
  v_add_u32 v28, 1024, v28
  s_mov_b32 s71, 32768
WC_73:
  buffer_load_dword v1, v3, s[40:43], 0 offen offset:204 sc1
  s_waitcnt vmcnt(0)
  v_cmp_gt_u32 vcc, 160, v1
  s_cbranch_vccz WCD_74
  s_sleep 2
  s_sub_u32 s71, s71, 1
  s_cmp_lg_u32 s71, 0
  s_cbranch_scc1 WC_73
  s_mov_b32 s68, 65
  s_branch L_ABORT
WCD_74:
  s_mov_b32 s71, 32768
WC_75:
  buffer_load_dword v1, v3, s[40:43], 0 offen offset:72 sc1
  s_waitcnt vmcnt(0)
  v_cmp_gt_u32 vcc, 36, v1
  s_cbranch_vccz WCD_76
  s_sleep 2
  s_sub_u32 s71, s71, 1
  s_cmp_lg_u32 s71, 0
  s_cbranch_scc1 WC_75
  s_mov_b32 s68, 66
  s_branch L_ABORT
WCD_76:
  s_mov_b32 s70, 71296
  buffer_load_dwordx4 v[60:63], v27, s[36:39], s70 offen offset:0 sc1
  buffer_load_ushort v64, v28, s[36:39], s70 offen offset:0 sc1
  s_waitcnt vmcnt(0)
  v_lshlrev_b32 v38, 16, v60
  v_and_b32 v39, 0xffff0000, v60
  v_lshlrev_b32 v40, 16, v61
  v_and_b32 v41, 0xffff0000, v61
  v_lshlrev_b32 v42, 16, v62
  v_and_b32 v43, 0xffff0000, v62
  v_lshlrev_b32 v44, 16, v63
  v_and_b32 v45, 0xffff0000, v63
  v_lshlrev_b32 v46, 16, v64
  v_add_u32 v1, 0, v0
  v_mul_u32_u24 v2, 911, v1
  v_lshrrev_b32 v2, 17, v2
  s_lshl_b32 s70, s64, 2
  v_add_u32 v2, s70, v2
  v_and_b32 v2, 7, v2
  v_xor_b32 v1, v1, v2
  v_lshlrev_b32 v29, 4, v1
  v_add_u32 v1, 64, v0
  v_mul_u32_u24 v2, 911, v1
  v_lshrrev_b32 v2, 17, v2
  s_lshl_b32 s70, s64, 2
  v_add_u32 v2, s70, v2
  v_and_b32 v2, 7, v2
  v_xor_b32 v1, v1, v2
  v_lshlrev_b32 v30, 4, v1
  v_add_u32 v1, 128, v0
  v_mul_u32_u24 v2, 911, v1
  v_lshrrev_b32 v2, 17, v2
  s_lshl_b32 s70, s64, 2
  v_add_u32 v2, s70, v2
  v_and_b32 v2, 7, v2
  v_xor_b32 v1, v1, v2
  v_lshlrev_b32 v31, 4, v1
  v_add_u32 v1, 192, v0
  v_mul_u32_u24 v2, 911, v1
  v_lshrrev_b32 v2, 17, v2
  s_lshl_b32 s70, s64, 2
  v_add_u32 v2, s70, v2
  v_and_b32 v2, 7, v2
  v_xor_b32 v1, v1, v2
  v_lshlrev_b32 v32, 4, v1
  v_add_u32 v1, 256, v0
  v_mul_u32_u24 v2, 911, v1
  v_lshrrev_b32 v2, 17, v2
  s_lshl_b32 s70, s64, 2
  v_add_u32 v2, s70, v2
  v_and_b32 v2, 7, v2
  v_xor_b32 v1, v1, v2
  v_lshlrev_b32 v33, 4, v1
  v_add_u32 v1, 320, v0
  v_mul_u32_u24 v2, 911, v1
  v_lshrrev_b32 v2, 17, v2
  s_lshl_b32 s70, s64, 2
  v_add_u32 v2, s70, v2
  v_and_b32 v2, 7, v2
  v_xor_b32 v1, v1, v2
  v_lshlrev_b32 v34, 4, v1
  v_add_u32 v1, 384, v0
  v_mul_u32_u24 v2, 911, v1
  v_lshrrev_b32 v2, 17, v2
  s_lshl_b32 s70, s64, 2
  v_add_u32 v2, s70, v2
  v_and_b32 v2, 7, v2
  v_xor_b32 v1, v1, v2
  v_lshlrev_b32 v35, 4, v1
  v_add_u32 v1, 448, v0
  v_mul_u32_u24 v2, 911, v1
  v_lshrrev_b32 v2, 17, v2
  s_lshl_b32 s70, s64, 2
  v_add_u32 v2, s70, v2
  v_and_b32 v2, 7, v2
  v_xor_b32 v1, v1, v2
  v_lshlrev_b32 v36, 4, v1
  v_add_u32 v1, 512, v0
  v_mul_u32_u24 v2, 911, v1
  v_lshrrev_b32 v2, 17, v2
  s_lshl_b32 s70, s64, 2
  v_add_u32 v2, s70, v2
  v_and_b32 v2, 7, v2
  v_xor_b32 v1, v1, v2
  v_lshlrev_b32 v37, 4, v1
  v_bfe_u32 v1, v0, 0, 4
  v_lshlrev_b32 v2, 0, v1
  v_mul_u32_u24 v15, 1152, v2
  v_bfe_u32 v1, v0, 1, 3
  v_bfe_u32 v2, v0, 4, 2
  v_xor_b32 v1, v1, v2
  v_xor_b32 v2, 4, v1
  v_lshl_add_u32 v16, v2, 4, v15
  v_lshl_add_u32 v15, v1, 4, v15
  s_lshr_b32 s70, s64, 1
  s_xor_b32 s82, s70, 1
  s_mul_i32 s71, s82, 18432
  v_add_u32 v17, s71, v15
  v_add_u32 v18, s71, v16
  s_mul_i32 s71, s70, 18432
  v_add_u32 v15, s71, v15
  v_add_u32 v16, s71, v16
  v_bfe_u32 v1, v0, 4, 2
  v_lshlrev_b32 v13, 9, v1
  v_bfe_u32 v1, v0, 0, 4
  v_lshl_add_u32 v13, v1, 4, v13
  s_lshl_b32 s71, s64, 11
  s_add_u32 s71, s71, 36864
  v_add_u32 v10, s71, v13
  s_lshl_b32 s71, s82, 8
  v_add_u32 v11, s71, v10
  s_lshl_b32 s71, s70, 8
  v_add_u32 v10, s71, v10
  v_bfe_u32 v1, v0, 4, 2
  v_lshlrev_b32 v14, 8, v1
  v_bfe_u32 v1, v0, 0, 4
  v_lshl_add_u32 v14, v1, 3, v14
  s_lshl_b32 s71, s70, 7
  s_and_b32 s82, s64, 1
  s_lshl_b32 s70, s82, 2
  s_add_u32 s71, s71, s70
  s_add_u32 s71, s71, 45056
  v_add_u32 v12, s71, v14
  s_lshl_b32 s71, s82, 10
  s_add_u32 s71, s71, 119808
  v_add_u32_e64 v9, s71, v4
  s_mul_i32 s70, s67, 0x240000
  s_add_u32 s70, s70, 15728640
  s_mul_i32 s77, s65, 1152
  s_add_u32 s77, s77, s70
  s_mul_i32 s78, s65, 36864
  s_add_u32 s78, s78, s70
  s_mov_b32 s72, s67
  s_mul_i32 s73, s64, 9216
  s_mov_b32 s83, 0
  s_barrier
  s_add_u32 s70, s72, 0
  s_lshr_b32 s81, s70, 1
  s_add_u32 s81, s81, 1
  s_and_b32 s86, s70, 1
  s_lshl_b32 s86, s86, 7
  s_add_u32 s86, s86, 12800
  s_mul_i32 s84, s70, 36864
  s_add_u32 s84, s84, s73
  s_add_u32 s84, s84, 4194304
  s_mov_b32 s85, 0
L_F_LOOP:
  s_bfe_u32 s79, s83, 0x10001
  s_mul_i32 s70, s72, 36864
  s_mul_i32 s80, s65, 1152
  s_add_u32 s80, s80, s70
  s_cmp_lg_u32 s85, 0
  s_cbranch_scc1 L_F_HAVE
  s_mov_b32 exec_hi, 0
  s_mov_b32 s71, 32768
PW_77:
  buffer_load_dword v6, v5, s[36:39], s86 offen offset:0 sc1
  s_waitcnt vmcnt(0)
  v_cmp_gt_u32 vcc, s81, v6
  s_cbranch_vccz PWD_78
  s_sleep 4
  s_sub_u32 s71, s71, 1
  s_cmp_lg_u32 s71, 0
  s_cbranch_scc1 PW_77
  s_mov_b32 s68, 67
  s_branch L_ABORT
PWD_78:
  s_mov_b64 exec, -1
  s_add_u32 m0, s73, 0
  s_nop 0
  buffer_load_dwordx4 v29, s[36:39], s84 offen sc1 lds
  s_add_u32 m0, s73, 1024
  s_nop 0
  buffer_load_dwordx4 v30, s[36:39], s84 offen sc1 lds
  s_add_u32 m0, s73, 2048
  s_nop 0
  buffer_load_dwordx4 v31, s[36:39], s84 offen sc1 lds
  s_add_u32 m0, s73, 3072
  s_nop 0
  buffer_load_dwordx4 v32, s[36:39], s84 offen sc1 lds
  s_add_u32 m0, s73, 4096
  s_nop 0
  buffer_load_dwordx4 v33, s[36:39], s84 offen sc1 lds
  s_add_u32 m0, s73, 5120
  s_nop 0
  buffer_load_dwordx4 v34, s[36:39], s84 offen sc1 lds
  s_add_u32 m0, s73, 6144
  s_nop 0
  buffer_load_dwordx4 v35, s[36:39], s84 offen sc1 lds
  s_add_u32 m0, s73, 7168
  s_nop 0
  buffer_load_dwordx4 v36, s[36:39], s84 offen sc1 lds
  s_add_u32 m0, s73, 8192
  s_nop 0
  buffer_load_dwordx4 v37, s[36:39], s84 offen sc1 lds
L_F_HAVE:
  s_waitcnt vmcnt(0)
  s_barrier
  s_add_u32 s70, s80, 7340032
  buffer_load_dwordx4 v[48:51], v27, s[36:39], s70 offen offset:0 sc1
  buffer_load_ushort v52, v28, s[36:39], s70 offen offset:0 sc1
  s_add_u32 s70, s72, 3
  s_lshr_b32 s81, s70, 1
  s_add_u32 s81, s81, 1
  s_and_b32 s86, s70, 1
  s_lshl_b32 s86, s86, 7
  s_add_u32 s86, s86, 12800
  s_mul_i32 s84, s70, 36864
  s_add_u32 s84, s84, s73
  s_add_u32 s84, s84, 4194304
  ds_read_b128 v[96:99], v15 offset:0
  ds_read_b128 v[100:103], v17 offset:0
  ds_read_b128 v[104:107], v9 offset:0
  ds_read_b128 v[108:111], v16 offset:0
  ds_read_b128 v[112:115], v18 offset:0
  ds_read_b128 v[116:119], v9 offset:2048
  ds_read_b128 v[120:123], v15 offset:128
  ds_read_b128 v[124:127], v17 offset:128
  ds_read_b128 v[128:131], v9 offset:4096
  s_waitcnt lgkmcnt(6)
  v_mfma_f32_16x16x32_bf16 v[60:63], a[0:3], v[96:99], 0
  v_mfma_f32_16x16x32_bf16 v[64:67], a[0:3], v[100:103], 0
  v_mfma_f32_16x16x32_bf16 v[76:79], a[144:147], v[96:99], 0
  v_mfma_f32_16x16x32_bf16 v[80:83], a[144:147], v[100:103], 0
  v_mfma_f32_16x16x32_bf16 v[92:95], v[104:107], v[96:99], 0
  ds_read_b128 v[96:99], v16 offset:128
  ds_read_b128 v[100:103], v18 offset:128
  ds_read_b128 v[104:107], v9 offset:6144
  s_waitcnt lgkmcnt(6)
  v_mfma_f32_16x16x32_bf16 v[60:63], a[4:7], v[108:111], v[60:63]
  v_mfma_f32_16x16x32_bf16 v[64:67], a[4:7], v[112:115], v[64:67]
  v_mfma_f32_16x16x32_bf16 v[76:79], a[148:151], v[108:111], v[76:79]
  v_mfma_f32_16x16x32_bf16 v[80:83], a[148:151], v[112:115], v[80:83]
  v_mfma_f32_16x16x32_bf16 v[92:95], v[116:119], v[108:111], v[92:95]
  ds_read_b128 v[108:111], v15 offset:256
  ds_read_b128 v[112:115], v17 offset:256
  ds_read_b128 v[116:119], v9 offset:8192
  s_waitcnt lgkmcnt(6)
  v_mfma_f32_16x16x32_bf16 v[60:63], a[8:11], v[120:123], v[60:63]
  v_mfma_f32_16x16x32_bf16 v[64:67], a[8:11], v[124:127], v[64:67]
  v_mfma_f32_16x16x32_bf16 v[76:79], a[152:155], v[120:123], v[76:79]
  v_mfma_f32_16x16x32_bf16 v[80:83], a[152:155], v[124:127], v[80:83]
  v_mfma_f32_16x16x32_bf16 v[92:95], v[128:131], v[120:123], v[92:95]
  ds_read_b128 v[120:123], v16 offset:256
  ds_read_b128 v[124:127], v18 offset:256
  ds_read_b128 v[128:131], v9 offset:10240
  s_waitcnt lgkmcnt(6)
  v_mfma_f32_16x16x32_bf16 v[60:63], a[12:15], v[96:99], v[60:63]
  v_mfma_f32_16x16x32_bf16 v[64:67], a[12:15], v[100:103], v[64:67]
  v_mfma_f32_16x16x32_bf16 v[76:79], a[156:159], v[96:99], v[76:79]
  v_mfma_f32_16x16x32_bf16 v[80:83], a[156:159], v[100:103], v[80:83]
  v_mfma_f32_16x16x32_bf16 v[92:95], v[104:107], v[96:99], v[92:95]
  ds_read_b128 v[96:99], v15 offset:384
  ds_read_b128 v[100:103], v17 offset:384
  ds_read_b128 v[104:107], v9 offset:12288
  s_waitcnt lgkmcnt(6)
  v_mfma_f32_16x16x32_bf16 v[60:63], a[16:19], v[108:111], v[60:63]
  v_mfma_f32_16x16x32_bf16 v[64:67], a[16:19], v[112:115], v[64:67]
  v_mfma_f32_16x16x32_bf16 v[76:79], a[160:163], v[108:111], v[76:79]
  v_mfma_f32_16x16x32_bf16 v[80:83], a[160:163], v[112:115], v[80:83]
  v_mfma_f32_16x16x32_bf16 v[92:95], v[116:119], v[108:111], v[92:95]
  ds_read_b128 v[108:111], v16 offset:384
  ds_read_b128 v[112:115], v18 offset:384
  ds_read_b128 v[116:119], v9 offset:14336
  s_waitcnt lgkmcnt(6)
  v_mfma_f32_16x16x32_bf16 v[60:63], a[20:23], v[120:123], v[60:63]
  v_mfma_f32_16x16x32_bf16 v[64:67], a[20:23], v[124:127], v[64:67]
  v_mfma_f32_16x16x32_bf16 v[76:79], a[164:167], v[120:123], v[76:79]
  v_mfma_f32_16x16x32_bf16 v[80:83], a[164:167], v[124:127], v[80:83]
  v_mfma_f32_16x16x32_bf16 v[92:95], v[128:131], v[120:123], v[92:95]
  ds_read_b128 v[120:123], v15 offset:512
  ds_read_b128 v[124:127], v17 offset:512
  ds_read_b128 v[128:131], v9 offset:16384
  s_waitcnt lgkmcnt(6)
  v_mfma_f32_16x16x32_bf16 v[60:63], a[24:27], v[96:99], v[60:63]
  v_mfma_f32_16x16x32_bf16 v[64:67], a[24:27], v[100:103], v[64:67]
  v_mfma_f32_16x16x32_bf16 v[76:79], a[168:171], v[96:99], v[76:79]
  v_mfma_f32_16x16x32_bf16 v[80:83], a[168:171], v[100:103], v[80:83]
  v_mfma_f32_16x16x32_bf16 v[92:95], v[104:107], v[96:99], v[92:95]
  ds_read_b128 v[96:99], v16 offset:512
  ds_read_b128 v[100:103], v18 offset:512
  ds_read_b128 v[104:107], v9 offset:18432
  s_waitcnt lgkmcnt(6)
  v_mfma_f32_16x16x32_bf16 v[60:63], a[28:31], v[108:111], v[60:63]
  v_mfma_f32_16x16x32_bf16 v[64:67], a[28:31], v[112:115], v[64:67]
  v_mfma_f32_16x16x32_bf16 v[76:79], a[172:175], v[108:111], v[76:79]
  v_mfma_f32_16x16x32_bf16 v[80:83], a[172:175], v[112:115], v[80:83]
  v_mfma_f32_16x16x32_bf16 v[92:95], v[116:119], v[108:111], v[92:95]
  ds_read_b128 v[108:111], v15 offset:640
  ds_read_b128 v[112:115], v17 offset:640
  ds_read_b128 v[116:119], v9 offset:20480
  s_waitcnt lgkmcnt(6)
  v_mfma_f32_16x16x32_bf16 v[60:63], a[32:35], v[120:123], v[60:63]
  v_mfma_f32_16x16x32_bf16 v[64:67], a[32:35], v[124:127], v[64:67]
  v_mfma_f32_16x16x32_bf16 v[76:79], a[176:179], v[120:123], v[76:79]
  v_mfma_f32_16x16x32_bf16 v[80:83], a[176:179], v[124:127], v[80:83]
  v_mfma_f32_16x16x32_bf16 v[92:95], v[128:131], v[120:123], v[92:95]
  ds_read_b128 v[120:123], v16 offset:640
  ds_read_b128 v[124:127], v18 offset:640
  ds_read_b128 v[128:131], v9 offset:22528
  s_waitcnt lgkmcnt(6)
  v_mfma_f32_16x16x32_bf16 v[60:63], a[36:39], v[96:99], v[60:63]
  v_mfma_f32_16x16x32_bf16 v[64:67], a[36:39], v[100:103], v[64:67]
  v_mfma_f32_16x16x32_bf16 v[76:79], a[180:183], v[96:99], v[76:79]
  v_mfma_f32_16x16x32_bf16 v[80:83], a[180:183], v[100:103], v[80:83]
  v_mfma_f32_16x16x32_bf16 v[92:95], v[104:107], v[96:99], v[92:95]
  ds_read_b128 v[96:99], v15 offset:768
  ds_read_b128 v[100:103], v17 offset:768
  ds_read_b128 v[104:107], v9 offset:24576
  s_waitcnt lgkmcnt(6)
  v_mfma_f32_16x16x32_bf16 v[60:63], a[40:43], v[108:111], v[60:63]
  v_mfma_f32_16x16x32_bf16 v[64:67], a[40:43], v[112:115], v[64:67]
  v_mfma_f32_16x16x32_bf16 v[76:79], a[184:187], v[108:111], v[76:79]
  v_mfma_f32_16x16x32_bf16 v[80:83], a[184:187], v[112:115], v[80:83]
  v_mfma_f32_16x16x32_bf16 v[92:95], v[116:119], v[108:111], v[92:95]
  ds_read_b128 v[108:111], v16 offset:768
  ds_read_b128 v[112:115], v18 offset:768
  ds_read_b128 v[116:119], v9 offset:26624
  s_waitcnt lgkmcnt(6)
  v_mfma_f32_16x16x32_bf16 v[60:63], a[44:47], v[120:123], v[60:63]
  v_mfma_f32_16x16x32_bf16 v[64:67], a[44:47], v[124:127], v[64:67]
  v_mfma_f32_16x16x32_bf16 v[76:79], a[188:191], v[120:123], v[76:79]
  v_mfma_f32_16x16x32_bf16 v[80:83], a[188:191], v[124:127], v[80:83]
  v_mfma_f32_16x16x32_bf16 v[92:95], v[128:131], v[120:123], v[92:95]
  ds_read_b128 v[120:123], v15 offset:896
  ds_read_b128 v[124:127], v17 offset:896
  ds_read_b128 v[128:131], v9 offset:28672
  s_waitcnt lgkmcnt(6)
  v_mfma_f32_16x16x32_bf16 v[60:63], a[48:51], v[96:99], v[60:63]
  v_mfma_f32_16x16x32_bf16 v[64:67], a[48:51], v[100:103], v[64:67]
  v_mfma_f32_16x16x32_bf16 v[76:79], a[192:195], v[96:99], v[76:79]
  v_mfma_f32_16x16x32_bf16 v[80:83], a[192:195], v[100:103], v[80:83]
  v_mfma_f32_16x16x32_bf16 v[92:95], v[104:107], v[96:99], v[92:95]
  ds_read_b128 v[96:99], v16 offset:896
  ds_read_b128 v[100:103], v18 offset:896
  ds_read_b128 v[104:107], v9 offset:30720
  s_waitcnt lgkmcnt(6)
  v_mfma_f32_16x16x32_bf16 v[60:63], a[52:55], v[108:111], v[60:63]
  v_mfma_f32_16x16x32_bf16 v[64:67], a[52:55], v[112:115], v[64:67]
  v_mfma_f32_16x16x32_bf16 v[76:79], a[196:199], v[108:111], v[76:79]
  v_mfma_f32_16x16x32_bf16 v[80:83], a[196:199], v[112:115], v[80:83]
  v_mfma_f32_16x16x32_bf16 v[92:95], v[116:119], v[108:111], v[92:95]
  ds_read_b128 v[108:111], v15 offset:1024
  ds_read_b128 v[112:115], v17 offset:1024
  ds_read_b128 v[116:119], v9 offset:32768
  s_waitcnt lgkmcnt(6)
  v_mfma_f32_16x16x32_bf16 v[60:63], a[56:59], v[120:123], v[60:63]
  v_mfma_f32_16x16x32_bf16 v[64:67], a[56:59], v[124:127], v[64:67]
  v_mfma_f32_16x16x32_bf16 v[76:79], a[200:203], v[120:123], v[76:79]
  v_mfma_f32_16x16x32_bf16 v[80:83], a[200:203], v[124:127], v[80:83]
  v_mfma_f32_16x16x32_bf16 v[92:95], v[128:131], v[120:123], v[92:95]
  ds_read_b128 v[120:123], v16 offset:1024
  ds_read_b128 v[124:127], v18 offset:1024
  ds_read_b128 v[128:131], v9 offset:34816
  s_waitcnt lgkmcnt(6)
  v_mfma_f32_16x16x32_bf16 v[60:63], a[60:63], v[96:99], v[60:63]
  v_mfma_f32_16x16x32_bf16 v[64:67], a[60:63], v[100:103], v[64:67]
  v_mfma_f32_16x16x32_bf16 v[76:79], a[204:207], v[96:99], v[76:79]
  v_mfma_f32_16x16x32_bf16 v[80:83], a[204:207], v[100:103], v[80:83]
  v_mfma_f32_16x16x32_bf16 v[92:95], v[104:107], v[96:99], v[92:95]
  ds_read_b128 v[96:99], v15 offset:0
  ds_read_b128 v[100:103], v17 offset:0
  s_waitcnt lgkmcnt(5)
  v_mfma_f32_16x16x32_bf16 v[60:63], a[64:67], v[108:111], v[60:63]
  v_mfma_f32_16x16x32_bf16 v[64:67], a[64:67], v[112:115], v[64:67]
  v_mfma_f32_16x16x32_bf16 v[76:79], a[208:211], v[108:111], v[76:79]
  v_mfma_f32_16x16x32_bf16 v[80:83], a[208:211], v[112:115], v[80:83]
  v_mfma_f32_16x16x32_bf16 v[92:95], v[116:119], v[108:111], v[92:95]
  ds_read_b128 v[108:111], v16 offset:0
  ds_read_b128 v[112:115], v18 offset:0
  s_waitcnt lgkmcnt(4)
  v_mfma_f32_16x16x32_bf16 v[60:63], a[68:71], v[120:123], v[60:63]
  v_mfma_f32_16x16x32_bf16 v[64:67], a[68:71], v[124:127], v[64:67]
  v_mfma_f32_16x16x32_bf16 v[76:79], a[212:215], v[120:123], v[76:79]
  v_mfma_f32_16x16x32_bf16 v[80:83], a[212:215], v[124:127], v[80:83]
  v_mfma_f32_16x16x32_bf16 v[92:95], v[128:131], v[120:123], v[92:95]
  ds_read_b128 v[120:123], v15 offset:128
  ds_read_b128 v[124:127], v17 offset:128
  s_waitcnt lgkmcnt(4)
  v_mfma_f32_16x16x32_bf16 v[68:71], a[72:75], v[96:99], 0
  v_mfma_f32_16x16x32_bf16 v[72:75], a[72:75], v[100:103], 0
  v_mfma_f32_16x16x32_bf16 v[84:87], a[216:219], v[96:99], 0
  v_mfma_f32_16x16x32_bf16 v[88:91], a[216:219], v[100:103], 0
  ds_read_b128 v[96:99], v16 offset:128
  ds_read_b128 v[100:103], v18 offset:128
  s_waitcnt lgkmcnt(4)
  v_mfma_f32_16x16x32_bf16 v[68:71], a[76:79], v[108:111], v[68:71]
  v_cvt_pk_bf16_f32 v132, v60, v61
  v_lshlrev_b32 v60, 16, v132
  v_mfma_f32_16x16x32_bf16 v[72:75], a[76:79], v[112:115], v[72:75]
  v_and_b32 v61, 0xffff0000, v132
  v_cvt_pk_bf16_f32 v132, v76, v77
  v_mfma_f32_16x16x32_bf16 v[84:87], a[220:223], v[108:111], v[84:87]
  v_lshlrev_b32_e64 v76, 16, v132
  v_and_b32 v77, 0xffff0000, v132
  v_mfma_f32_16x16x32_bf16 v[88:91], a[220:223], v[112:115], v[88:91]
  v_mul_f32 v132, 0xbfb8aa3b, v60
  v_mul_f32 v133, 0xbfb8aa3b, v61
  ds_read_b128 v[108:111], v15 offset:256
  ds_read_b128 v[112:115], v17 offset:256
  s_waitcnt lgkmcnt(4)
  v_mfma_f32_16x16x32_bf16 v[68:71], a[80:83], v[120:123], v[68:71]
  v_exp_f32 v132, v132
  v_exp_f32 v133, v133
  v_mfma_f32_16x16x32_bf16 v[72:75], a[80:83], v[124:127], v[72:75]
  v_add_f32 v132, 1.0, v132
  v_add_f32 v133, 1.0, v133
  v_mfma_f32_16x16x32_bf16 v[84:87], a[224:227], v[120:123], v[84:87]
  v_rcp_f32 v132, v132
  v_rcp_f32 v133, v133
  v_mfma_f32_16x16x32_bf16 v[88:91], a[224:227], v[124:127], v[88:91]
  v_mul_f32 v60, v60, v132
  v_mul_f32 v61, v61, v133
  ds_read_b128 v[120:123], v16 offset:256
  ds_read_b128 v[124:127], v18 offset:256
  s_waitcnt lgkmcnt(4)
  v_mfma_f32_16x16x32_bf16 v[68:71], a[84:87], v[96:99], v[68:71]
  v_cvt_pk_bf16_f32 v132, v60, v61
  v_lshlrev_b32 v60, 16, v132
  v_mfma_f32_16x16x32_bf16 v[72:75], a[84:87], v[100:103], v[72:75]
  v_and_b32 v61, 0xffff0000, v132
  v_mul_f32 v60, v60, v76
  v_mfma_f32_16x16x32_bf16 v[84:87], a[228:231], v[96:99], v[84:87]
  v_mul_f32 v61, v61, v77
  v_cvt_pk_bf16_f32 v60, v60, v61
  v_mfma_f32_16x16x32_bf16 v[88:91], a[228:231], v[100:103], v[88:91]
  v_cvt_pk_bf16_f32 v132, v62, v63
  v_lshlrev_b32 v62, 16, v132
  ds_read_b128 v[96:99], v15 offset:384
  ds_read_b128 v[100:103], v17 offset:384
  s_waitcnt lgkmcnt(4)
  v_mfma_f32_16x16x32_bf16 v[68:71], a[88:91], v[108:111], v[68:71]
  v_and_b32 v63, 0xffff0000, v132
  v_cvt_pk_bf16_f32 v132, v78, v79
  v_mfma_f32_16x16x32_bf16 v[72:75], a[88:91], v[112:115], v[72:75]
  v_lshlrev_b32 v78, 16, v132
  v_and_b32 v79, 0xffff0000, v132
  v_mfma_f32_16x16x32_bf16 v[84:87], a[232:235], v[108:111], v[84:87]
  v_mul_f32 v132, 0xbfb8aa3b, v62
  v_mul_f32 v133, 0xbfb8aa3b, v63
  v_mfma_f32_16x16x32_bf16 v[88:91], a[232:235], v[112:115], v[88:91]
  v_exp_f32 v132, v132
  v_exp_f32 v133, v133
  ds_read_b128 v[108:111], v16 offset:384
  ds_read_b128 v[112:115], v18 offset:384
  s_waitcnt lgkmcnt(4)
  v_mfma_f32_16x16x32_bf16 v[68:71], a[92:95], v[120:123], v[68:71]
  v_add_f32 v132, 1.0, v132
  v_add_f32 v133, 1.0, v133
  v_mfma_f32_16x16x32_bf16 v[72:75], a[92:95], v[124:127], v[72:75]
  v_rcp_f32 v132, v132
  v_rcp_f32 v133, v133
  v_mfma_f32_16x16x32_bf16 v[84:87], a[236:239], v[120:123], v[84:87]
  v_mul_f32 v62, v62, v132
  v_mul_f32 v63, v63, v133
  v_mfma_f32_16x16x32_bf16 v[88:91], a[236:239], v[124:127], v[88:91]
  v_cvt_pk_bf16_f32 v132, v62, v63
  v_lshlrev_b32 v62, 16, v132
  ds_read_b128 v[120:123], v15 offset:512
  ds_read_b128 v[124:127], v17 offset:512
  s_waitcnt lgkmcnt(4)
  v_mfma_f32_16x16x32_bf16 v[68:71], a[96:99], v[96:99], v[68:71]
  v_and_b32 v63, 0xffff0000, v132
  v_mul_f32 v62, v62, v78
  v_mfma_f32_16x16x32_bf16 v[72:75], a[96:99], v[100:103], v[72:75]
  v_mul_f32 v63, v63, v79
  v_cvt_pk_bf16_f32 v61, v62, v63
  v_mfma_f32_16x16x32_bf16 v[84:87], a[240:243], v[96:99], v[84:87]
  v_cvt_pk_bf16_f32 v132, v64, v65
  v_lshlrev_b32 v64, 16, v132
  v_mfma_f32_16x16x32_bf16 v[88:91], a[240:243], v[100:103], v[88:91]
  v_and_b32 v65, 0xffff0000, v132
  v_cvt_pk_bf16_f32 v132, v80, v81
  ds_read_b128 v[96:99], v16 offset:512
  ds_read_b128 v[100:103], v18 offset:512
  s_waitcnt lgkmcnt(4)
  v_mfma_f32_16x16x32_bf16 v[68:71], a[100:103], v[108:111], v[68:71]
  v_lshlrev_b32 v80, 16, v132
  v_and_b32 v81, 0xffff0000, v132
  v_mfma_f32_16x16x32_bf16 v[72:75], a[100:103], v[112:115], v[72:75]
  v_mul_f32 v132, 0xbfb8aa3b, v64
  v_mul_f32 v133, 0xbfb8aa3b, v65
  v_mfma_f32_16x16x32_bf16 v[84:87], a[244:247], v[108:111], v[84:87]
  v_exp_f32 v132, v132
  v_exp_f32 v133, v133
  v_mfma_f32_16x16x32_bf16 v[88:91], a[244:247], v[112:115], v[88:91]
  v_add_f32 v132, 1.0, v132
  v_add_f32 v133, 1.0, v133
  ds_read_b128 v[108:111], v15 offset:640
  ds_read_b128 v[112:115], v17 offset:640
  s_waitcnt lgkmcnt(4)
  v_mfma_f32_16x16x32_bf16 v[68:71], a[104:107], v[120:123], v[68:71]
  v_rcp_f32 v132, v132
  v_rcp_f32 v133, v133
  v_mfma_f32_16x16x32_bf16 v[72:75], a[104:107], v[124:127], v[72:75]
  v_mul_f32 v64, v64, v132
  v_mul_f32 v65, v65, v133
  v_mfma_f32_16x16x32_bf16 v[84:87], a[248:251], v[120:123], v[84:87]
  v_cvt_pk_bf16_f32 v132, v64, v65
  v_lshlrev_b32 v64, 16, v132
  v_mfma_f32_16x16x32_bf16 v[88:91], a[248:251], v[124:127], v[88:91]
  v_and_b32 v65, 0xffff0000, v132
  v_mul_f32 v64, v64, v80
  s_mov_b32 exec_hi, 0
  buffer_load_dword v6, v5, s[36:39], s86 offen sc1
  s_mov_b64 exec, -1
  ds_read_b128 v[120:123], v16 offset:640
  ds_read_b128 v[124:127], v18 offset:640
  s_waitcnt lgkmcnt(4)
  v_mfma_f32_16x16x32_bf16 v[68:71], a[108:111], v[96:99], v[68:71]
  v_mul_f32 v65, v65, v81
  v_cvt_pk_bf16_f32 v64, v64, v65
  v_mfma_f32_16x16x32_bf16 v[72:75], a[108:111], v[100:103], v[72:75]
  v_cvt_pk_bf16_f32 v132, v66, v67
  v_lshlrev_b32 v66, 16, v132
  v_mfma_f32_16x16x32_bf16 v[84:87], a[252:255], v[96:99], v[84:87]
  v_and_b32 v67, 0xffff0000, v132
  v_cvt_pk_bf16_f32 v132, v82, v83
  v_mfma_f32_16x16x32_bf16 v[88:91], a[252:255], v[100:103], v[88:91]
  v_lshlrev_b32_e64 v82, 16, v132
  v_and_b32 v83, 0xffff0000, v132
  ds_read_b128 v[96:99], v15 offset:768
  ds_read_b128 v[100:103], v17 offset:768
  s_waitcnt lgkmcnt(4)
  v_mfma_f32_16x16x32_bf16 v[68:71], a[112:115], v[108:111], v[68:71]
  v_mul_f32 v132, 0xbfb8aa3b, v66
  v_mul_f32 v133, 0xbfb8aa3b, v67
  v_mfma_f32_16x16x32_bf16 v[72:75], a[112:115], v[112:115], v[72:75]
  v_exp_f32 v132, v132
  v_exp_f32 v133, v133
  v_mfma_f32_16x16x32_bf16 v[84:87], v[134:137], v[108:111], v[84:87]
  v_add_f32 v132, 1.0, v132
  v_add_f32 v133, 1.0, v133
  v_mfma_f32_16x16x32_bf16 v[88:91], v[134:137], v[112:115], v[88:91]
  v_rcp_f32 v132, v132
  v_rcp_f32 v133, v133
  ds_read_b128 v[108:111], v16 offset:768
  ds_read_b128 v[112:115], v18 offset:768
  s_waitcnt lgkmcnt(4)
  v_mfma_f32_16x16x32_bf16 v[68:71], a[116:119], v[120:123], v[68:71]
  v_mul_f32 v66, v66, v132
  v_mul_f32 v67, v67, v133
  v_mfma_f32_16x16x32_bf16 v[72:75], a[116:119], v[124:127], v[72:75]
  v_cvt_pk_bf16_f32 v132, v66, v67
  v_lshlrev_b32 v66, 16, v132
  v_mfma_f32_16x16x32_bf16 v[84:87], v[138:141], v[120:123], v[84:87]
  v_and_b32 v67, 0xffff0000, v132
  v_mul_f32 v66, v66, v82
  v_mfma_f32_16x16x32_bf16 v[88:91], v[138:141], v[124:127], v[88:91]
  v_mul_f32_e64 v67, v67, v83
  v_cvt_pk_bf16_f32 v65, v66, v67
  ds_read_b128 v[120:123], v15 offset:896
  ds_read_b128 v[124:127], v17 offset:896
  s_waitcnt lgkmcnt(4)
  v_mfma_f32_16x16x32_bf16 v[68:71], a[120:123], v[96:99], v[68:71]
  v_permlane16_swap_b32 v92, v93
  v_permlane16_swap_b32 v94, v95
  v_mfma_f32_16x16x32_bf16 v[72:75], a[120:123], v[100:103], v[72:75]
  v_mov_b32 v132, v93
  v_mov_b32 v93, v94
  v_mfma_f32_16x16x32_bf16 v[84:87], v[142:145], v[96:99], v[84:87]
  v_mov_b32 v94, v132
  v_cvt_pk_bf16_f32 v132, v92, v93
  v_mfma_f32_16x16x32_bf16 v[88:91], v[142:145], v[100:103], v[88:91]
  v_lshlrev_b32_e64 v92, 16, v132
  v_and_b32 v93, 0xffff0000, v132
  ds_read_b128 v[96:99], v16 offset:896
  ds_read_b128 v[100:103], v18 offset:896
  s_waitcnt lgkmcnt(4)
  v_mfma_f32_16x16x32_bf16 v[68:71], a[124:127], v[108:111], v[68:71]
  v_cvt_pk_bf16_f32 v132, v94, v95
  v_lshlrev_b32 v94, 16, v132
  v_mfma_f32_16x16x32_bf16 v[72:75], a[124:127], v[112:115], v[72:75]
  v_and_b32 v95, 0xffff0000, v132
  v_mul_f32 v132, 0xbfb8aa3b, v92
  v_mfma_f32_16x16x32_bf16 v[84:87], v[146:149], v[108:111], v[84:87]
  v_mul_f32 v133, 0xbfb8aa3b, v93
  v_exp_f32 v132, v132
  v_mfma_f32_16x16x32_bf16 v[88:91], v[146:149], v[112:115], v[88:91]
  v_exp_f32 v133, v133
  v_add_f32 v132, 1.0, v132
  ds_read_b128 v[108:111], v15 offset:1024
  ds_read_b128 v[112:115], v17 offset:1024
  s_waitcnt lgkmcnt(4)
  v_mfma_f32_16x16x32_bf16 v[68:71], a[128:131], v[120:123], v[68:71]
  v_add_f32 v133, 1.0, v133
  v_rcp_f32 v132, v132
  v_mfma_f32_16x16x32_bf16 v[72:75], a[128:131], v[124:127], v[72:75]
  v_rcp_f32 v133, v133
  v_mul_f32 v92, v92, v132
  v_mfma_f32_16x16x32_bf16 v[84:87], v[150:153], v[120:123], v[84:87]
  v_mul_f32 v93, v93, v133
  v_cvt_pk_bf16_f32 v132, v92, v93
  v_mfma_f32_16x16x32_bf16 v[88:91], v[150:153], v[124:127], v[88:91]
  v_lshlrev_b32 v92, 16, v132
  v_and_b32 v93, 0xffff0000, v132
  ds_read_b128 v[120:123], v16 offset:1024
  ds_read_b128 v[124:127], v18 offset:1024
  s_waitcnt lgkmcnt(4)
  v_mfma_f32_16x16x32_bf16 v[68:71], a[132:135], v[96:99], v[68:71]
  v_mul_f32 v92, v92, v94
  v_mul_f32 v93, v93, v95
  v_mfma_f32_16x16x32_bf16 v[72:75], a[132:135], v[100:103], v[72:75]
  v_cvt_pk_bf16_f32 v92, v92, v93
  v_mfma_f32_16x16x32_bf16 v[84:87], v[154:157], v[96:99], v[84:87]
  v_mfma_f32_16x16x32_bf16 v[88:91], v[154:157], v[100:103], v[88:91]
  s_waitcnt lgkmcnt(2)
  v_mfma_f32_16x16x32_bf16 v[68:71], a[136:139], v[108:111], v[68:71]
  v_mfma_f32_16x16x32_bf16 v[72:75], a[136:139], v[112:115], v[72:75]
  v_mfma_f32_16x16x32_bf16 v[84:87], v[158:161], v[108:111], v[84:87]
  v_mfma_f32_16x16x32_bf16 v[88:91], v[158:161], v[112:115], v[88:91]
  s_waitcnt lgkmcnt(0)
  v_mfma_f32_16x16x32_bf16 v[68:71], a[140:143], v[120:123], v[68:71]
  v_mfma_f32_16x16x32_bf16 v[72:75], a[140:143], v[124:127], v[72:75]
  v_mfma_f32_16x16x32_bf16 v[84:87], v[162:165], v[120:123], v[84:87]
  v_mfma_f32_16x16x32_bf16 v[88:91], v[162:165], v[124:127], v[88:91]
  ds_write_b32 v12, v92
  s_nop 3
  v_cvt_pk_bf16_f32 v132, v68, v69
  v_cvt_pk_bf16_f32 v96, v70, v71
  v_lshlrev_b32 v68, 16, v132
  v_lshlrev_b32 v70, 16, v96
  v_and_b32 v69, 0xffff0000, v132
  v_and_b32 v71, 0xffff0000, v96
  v_cvt_pk_bf16_f32 v132, v84, v85
  v_cvt_pk_bf16_f32 v96, v86, v87
  v_lshlrev_b32 v84, 16, v132
  v_lshlrev_b32 v86, 16, v96
  v_and_b32 v85, 0xffff0000, v132
  v_and_b32 v87, 0xffff0000, v96
  v_mul_f32 v132, 0xbfb8aa3b, v68
  v_mul_f32 v96, 0xbfb8aa3b, v70
  v_mul_f32 v133, 0xbfb8aa3b, v69
  v_mul_f32 v97, 0xbfb8aa3b, v71
  v_exp_f32 v132, v132
  v_exp_f32 v96, v96
  v_exp_f32 v133, v133
  v_exp_f32 v97, v97
  v_add_f32 v132, 1.0, v132
  v_add_f32 v96, 1.0, v96
  v_add_f32 v133, 1.0, v133
  v_add_f32 v97, 1.0, v97
  v_rcp_f32 v132, v132
  v_rcp_f32 v96, v96
  v_rcp_f32 v133, v133
  v_rcp_f32 v97, v97
  v_mul_f32 v68, v68, v132
  v_mul_f32 v70, v70, v96
  v_mul_f32 v69, v69, v133
  v_mul_f32 v71, v71, v97
  v_cvt_pk_bf16_f32 v132, v68, v69
  v_cvt_pk_bf16_f32 v96, v70, v71
  v_lshlrev_b32 v68, 16, v132
  v_lshlrev_b32 v70, 16, v96
  v_and_b32 v69, 0xffff0000, v132
  v_and_b32 v71, 0xffff0000, v96
  v_mul_f32 v68, v68, v84
  v_mul_f32 v70, v70, v86
  v_mul_f32 v69, v69, v85
  v_mul_f32 v71, v71, v87
  v_cvt_pk_bf16_f32 v62, v68, v69
  v_cvt_pk_bf16_f32 v63, v70, v71
  ds_write_b128 v10, v[60:63]
  v_cvt_pk_bf16_f32 v132, v72, v73
  v_cvt_pk_bf16_f32 v96, v74, v75
  v_lshlrev_b32 v72, 16, v132
  v_lshlrev_b32 v74, 16, v96
  v_and_b32 v73, 0xffff0000, v132
  v_and_b32 v75, 0xffff0000, v96
  v_cvt_pk_bf16_f32 v132, v88, v89
  v_cvt_pk_bf16_f32 v96, v90, v91
  v_lshlrev_b32 v88, 16, v132
  v_lshlrev_b32 v90, 16, v96
  v_and_b32 v89, 0xffff0000, v132
  v_and_b32 v91, 0xffff0000, v96
  v_mul_f32 v132, 0xbfb8aa3b, v72
  v_mul_f32 v96, 0xbfb8aa3b, v74
  v_mul_f32 v133, 0xbfb8aa3b, v73
  v_mul_f32 v97, 0xbfb8aa3b, v75
  v_exp_f32 v132, v132
  v_exp_f32 v96, v96
  v_exp_f32 v133, v133
  v_exp_f32 v97, v97
  v_add_f32 v132, 1.0, v132
  v_add_f32 v96, 1.0, v96
  v_add_f32 v133, 1.0, v133
  v_add_f32 v97, 1.0, v97
  v_rcp_f32 v132, v132
  v_rcp_f32 v96, v96
  v_rcp_f32 v133, v133
  v_rcp_f32 v97, v97
  v_mul_f32 v72, v72, v132
  v_mul_f32 v74, v74, v96
  v_mul_f32 v73, v73, v133
  v_mul_f32 v75, v75, v97
  v_cvt_pk_bf16_f32 v132, v72, v73
  v_cvt_pk_bf16_f32 v96, v74, v75
  v_lshlrev_b32 v72, 16, v132
  v_lshlrev_b32 v74, 16, v96
  v_and_b32 v73, 0xffff0000, v132
  v_and_b32 v75, 0xffff0000, v96
  v_mul_f32 v72, v72, v88
  v_mul_f32 v74, v74, v90
  v_mul_f32 v73, v73, v89
  v_mul_f32 v75, v75, v91
  v_cvt_pk_bf16_f32 v66, v72, v73
  v_cvt_pk_bf16_f32 v67, v74, v75
  ds_write_b128 v11, v[64:67]
  s_waitcnt lgkmcnt(0) vmcnt(0)
  s_barrier
  s_mov_b32 s85, 0
  s_mov_b32 exec_hi, 0
  v_cmp_gt_u32 vcc, s81, v6
  s_mov_b64 exec, -1
  s_cbranch_vccnz L_F_NOPRE
  s_mov_b32 s85, 1
  s_add_u32 m0, s73, 0
  s_nop 0
  buffer_load_dwordx4 v29, s[36:39], s84 offen sc1 lds
  s_add_u32 m0, s73, 1024
  s_nop 0
  buffer_load_dwordx4 v30, s[36:39], s84 offen sc1 lds
  s_add_u32 m0, s73, 2048
  s_nop 0
  buffer_load_dwordx4 v31, s[36:39], s84 offen sc1 lds
  s_add_u32 m0, s73, 3072
  s_nop 0
  buffer_load_dwordx4 v32, s[36:39], s84 offen sc1 lds
  s_add_u32 m0, s73, 4096
  s_nop 0
  buffer_load_dwordx4 v33, s[36:39], s84 offen sc1 lds
  s_add_u32 m0, s73, 5120
  s_nop 0
  buffer_load_dwordx4 v34, s[36:39], s84 offen sc1 lds
  s_add_u32 m0, s73, 6144
  s_nop 0
  buffer_load_dwordx4 v35, s[36:39], s84 offen sc1 lds
  s_add_u32 m0, s73, 7168
  s_nop 0
  buffer_load_dwordx4 v36, s[36:39], s84 offen sc1 lds
  s_add_u32 m0, s73, 8192
  s_nop 0
  buffer_load_dwordx4 v37, s[36:39], s84 offen sc1 lds
L_F_NOPRE:
  ds_read_b128 v[96:99], v13 offset:36864
  ds_read_b128 v[100:103], v13 offset:38912
  ds_read_b128 v[104:107], v13 offset:40960
  ds_read_b128 v[108:111], v13 offset:43008
  ds_read_b64 v[112:113], v14 offset:45056
  ds_read_b128 v[116:119], v8 offset:0
  ds_read_b128 v[120:123], v8 offset:1024
  ds_read_b128 v[124:127], v8 offset:2048
  ds_read_b128 v[128:131], v8 offset:3072
  s_waitcnt lgkmcnt(8)
  v_mfma_f32_16x16x32_bf16 v[60:63], v[96:99], v[166:169], 0
  v_mfma_f32_16x16x32_bf16 v[64:67], v[96:99], v[170:173], 0
  v_mfma_f32_16x16x32_bf16 v[68:71], v[96:99], v[174:177], 0
  v_mfma_f32_16x16x32_bf16 v[72:75], v[96:99], v[178:181], 0
  v_mfma_f32_16x16x32_bf16 v[76:79], v[96:99], v[182:185], 0
  v_mfma_f32_16x16x32_bf16 v[80:83], v[96:99], v[186:189], 0
  v_mfma_f32_16x16x32_bf16 v[84:87], v[96:99], v[190:193], 0
  v_mfma_f32_16x16x32_bf16 v[88:91], v[96:99], v[194:197], 0
  v_mfma_f32_16x16x32_bf16 v[92:95], v[96:99], v[198:201], 0
  s_waitcnt lgkmcnt(3)
  v_mfma_f32_16x16x32_bf16 v[60:63], v[104:107], v[116:119], v[60:63]
  ds_read_b128 v[116:119], v8 offset:4096
  v_mfma_f32_16x16x32_bf16 v[76:79], v[100:103], v[218:221], v[76:79]
  s_waitcnt lgkmcnt(3)
  v_mfma_f32_16x16x32_bf16 v[64:67], v[104:107], v[120:123], v[64:67]
  ds_read_b128 v[120:123], v8 offset:5120
  v_mfma_f32_16x16x32_bf16 v[80:83], v[100:103], v[222:225], v[80:83]
  s_waitcnt lgkmcnt(3)
  v_mfma_f32_16x16x32_bf16 v[68:71], v[104:107], v[124:127], v[68:71]
  ds_read_b128 v[124:127], v8 offset:6144
  v_mfma_f32_16x16x32_bf16 v[84:87], v[100:103], v[226:229], v[84:87]
  s_waitcnt lgkmcnt(3)
  v_mfma_f32_16x16x32_bf16 v[72:75], v[104:107], v[128:131], v[72:75]
  ds_read_b128 v[128:131], v8 offset:7168
  v_mfma_f32_16x16x32_bf16 v[88:91], v[100:103], v[230:233], v[88:91]
  s_waitcnt lgkmcnt(3)
  v_mfma_f32_16x16x32_bf16 v[76:79], v[104:107], v[116:119], v[76:79]
  ds_read_b128 v[116:119], v8 offset:8192
  v_mfma_f32_16x16x32_bf16 v[92:95], v[100:103], v[234:237], v[92:95]
  s_waitcnt lgkmcnt(3)
  v_mfma_f32_16x16x32_bf16 v[80:83], v[104:107], v[120:123], v[80:83]
  ds_read_b128 v[120:123], v8 offset:9216
  v_mfma_f32_16x16x16_bf16 v[60:63], v[112:113], v[238:239], v[60:63]
  s_waitcnt lgkmcnt(3)
  v_mfma_f32_16x16x32_bf16 v[84:87], v[104:107], v[124:127], v[84:87]
  ds_read_b128 v[124:127], v8 offset:10240
  v_mfma_f32_16x16x16_bf16 v[64:67], v[112:113], v[240:241], v[64:67]
  s_waitcnt lgkmcnt(3)
  v_mfma_f32_16x16x32_bf16 v[88:91], v[104:107], v[128:131], v[88:91]
  ds_read_b128 v[128:131], v8 offset:11264
  v_mfma_f32_16x16x16_bf16 v[68:71], v[112:113], v[242:243], v[68:71]
  s_waitcnt lgkmcnt(3)
  v_mfma_f32_16x16x32_bf16 v[92:95], v[104:107], v[116:119], v[92:95]
  ds_read_b128 v[116:119], v8 offset:12288
  v_mfma_f32_16x16x16_bf16 v[72:75], v[112:113], v[244:245], v[72:75]
  s_waitcnt lgkmcnt(3)
  v_mfma_f32_16x16x32_bf16 v[60:63], v[108:111], v[120:123], v[60:63]
  ds_read_b128 v[120:123], v8 offset:13312
  v_mfma_f32_16x16x16_bf16 v[76:79], v[112:113], v[246:247], v[76:79]
  s_waitcnt lgkmcnt(3)
  v_mfma_f32_16x16x32_bf16 v[64:67], v[108:111], v[124:127], v[64:67]
  ds_read_b128 v[124:127], v8 offset:14336
  v_mfma_f32_16x16x16_bf16 v[80:83], v[112:113], v[248:249], v[80:83]
  s_waitcnt lgkmcnt(3)
  v_mfma_f32_16x16x32_bf16 v[68:71], v[108:111], v[128:131], v[68:71]
  ds_read_b128 v[128:131], v8 offset:15360
  v_mfma_f32_16x16x16_bf16 v[84:87], v[112:113], v[250:251], v[84:87]
  s_waitcnt lgkmcnt(3)
  v_mfma_f32_16x16x32_bf16 v[72:75], v[108:111], v[116:119], v[72:75]
  ds_read_b128 v[116:119], v8 offset:16384
  v_mfma_f32_16x16x16_bf16 v[88:91], v[112:113], v[252:253], v[88:91]
  s_waitcnt lgkmcnt(3)
  v_mfma_f32_16x16x32_bf16 v[76:79], v[108:111], v[120:123], v[76:79]
  ds_read_b128 v[120:123], v8 offset:17408
  v_mfma_f32_16x16x16_bf16 v[92:95], v[112:113], v[254:255], v[92:95]
  s_waitcnt lgkmcnt(3)
  v_mfma_f32_16x16x32_bf16 v[80:83], v[108:111], v[124:127], v[80:83]
  v_mfma_f32_16x16x32_bf16 v[60:63], v[100:103], v[202:205], v[60:63]
  s_waitcnt lgkmcnt(2)
  v_mfma_f32_16x16x32_bf16 v[84:87], v[108:111], v[128:131], v[84:87]
  v_mfma_f32_16x16x32_bf16 v[64:67], v[100:103], v[206:209], v[64:67]
  s_waitcnt lgkmcnt(1)
  v_mfma_f32_16x16x32_bf16 v[88:91], v[108:111], v[116:119], v[88:91]
  v_mfma_f32_16x16x32_bf16 v[68:71], v[100:103], v[210:213], v[68:71]
  s_waitcnt lgkmcnt(0)
  v_mfma_f32_16x16x32_bf16 v[92:95], v[108:111], v[120:123], v[92:95]
  v_mfma_f32_16x16x32_bf16 v[72:75], v[100:103], v[214:217], v[72:75]
  s_nop 7
  v_cvt_pk_bf16_f32 v116, v60, v64
  v_cvt_pk_bf16_f32 v117, v68, v72
  v_cvt_pk_bf16_f32 v118, v76, v80
  v_cvt_pk_bf16_f32 v119, v84, v88
  v_cvt_pk_bf16_f32 v120, v92, v92
  v_and_or_b32 v116, v116, -2, s79
  v_and_or_b32 v120, v120, -2, s79
  s_add_u32 s70, s77, 0
  buffer_store_dwordx4 v[116:119], v19, s[36:39], s70 offen
  buffer_store_short v120, v20, s[36:39], s70 offen
  v_cvt_pk_bf16_f32 v124, v61, v65
  v_cvt_pk_bf16_f32 v125, v69, v73
  v_cvt_pk_bf16_f32 v126, v77, v81
  v_cvt_pk_bf16_f32 v127, v85, v89
  v_cvt_pk_bf16_f32 v128, v93, v93
  v_and_or_b32 v124, v124, -2, s79
  v_and_or_b32 v128, v128, -2, s79
  s_add_u32 s70, s77, 36864
  buffer_store_dwordx4 v[124:127], v19, s[36:39], s70 offen
  buffer_store_short v128, v20, s[36:39], s70 offen
  v_cvt_pk_bf16_f32 v116, v62, v66
  v_cvt_pk_bf16_f32 v117, v70, v74
  v_cvt_pk_bf16_f32 v118, v78, v82
  v_cvt_pk_bf16_f32 v119, v86, v90
  v_cvt_pk_bf16_f32 v120, v94, v94
  v_and_or_b32 v116, v116, -2, s79
  v_and_or_b32 v120, v120, -2, s79
  s_add_u32 s70, s77, 73728
  buffer_store_dwordx4 v[116:119], v19, s[36:39], s70 offen
  buffer_store_short v120, v20, s[36:39], s70 offen
  v_cvt_pk_bf16_f32 v124, v63, v67
  v_cvt_pk_bf16_f32 v125, v71, v75
  v_cvt_pk_bf16_f32 v126, v79, v83
  v_cvt_pk_bf16_f32 v127, v87, v91
  v_cvt_pk_bf16_f32 v128, v95, v95
  v_and_or_b32 v124, v124, -2, s79
  v_and_or_b32 v128, v128, -2, s79
  s_add_u32 s70, s77, 110592
  buffer_store_dwordx4 v[124:127], v19, s[36:39], s70 offen
  buffer_store_short v128, v20, s[36:39], s70 offen
  ds_read_b128 v[96:99], v13 offset:37120
  ds_read_b128 v[100:103], v13 offset:39168
  ds_read_b128 v[104:107], v13 offset:41216
  ds_read_b128 v[108:111], v13 offset:43264
  ds_read_b64 v[112:113], v14 offset:45184
  ds_read_b128 v[116:119], v8 offset:0
  ds_read_b128 v[120:123], v8 offset:1024
  ds_read_b128 v[124:127], v8 offset:2048
  ds_read_b128 v[128:131], v8 offset:3072
  s_waitcnt lgkmcnt(8)
  v_mfma_f32_16x16x32_bf16 v[60:63], v[96:99], v[166:169], 0
  v_mfma_f32_16x16x32_bf16 v[64:67], v[96:99], v[170:173], 0
  v_mfma_f32_16x16x32_bf16 v[68:71], v[96:99], v[174:177], 0
  v_mfma_f32_16x16x32_bf16 v[72:75], v[96:99], v[178:181], 0
  v_mfma_f32_16x16x32_bf16 v[76:79], v[96:99], v[182:185], 0
  v_mfma_f32_16x16x32_bf16 v[80:83], v[96:99], v[186:189], 0
  v_mfma_f32_16x16x32_bf16 v[84:87], v[96:99], v[190:193], 0
  v_mfma_f32_16x16x32_bf16 v[88:91], v[96:99], v[194:197], 0
  v_mfma_f32_16x16x32_bf16 v[92:95], v[96:99], v[198:201], 0
  s_waitcnt lgkmcnt(3)
  v_mfma_f32_16x16x32_bf16 v[60:63], v[104:107], v[116:119], v[60:63]
  ds_read_b128 v[116:119], v8 offset:4096
  v_mfma_f32_16x16x32_bf16 v[76:79], v[100:103], v[218:221], v[76:79]
  s_waitcnt lgkmcnt(3)
  v_mfma_f32_16x16x32_bf16 v[64:67], v[104:107], v[120:123], v[64:67]
  ds_read_b128 v[120:123], v8 offset:5120
  v_mfma_f32_16x16x32_bf16 v[80:83], v[100:103], v[222:225], v[80:83]
  s_waitcnt lgkmcnt(3)
  v_mfma_f32_16x16x32_bf16 v[68:71], v[104:107], v[124:127], v[68:71]
  ds_read_b128 v[124:127], v8 offset:6144
  v_mfma_f32_16x16x32_bf16 v[84:87], v[100:103], v[226:229], v[84:87]
  s_waitcnt lgkmcnt(3)
  v_mfma_f32_16x16x32_bf16 v[72:75], v[104:107], v[128:131], v[72:75]
  ds_read_b128 v[128:131], v8 offset:7168
  v_mfma_f32_16x16x32_bf16 v[88:91], v[100:103], v[230:233], v[88:91]
  s_waitcnt lgkmcnt(3)
  v_mfma_f32_16x16x32_bf16 v[76:79], v[104:107], v[116:119], v[76:79]
  ds_read_b128 v[116:119], v8 offset:8192
  v_mfma_f32_16x16x32_bf16 v[92:95], v[100:103], v[234:237], v[92:95]
  s_waitcnt lgkmcnt(3)
  v_mfma_f32_16x16x32_bf16 v[80:83], v[104:107], v[120:123], v[80:83]
  ds_read_b128 v[120:123], v8 offset:9216
  v_mfma_f32_16x16x16_bf16 v[60:63], v[112:113], v[238:239], v[60:63]
  s_waitcnt lgkmcnt(3)
  v_mfma_f32_16x16x32_bf16 v[84:87], v[104:107], v[124:127], v[84:87]
  ds_read_b128 v[124:127], v8 offset:10240
  v_mfma_f32_16x16x16_bf16 v[64:67], v[112:113], v[240:241], v[64:67]
  s_waitcnt lgkmcnt(3)
  v_mfma_f32_16x16x32_bf16 v[88:91], v[104:107], v[128:131], v[88:91]
  ds_read_b128 v[128:131], v8 offset:11264
  v_mfma_f32_16x16x16_bf16 v[68:71], v[112:113], v[242:243], v[68:71]
  s_waitcnt lgkmcnt(3)
  v_mfma_f32_16x16x32_bf16 v[92:95], v[104:107], v[116:119], v[92:95]
  ds_read_b128 v[116:119], v8 offset:12288
  v_mfma_f32_16x16x16_bf16 v[72:75], v[112:113], v[244:245], v[72:75]
  s_waitcnt lgkmcnt(3)
  v_mfma_f32_16x16x32_bf16 v[60:63], v[108:111], v[120:123], v[60:63]
  ds_read_b128 v[120:123], v8 offset:13312
  v_mfma_f32_16x16x16_bf16 v[76:79], v[112:113], v[246:247], v[76:79]
  s_waitcnt lgkmcnt(3)
  v_mfma_f32_16x16x32_bf16 v[64:67], v[108:111], v[124:127], v[64:67]
  ds_read_b128 v[124:127], v8 offset:14336
  v_mfma_f32_16x16x16_bf16 v[80:83], v[112:113], v[248:249], v[80:83]
  s_waitcnt lgkmcnt(3)
  v_mfma_f32_16x16x32_bf16 v[68:71], v[108:111], v[128:131], v[68:71]
  ds_read_b128 v[128:131], v8 offset:15360
  v_mfma_f32_16x16x16_bf16 v[84:87], v[112:113], v[250:251], v[84:87]
  s_waitcnt lgkmcnt(3)
  v_mfma_f32_16x16x32_bf16 v[72:75], v[108:111], v[116:119], v[72:75]
  ds_read_b128 v[116:119], v8 offset:16384
  v_mfma_f32_16x16x16_bf16 v[88:91], v[112:113], v[252:253], v[88:91]
  s_waitcnt lgkmcnt(3)
  v_mfma_f32_16x16x32_bf16 v[76:79], v[108:111], v[120:123], v[76:79]
  ds_read_b128 v[120:123], v8 offset:17408
  v_mfma_f32_16x16x16_bf16 v[92:95], v[112:113], v[254:255], v[92:95]
  s_waitcnt lgkmcnt(3)
  v_mfma_f32_16x16x32_bf16 v[80:83], v[108:111], v[124:127], v[80:83]
  v_mfma_f32_16x16x32_bf16 v[60:63], v[100:103], v[202:205], v[60:63]
  s_waitcnt lgkmcnt(2)
  v_mfma_f32_16x16x32_bf16 v[84:87], v[108:111], v[128:131], v[84:87]
  v_mfma_f32_16x16x32_bf16 v[64:67], v[100:103], v[206:209], v[64:67]
  s_waitcnt lgkmcnt(1)
  v_mfma_f32_16x16x32_bf16 v[88:91], v[108:111], v[116:119], v[88:91]
  v_mfma_f32_16x16x32_bf16 v[68:71], v[100:103], v[210:213], v[68:71]
  s_waitcnt lgkmcnt(0)
  v_mfma_f32_16x16x32_bf16 v[92:95], v[108:111], v[120:123], v[92:95]
  v_mfma_f32_16x16x32_bf16 v[72:75], v[100:103], v[214:217], v[72:75]
  s_nop 7
  v_cvt_pk_bf16_f32 v116, v60, v64
  v_cvt_pk_bf16_f32 v117, v68, v72
  v_cvt_pk_bf16_f32 v118, v76, v80
  v_cvt_pk_bf16_f32 v119, v84, v88
  v_cvt_pk_bf16_f32 v120, v92, v92
  v_and_or_b32 v116, v116, -2, s79
  v_and_or_b32 v120, v120, -2, s79
  s_add_u32 s70, s77, 589824
  buffer_store_dwordx4 v[116:119], v19, s[36:39], s70 offen
  buffer_store_short v120, v20, s[36:39], s70 offen
  v_cvt_pk_bf16_f32 v124, v61, v65
  v_cvt_pk_bf16_f32 v125, v69, v73
  v_cvt_pk_bf16_f32 v126, v77, v81
  v_cvt_pk_bf16_f32 v127, v85, v89
  v_cvt_pk_bf16_f32 v128, v93, v93
  v_and_or_b32 v124, v124, -2, s79
  v_and_or_b32 v128, v128, -2, s79
  s_add_u32 s70, s77, 626688
  buffer_store_dwordx4 v[124:127], v19, s[36:39], s70 offen
  buffer_store_short v128, v20, s[36:39], s70 offen
  v_cvt_pk_bf16_f32 v116, v62, v66
  v_cvt_pk_bf16_f32 v117, v70, v74
  v_cvt_pk_bf16_f32 v118, v78, v82
  v_cvt_pk_bf16_f32 v119, v86, v90
  v_cvt_pk_bf16_f32 v120, v94, v94
  v_and_or_b32 v116, v116, -2, s79
  v_and_or_b32 v120, v120, -2, s79
  s_add_u32 s70, s77, 663552
  buffer_store_dwordx4 v[116:119], v19, s[36:39], s70 offen
  buffer_store_short v120, v20, s[36:39], s70 offen
  v_cvt_pk_bf16_f32 v124, v63, v67
  v_cvt_pk_bf16_f32 v125, v71, v75
  v_cvt_pk_bf16_f32 v126, v79, v83
  v_cvt_pk_bf16_f32 v127, v87, v91
  v_cvt_pk_bf16_f32 v128, v95, v95
  v_and_or_b32 v124, v124, -2, s79
  v_and_or_b32 v128, v128, -2, s79
  s_add_u32 s70, s77, 700416
  buffer_store_dwordx4 v[124:127], v19, s[36:39], s70 offen
  buffer_store_short v128, v20, s[36:39], s70 offen
  s_waitcnt vmcnt(0)
  s_add_u32 s70, s78, 0
  buffer_load_dwordx4 v[60:63], v21, s[36:39], s70 offen sc1
  s_add_u32 s70, s78, 4608
  buffer_load_dwordx4 v[64:67], v21, s[36:39], s70 offen sc1
  s_add_u32 s70, s78, 9216
  buffer_load_dwordx4 v[68:71], v21, s[36:39], s70 offen sc1
  s_add_u32 s70, s78, 13824
  buffer_load_dwordx4 v[72:75], v21, s[36:39], s70 offen sc1
  s_add_u32 s70, s78, 18432
  buffer_load_dwordx4 v[76:79], v21, s[36:39], s70 offen sc1
  s_add_u32 s70, s78, 23040
  buffer_load_dwordx4 v[80:83], v21, s[36:39], s70 offen sc1
  s_add_u32 s70, s78, 27648
  buffer_load_dwordx4 v[84:87], v21, s[36:39], s70 offen sc1
  s_add_u32 s70, s78, 32256
  buffer_load_dwordx4 v[88:91], v21, s[36:39], s70 offen sc1
  buffer_load_dwordx4 v[92:95], v22, s[36:39], s78 offen sc1
  s_mov_b32 s71, 32768
  s_barrier
  s_branch RRC_80
RR_79:
  s_sub_u32 s71, s71, 1
  s_cmp_lg_u32 s71, 0
  s_cbranch_scc1 RRO_81
  s_mov_b32 s68, 68
  s_branch L_ABORT
RRO_81:
  s_add_u32 s70, s78, 0
  buffer_load_dwordx4 v[60:63], v21, s[36:39], s70 offen sc1
  s_add_u32 s70, s78, 4608
  buffer_load_dwordx4 v[64:67], v21, s[36:39], s70 offen sc1
  s_add_u32 s70, s78, 9216
  buffer_load_dwordx4 v[68:71], v21, s[36:39], s70 offen sc1
  s_add_u32 s70, s78, 13824
  buffer_load_dwordx4 v[72:75], v21, s[36:39], s70 offen sc1
  s_add_u32 s70, s78, 18432
  buffer_load_dwordx4 v[76:79], v21, s[36:39], s70 offen sc1
  s_add_u32 s70, s78, 23040
  buffer_load_dwordx4 v[80:83], v21, s[36:39], s70 offen sc1
  s_add_u32 s70, s78, 27648
  buffer_load_dwordx4 v[84:87], v21, s[36:39], s70 offen sc1
  s_add_u32 s70, s78, 32256
  buffer_load_dwordx4 v[88:91], v21, s[36:39], s70 offen sc1
  buffer_load_dwordx4 v[92:95], v22, s[36:39], s78 offen sc1
RRC_80:
  s_waitcnt vmcnt(8)
  v_mfma_f32_16x16x32_bf16 v[96:99], v[56:59], v[60:63], 0
  v_xor_b32 v104, s79, v60
  s_waitcnt vmcnt(7)
  v_mfma_f32_16x16x32_bf16 v[96:99], v[56:59], v[64:67], v[96:99]
  v_bitop3_b32 v104, v104, v64, s79 bitop3:0xf6
  s_waitcnt vmcnt(6)
  v_mfma_f32_16x16x32_bf16 v[96:99], v[56:59], v[68:71], v[96:99]
  v_bitop3_b32 v104, v104, v68, s79 bitop3:0xf6
  s_waitcnt vmcnt(5)
  v_mfma_f32_16x16x32_bf16 v[96:99], v[56:59], v[72:75], v[96:99]
  v_bitop3_b32 v104, v104, v72, s79 bitop3:0xf6
  s_waitcnt vmcnt(4)
  v_mfma_f32_16x16x32_bf16 v[96:99], v[56:59], v[76:79], v[96:99]
  v_bitop3_b32 v104, v104, v76, s79 bitop3:0xf6
  s_waitcnt vmcnt(3)
  v_mfma_f32_16x16x32_bf16 v[96:99], v[56:59], v[80:83], v[96:99]
  v_bitop3_b32 v104, v104, v80, s79 bitop3:0xf6
  s_waitcnt vmcnt(2)
  v_mfma_f32_16x16x32_bf16 v[96:99], v[56:59], v[84:87], v[96:99]
  v_bitop3_b32 v104, v104, v84, s79 bitop3:0xf6
  s_waitcnt vmcnt(1)
  v_mfma_f32_16x16x32_bf16 v[96:99], v[56:59], v[88:91], v[96:99]
  v_bitop3_b32 v104, v104, v88, s79 bitop3:0xf6
  s_waitcnt vmcnt(0)
  v_mfma_f32_16x16x32_bf16 v[100:103], v[56:59], v[92:95], 0
  v_bitop3_b32 v104, v104, v92, s79 bitop3:0xf6
  v_and_b32 v104, 1, v104
  v_cmp_ne_u32 vcc, 0, v104
  s_cbranch_vccnz RR_79
  s_nop 0
  ds_write2_b32 v23, v96, v97 offset0:0 offset1:16
  s_nop 1
  ds_write_b64 v24, v[100:101]
  s_waitcnt lgkmcnt(0)
  s_barrier
  s_and_b32 s70, s83, 3
  s_cmp_lg_u32 s70, s64
  s_cbranch_scc1 L_F_NOLN
  v_lshlrev_b32 v84, 16, v48
  v_and_b32 v85, 0xffff0000, v48
  v_lshlrev_b32 v86, 16, v49
  v_and_b32 v87, 0xffff0000, v49
  v_lshlrev_b32 v88, 16, v50
  v_and_b32 v89, 0xffff0000, v50
  v_lshlrev_b32 v90, 16, v51
  v_and_b32 v91, 0xffff0000, v51
  v_lshlrev_b32_e64 v92, 16, v52
  ds_read_b128 v[60:63], v25 offset:36864
  ds_read_b128 v[64:67], v25 offset:36880
  ds_read_b32 v72, v26 offset:38912
  ds_read_b32 v73, v26 offset:39168
  ds_read_b32 v74, v26 offset:39424
  ds_read_b32 v75, v26 offset:39680
  ds_read_b32 v76, v26 offset:39936
  ds_read_b32 v77, v26 offset:40192
  ds_read_b32 v78, v26 offset:40448
  ds_read_b32 v79, v26 offset:40704
  s_waitcnt lgkmcnt(0)
  v_add_f32 v72, v72, v76
  v_add_f32 v73, v73, v77
  v_add_f32 v74, v74, v78
  v_add_f32 v75, v75, v79
  v_add_f32 v72, v72, v74
  v_add_f32 v73, v73, v75
  v_add_f32 v68, v72, v73
  v_cvt_pk_bf16_f32 v100, v60, v61
  v_lshlrev_b32 v60, 16, v100
  v_and_b32 v61, 0xffff0000, v100
  v_cvt_pk_bf16_f32 v100, v62, v63
  v_lshlrev_b32 v62, 16, v100
  v_and_b32 v63, 0xffff0000, v100
  v_cvt_pk_bf16_f32 v100, v64, v65
  v_lshlrev_b32 v64, 16, v100
  v_and_b32 v65, 0xffff0000, v100
  v_cvt_pk_bf16_f32 v100, v66, v67
  v_lshlrev_b32 v66, 16, v100
  v_and_b32 v67, 0xffff0000, v100
  v_cvt_pk_bf16_f32 v68, v68, v68
  v_lshlrev_b32_e64 v68, 16, v68
  v_pk_mul_f32 v[60:61], v[60:61], v[38:39]
  v_pk_mul_f32 v[62:63], v[62:63], v[40:41]
  v_pk_mul_f32 v[64:65], v[64:65], v[42:43]
  v_pk_mul_f32 v[66:67], v[66:67], v[44:45]
  v_mul_f32 v68, v68, v46
  v_cvt_pk_bf16_f32 v100, v60, v61
  v_lshlrev_b32 v60, 16, v100
  v_and_b32 v61, 0xffff0000, v100
  v_cvt_pk_bf16_f32 v100, v62, v63
  v_lshlrev_b32 v62, 16, v100
  v_and_b32 v63, 0xffff0000, v100
  v_cvt_pk_bf16_f32 v100, v64, v65
  v_lshlrev_b32 v64, 16, v100
  v_and_b32 v65, 0xffff0000, v100
  v_cvt_pk_bf16_f32 v100, v66, v67
  v_lshlrev_b32 v66, 16, v100
  v_and_b32 v67, 0xffff0000, v100
  v_cvt_pk_bf16_f32 v68, v68, v68
  v_lshlrev_b32 v68, 16, v68
  v_pk_add_f32 v[60:61], v[60:61], v[84:85]
  v_pk_add_f32 v[62:63], v[62:63], v[86:87]
  v_pk_add_f32 v[64:65], v[64:65], v[88:89]
  v_pk_add_f32 v[66:67], v[66:67], v[90:91]
  v_add_f32_e64 v68, v68, v92
  v_cvt_pk_bf16_f32 v104, v60, v61
  v_cvt_pk_bf16_f32 v105, v62, v63
  v_cvt_pk_bf16_f32 v106, v64, v65
  v_cvt_pk_bf16_f32 v107, v66, v67
  v_cvt_pk_bf16_f32 v108, v68, v68
  buffer_store_dwordx4 v[104:107], v27, s[56:59], s80 offen
  buffer_store_short v108, v28, s[56:59], s80 offen
L_F_NOLN:
  s_bitcmp1_b32 s83, 0
  s_mov_b32 s70, 0x120000
  s_cselect_b32 s70, 4293787648, s70
  s_add_u32 s77, s77, s70
  s_add_u32 s78, s78, s70
  s_add_u32 s83, s83, 1
  s_add_u32 s72, s72, 3
  s_cmp_lt_u32 s72, 64
  s_cbranch_scc1 L_F_LOOP
  s_endpgm
L_CODE_END:
  s_endpgm
.section .rodata,"a"
.p2align 6
.amdhsa_kernel adaLN_cond__memory_aug_recurrent_mem_tr__swiglu_ffn__prompt_kernel
  .amdhsa_next_free_vgpr 512
  .amdhsa_next_free_sgpr 102
  .amdhsa_accum_offset 256
  .amdhsa_group_segment_fixed_size 0
  .amdhsa_kernarg_size 128
  .amdhsa_user_sgpr_count 2
  .amdhsa_user_sgpr_kernarg_segment_ptr 1
  .amdhsa_system_sgpr_workgroup_id_x 1
  .amdhsa_float_denorm_mode_32 3
.end_amdhsa_kernel
```
